```python
import torch

def _softmax(x, axis=-1):
    return torch.softmax(x, dim=axis)
def _gelu(x):
    return torch.nn.functional.gelu(x, approximate="tanh")
def _silu(x):
    return torch.nn.functional.silu(x)
def _sigmoid(x):
    return torch.sigmoid(x)
def _layernorm(x, axis=-1, eps=1e-5):
    m = x.mean(dim=axis, keepdim=True)
    v = x.var(dim=axis, keepdim=True, unbiased=False)
    return (x - m) / torch.sqrt(v + eps)
def _scatter_add(tgt, idx, src, axis=0):
    return tgt.clone().index_add_(axis, idx, src)
def _segment_sum(src, seg, n):
    out = torch.zeros((n,) + src.shape[1:], dtype=src.dtype)
    return out.index_add_(0, seg, src)
def _pad(x, pw):
    flat = tuple(v for pair in reversed(pw) for v in pair)
    return torch.nn.functional.pad(x, flat)

kernel_name = 'parallel_sum__linear_kernel_hedgehog__dense_activation_relu__prompt'

def setup_inputs():

    _w = (lambda a: (lambda t: t.to(torch.bfloat16) if t.is_floating_point() else t)(torch.as_tensor(a)))
    def _A_setup():
        B, S, D, H = 1, 2048, 576, 32
        Dh = D // H
        return {
            "x": _w((lambda *s: torch.randn(*s, dtype=torch.bfloat16) * 0.05)(B, S, D)),
            "wqkv": _w((lambda *s: torch.randn(*s, dtype=torch.bfloat16) * 0.8)(D, 3 * D)),
            "w_phi": _w((lambda *s: torch.randn(*s, dtype=torch.bfloat16) * 0.8)(H, Dh, Dh) * (Dh ** -0.5)),
            "wo": _w((lambda *s: torch.randn(*s, dtype=torch.bfloat16) * 0.2)(D, D)),
        }
    _A_in = _A_setup()

    def _B_setup():
        B, S, D, Dff = 1, 2048, 576, 4608
        return {
            "x": _w((lambda *s: torch.randn(*s, dtype=torch.bfloat16) * 0.05)(B, S, D)),
            "w1": _w((lambda *s: torch.randn(*s, dtype=torch.bfloat16) * 0.05)(D, Dff)),
            "w2": _w((lambda *s: torch.randn(*s, dtype=torch.bfloat16) * 0.05)(Dff, D)),
        }
    _B_in = _B_setup()

    return {
        "A_x": _A_in["x"],
        "A_wqkv": _A_in["wqkv"],
        "A_w_phi": _A_in["w_phi"],
        "A_wo": _A_in["wo"],
        "B_x": _B_in["x"],
        "B_w1": _B_in["w1"],
        "B_w2": _B_in["w2"],
    }

def reference(A_x, A_wqkv, A_w_phi, A_wo, B_x, B_w1, B_w2):
    def _A_ref(x, wqkv, w_phi, wo):
        B, S, D = x.shape
        H = 32; Dh = D // H
        qkv = (lambda x, *d: x.permute(*d))((x @ wqkv).reshape(B, S, 3, H, Dh), 2, 0, 3, 1, 4)
        q, k, v = qkv[0], qkv[1], qkv[2]
        pq = torch.einsum("bhsd,hdf->bhsf", q, w_phi)
        pk = torch.einsum("bhsd,hdf->bhsf", k, w_phi)
        phi_q = torch.concatenate([_softmax(pq, axis=-1), _softmax(-pq, axis=-1)], axis=-1)
        phi_k = torch.concatenate([_softmax(pk, axis=-1), _softmax(-pk, axis=-1)], axis=-1)
        kv = torch.einsum("bhsf,bhsd->bhfd", phi_k, v)
        z  = torch.einsum("bhsf->bhf", phi_k)
        num = torch.einsum("bhqf,bhfd->bhqd", phi_q, kv)
        den = torch.einsum("bhqf,bhf->bhq", phi_q, z)[..., None] + 1e-6
        o = num / den
        return (lambda x, *d: x.permute(*d))(o, 0, 2, 1, 3).reshape(B, S, D) @ wo

    def _B_ref(x, w1, w2):
        h = torch.einsum("bsd,df->bsf", x, w1)
        zero = torch.zeros_like(h)
        h = torch.maximum(h, zero)
        return torch.einsum("bsf,fd->bsd", h, w2)

    x = A_x
    xn = _layernorm(x, axis=-1)
    return x + _A_ref(xn, A_wqkv, A_w_phi, A_wo) + _B_ref(xn, B_w1, B_w2)
```

```asm
; @launch grid=(256,1,1) block=(256,1,1) lds=163840
.amdgcn_target "amdgcn-amd-amdhsa--gfx950"
.text
.globl parallel_sum__linear_kernel_hedgehog__dense_activation_relu__prompt_kernel
.p2align 8
.type parallel_sum__linear_kernel_hedgehog__dense_activation_relu__prompt_kernel,@function
parallel_sum__linear_kernel_hedgehog__dense_activation_relu__prompt_kernel:
  s_cmp_ge_u32 s2, 0x100
  s_cbranch_scc1 L_end
  s_load_dwordx16 s[84:99], s[0:1], 0
  s_load_dwordx2 s[100:101], s[0:1], 72
  s_getpc_b64 s[82:83]
  v_lshrrev_b32_e64 v239, 6, v0
  s_lshr_b32 s79, s2, 3
  s_mul_i32 s7, s79, 24
  v_lshrrev_b32_e32 v240, 3, v0
  v_add_u32_e32 v240, s7, v240
  v_min_u32_e32 v240, 0x307, v240
  v_lshlrev_b32_e64 v240, 7, v240
  global_load_dword v246, v240, s[82:83]
  v_and_b32_e64 v232, 63, v0
  s_and_b32 s7, s2, 7
  v_readfirstlane_b32 s3, v239
  s_and_b32 s4, s7, 3
  s_lshl_b32 s4, s4, 2
  s_lshr_b32 s5, s7, 2
  s_mul_i32 s5, s5, 8
  s_lshr_b32 s80, s79, 2
  s_add_u32 s5, s5, s80
  s_and_b32 s81, s79, 3
  s_add_u32 s4, s4, s81
  s_and_b32 s6, s4, 1
  s_mul_i32 s81, s81, 2
  s_mul_i32 s7, s80, 1
  s_add_u32 s7, s7, s81
  s_mul_i32 s81, s7, 57
  s_lshr_b32 s81, s81, 9
  s_mul_i32 s81, s81, 9
  s_sub_u32 s7, s7, s81
  s_lshl_b32 s48, s7, 7
  s_add_u32 s49, s48, 0x80
  s_cmp_eq_u32 s49, 0x480
  s_cselect_b32 s49, 0, s49
  s_add_u32 s50, s49, 0x80
  s_cmp_eq_u32 s50, 0x480
  s_cselect_b32 s50, 0, s50
  s_add_u32 s51, s50, 0x80
  s_cmp_eq_u32 s51, 0x480
  s_cselect_b32 s51, 0, s51
  s_add_u32 s52, s51, 0x80
  s_cmp_eq_u32 s52, 0x480
  s_cselect_b32 s52, 0, s52
  s_add_u32 s53, s52, 0x80
  s_cmp_eq_u32 s53, 0x480
  s_cselect_b32 s53, 0, s53
  s_add_u32 s54, s53, 0x80
  s_cmp_eq_u32 s54, 0x480
  s_cselect_b32 s54, 0, s54
  s_add_u32 s55, s54, 0x80
  s_cmp_eq_u32 s55, 0x480
  s_cselect_b32 s55, 0, s55
  s_add_u32 s56, s55, 0x80
  s_cmp_eq_u32 s56, 0x480
  s_cselect_b32 s56, 0, s56
  v_lshrrev_b32_e32 v200, 4, v232
  v_and_b32_e64 v203, 15, v232
  s_lshl_b32 s7, s5, 2
  s_add_u32 s7, s7, s3
  s_mul_i32 s7, s7, 0x9000
  v_lshrrev_b32_e32 v119, 3, v232
  v_xor_b32_e32 v118, v119, v232
  v_and_b32_e32 v118, 7, v118
  v_lshlrev_b32_e32 v118, 4, v118
  v_mul_u32_u24_e32 v112, 0x480, v119
  v_add3_u32 v112, v112, v118, s7
  v_xor_b32_e32 v119, 9, v119
  v_xor_b32_e32 v118, 16, v118
  v_mul_u32_u24_e32 v113, 0x480, v119
  v_add3_u32 v113, v113, v118, s7
  v_subrev_u32_e32 v113, 0x400, v113
  s_mul_i32 s78, s3, 0x4800
  s_add_u32 s78, s78, 0x4000
  v_add_u32_e32 v114, 0x4800, v112
  v_add_u32_e32 v115, 0x4800, v113
  v_bfe_u32 v201, v232, 2, 2
  v_and_b32_e64 v202, 3, v232
  s_mul_i32 s76, s3, 0x420
  s_lshl_b32 s77, s76, 1
  s_waitcnt lgkmcnt(0)
  s_mov_b32 s8, s84
  s_nop 0
  s_and_b32 s9, s85, 0xffff
  s_mov_b32 s10, 0x240000
  s_mov_b32 s11, 0x20000
  s_add_u32 s92, s78, 0x12000
  s_lshl4_add_u32 m0, s48, s78
  s_nop 0
  buffer_load_dwordx4 v112, s[8:11], s48 offen lds
  buffer_load_dwordx4 v113, s[8:11], s48 offen offset:1024 lds
  s_lshl4_add_u32 m0, s49, s78
  s_nop 0
  buffer_load_dwordx4 v112, s[8:11], s49 offen lds
  buffer_load_dwordx4 v113, s[8:11], s49 offen offset:1024 lds
  s_lshl4_add_u32 m0, s50, s78
  s_nop 0
  buffer_load_dwordx4 v112, s[8:11], s50 offen lds
  buffer_load_dwordx4 v113, s[8:11], s50 offen offset:1024 lds
  s_lshl4_add_u32 m0, s48, s92
  s_nop 0
  buffer_load_dwordx4 v114, s[8:11], s48 offen lds
  buffer_load_dwordx4 v115, s[8:11], s48 offen offset:1024 lds
  s_lshl4_add_u32 m0, s49, s92
  s_nop 0
  buffer_load_dwordx4 v114, s[8:11], s49 offen lds
  buffer_load_dwordx4 v115, s[8:11], s49 offen offset:1024 lds
  s_lshl4_add_u32 m0, s50, s92
  s_nop 0
  buffer_load_dwordx4 v114, s[8:11], s50 offen lds
  buffer_load_dwordx4 v115, s[8:11], s50 offen offset:1024 lds
  s_mov_b32 s12, s86
  s_and_b32 s13, s87, 0xffff
  s_mov_b32 s14, 0x1e6000
  s_mov_b32 s15, 0x20000
  s_mov_b32 s16, s94
  s_and_b32 s17, s95, 0xffff
  s_mov_b32 s18, 0x510000
  s_mov_b32 s19, 0x20000
  s_mov_b32 s32, s100
  s_and_b32 s33, s101, 0xffff
  s_mov_b32 s34, 0x10000000
  s_mov_b32 s35, 0x20000
  s_mov_b32 s36, s88
  s_and_b32 s37, s89, 0xffff
  s_mov_b32 s38, 0x5100
  s_mov_b32 s39, 0x20000
  s_mov_b32 s20, s96
  s_and_b32 s21, s97, 0xffff
  s_mov_b32 s22, 0x510000
  s_mov_b32 s23, 0x20000
  s_mov_b32 s24, s90
  s_and_b32 s25, s91, 0xffff
  s_mov_b32 s26, 0xa2000
  s_mov_b32 s27, 0x20000
  s_mov_b32 s28, s98
  s_nop 0
  s_and_b32 s29, s99, 0xffff
  s_mov_b32 s30, 0x240000
  s_mov_b32 s31, 0x20000
  v_mul_u32_u24_e32 v123, 0x56, v232
  v_lshrrev_b32_e64 v123, 8, v123
  v_mul_u32_u24_e32 v244, 0x1ae80, v123
  v_lshl_add_u32 v244, v232, 7, v244
  v_mul_u32_u24_e32 v211, 0x47e80, v123
  v_lshl_add_u32 v211, v232, 7, v211
  v_and_b32_e64 v209, 1, v123
  v_mul_u32_u24_e32 v209, 0x45c00, v209
  v_sub_u32_e64 v211, v211, v209
  v_cmp_gt_u32_e64 s[82:83], 18, v232
  v_mul_u32_u24_e32 v209, 0x90000, v232
  s_lshr_b32 s7, s4, 2
  s_mul_i32 s81, s7, 9
  s_lshr_b32 s81, s81, 2
  s_lshl_b32 s81, s81, 7
  s_mul_i32 s87, s79, 0xd80
  s_add_u32 s87, s87, s81
  s_mul_i32 s81, s3, 0x480
  s_add_u32 s87, s87, s81
  s_cmp_eq_u32 s3, 3
  s_nop 0
  s_cselect_b32 s87, 0x40000000, s87
  v_mov_b32_e32 v123, 0x7ffffff0
  v_cndmask_b32_e64 v244, v123, v244, s[82:83]
  s_mul_i32 s7, s7, 0x900
  s_mul_i32 s93, s79, 0x2400
  s_add_u32 s93, s93, s7
  s_mul_i32 s7, s3, 0x240
  s_and_b32 s81, s7, 64
  s_add_u32 s7, s7, s81
  s_add_u32 s93, s93, s7
  s_lshr_b32 s7, s5, 3
  s_mul_i32 s7, s7, 0x48000
  s_add_u32 s93, s93, s7
  s_lshl_b32 s7, s3, 13
  s_nop 0
  v_lshl_add_u32 v247, v232, 7, s7
  v_min_u32_e32 v247, 0x5080, v247
  s_mul_i32 s89, s4, 0x51000
  s_mul_i32 s7, s5, 0x5100
  s_add_u32 s89, s89, s7
  s_lshr_b32 s85, s89, 3
  s_mul_i32 s96, s4, 0x510
  s_load_dword s79, s[100:101], 0
  s_mov_b32 s0, 0
  s_mov_b32 s1, 0
  s_mov_b32 s40, 0x48000
  s_mov_b32 s57, 0x1b000
  s_mov_b32 s41, 0x90000
  s_mov_b32 s58, 0x36000
  s_mov_b32 s42, 0xd8000
  s_mov_b32 s59, 0x51000
  s_mov_b32 s43, 0x120000
  s_mov_b32 s60, 0x6c000
  s_mov_b32 s44, 0x168000
  s_mov_b32 s61, 0x87000
  s_and_b32 s7, s3, 1
  s_lshl_b32 s7, s7, 1
  s_lshr_b32 s80, s3, 1
  s_lshl_b32 s80, s80, 3
  s_add_u32 s7, s7, s80
  v_and_b32_e32 v207, 1, v200
  v_lshlrev_b32_e32 v207, 2, v207
  v_lshrrev_b32_e32 v208, 1, v200
  v_lshl_add_u32 v207, v208, 4, v207
  v_add_u32_e64 v207, s7, v207
  v_mul_u32_u24_e32 v236, 0xd80, v207
  v_min_u32_e32 v206, 14, v203
  v_mul_u32_u24_e32 v207, 52, v206
  v_lshrrev_b32_e64 v207, 8, v207
  v_mul_u32_u24_e32 v208, 0x430, v207
  v_lshl_add_u32 v208, v206, 4, v208
  v_add_u32_e64 v236, v236, v208
  s_mul_i32 s80, s4, 0x48
  s_and_b32 s80, s80, 0xfffffff0
  v_add_u32_e64 v236, s80, v236
  v_bfe_u32 v207, v232, 3, 1
  v_bfe_u32 v208, v232, 4, 1
  v_lshl_add_u32 v207, v208, 2, v207
  v_lshrrev_b32_e64 v208, 5, v232
  v_lshl_add_u32 v207, v208, 4, v207
  v_add_u32_e64 v207, s7, v207
  v_mul_u32_u24_e32 v237, 0x2400, v207
  v_and_b32_e64 v208, 7, v232
  v_lshl_add_u32 v237, v208, 4, v237
  s_mul_i32 s80, s4, 0x240
  s_lshl_b32 s81, s6, 6
  s_add_u32 s80, s80, s81
  v_add_u32_e64 v237, s80, v237
s_getpc_b64 s[94:95]
L_pc2:
  v_lshlrev_b32_e32 v204, 4, v232
  v_lshl_add_u32 v204, s3, 13, v204
  v_add_u32_e32 v204, L_tab-L_pc2+4096, v204
  v_lshrrev_b32_e32 v207, 3, v203
  v_xor_b32_e32 v207, v207, v203
  v_lshlrev_b32_e32 v207, 7, v207
  v_xor_b32_e32 v208, v200, v203
  v_and_b32_e32 v208, 7, v208
  v_lshlrev_b32_e32 v208, 4, v208
  v_add3_u32 v116, v207, v208, s78
  v_xor_b32_e64 v117, 64, v116
  v_add3_u32 v118, v207, v208, s92
  v_xor_b32_e64 v119, 64, v118
  s_lshl_b32 s7, s6, 2
  s_lshr_b32 s80, s4, 1
  s_lshl_b32 s81, s80, 11
  s_add_u32 s81, s81, s78
  v_lshrrev_b32_e32 v208, 1, v200
  v_add_u32_e32 v208, s7, v208
  v_xor_b32_e32 v208, v208, v203
  v_and_b32_e32 v208, 7, v208
  v_lshl_add_u32 v208, v208, 4, v207
  v_and_b32_e64 v206, 1, v200
  v_lshl_add_u32 v208, v206, 3, v208
  v_add_u32_e32 v120, s81, v208
  v_xor_b32_e32 v121, 32, v120
  s_lshl_b32 s7, s6, 3
  s_add_u32 s7, s7, s78
  v_xor_b32_e32 v208, s80, v203
  v_and_b32_e32 v208, 7, v208
  v_lshl_add_u32 v208, v208, 4, v207
  v_add_u32_e64 v122, s7, v208
  v_accvgpr_write_b32 a244, 0
  v_accvgpr_write_b32 a245, 0
  v_accvgpr_write_b32 a246, 0
  v_accvgpr_write_b32 a247, 0
  v_and_b32_e32 v207, 1, v200
  v_lshrrev_b32_e32 v208, 1, v200
  v_mul_u32_u24_e32 v234, 0x420, v201
  v_mul_u32_u24_e32 v206, 0x1080, v207
  v_add_u32_e64 v234, v234, v206
  v_lshl_add_u32 v234, v208, 9, v234
  s_lshl_b32 s7, s6, 3
  s_add_u32 s7, s7, 0x2100
  v_add_u32_e32 v234, s7, v234
  v_min_u32_e64 v206, 2, v202
  v_mul_u32_u24_e32 v206, 0x50, v206
  v_add3_u32 v235, v234, v206, 64
  v_lshl_add_u32 v234, v202, 3, v234
  v_lshrrev_b32_e64 v206, 1, v201
  v_mul_u32_u24_e32 v233, 0x420, v206
  v_mul_u32_u24_e32 v206, 0x840, v207
  v_add_u32_e64 v233, v233, v206
  v_lshl_add_u32 v233, v208, 9, v233
  v_and_b32_e64 v206, 1, v201
  v_lshl_add_u32 v233, v206, 7, v233
  v_lshl_add_u32 v233, v202, 3, v233
  v_lshrrev_b32_e64 v207, 2, v203
  v_cmp_eq_u32_e64 s[82:83], v207, v200
  v_and_b32_e32 v208, 1, v203
  v_lshlrev_b32_e32 v208, 4, v208
  v_mov_b32_e32 v206, 0x3f80
  v_lshlrev_b32_e64 v206, v208, v206
  v_cndmask_b32_e64 v206, 0, v206, s[82:83]
  v_and_b32_e64 v208, 2, v203
  v_cmp_eq_u32_e64 s[66:67], 0, v208
  v_mov_b32_e32 v205, 0x3f803f80
  s_nop 0
  s_nop 0
  v_cndmask_b32_e64 v207, 0, v206, s[66:67]
  v_cndmask_b32_e64 v208, v206, 0, s[66:67]
  v_accvgpr_write_b32 a176, v207
  v_accvgpr_write_b32 a177, v208
  v_accvgpr_write_b32 a178, 0
  v_accvgpr_write_b32 a179, 0
  v_accvgpr_write_b32 a180, 0
  v_accvgpr_write_b32 a181, 0
  v_accvgpr_write_b32 a182, v207
  v_accvgpr_write_b32 a183, v208
  v_accvgpr_write_b32 a184, v205
  v_accvgpr_write_b32 a185, v205
  v_accvgpr_write_b32 a186, v205
  v_accvgpr_write_b32 a187, v205
  v_accvgpr_write_b32 a248, -1
  v_accvgpr_write_b32 a249, -1
  v_accvgpr_write_b32 a250, -1
  v_accvgpr_write_b32 a251, -1
  v_and_b32_e32 v208, 1, v203
  v_lshlrev_b32_e32 v208, 4, v208
  v_mov_b32_e32 v206, 0x3f80
  v_lshlrev_b32_e32 v206, v208, v206
  v_lshrrev_b32_e32 v207, 1, v203
  v_cmp_eq_u32_e64 s[82:83], 0, v207
  s_nop 1
  v_cndmask_b32_e64 v208, 0, v206, s[82:83]
  v_accvgpr_write_b32 a252, v208
  v_cmp_eq_u32_e64 s[82:83], 1, v207
  s_nop 1
  v_cndmask_b32_e64 v208, 0, v206, s[82:83]
  v_accvgpr_write_b32 a253, v208
  v_cmp_eq_u32_e64 s[82:83], 2, v207
  s_nop 1
  v_cndmask_b32_e64 v208, 0, v206, s[82:83]
  v_accvgpr_write_b32 a254, v208
  v_cmp_eq_u32_e64 s[82:83], 3, v207
  s_nop 1
  v_cndmask_b32_e64 v208, 0, v206, s[82:83]
  v_accvgpr_write_b32 a255, v208
  v_and_b32_e64 v208, 1, v203
  v_cmp_eq_u32_e64 s[68:69], 0, v208
  v_lshrrev_b32_e64 v207, 2, v203
  v_lshl_add_u32 v207, v207, 4, v203
  v_lshlrev_b32_e32 v210, 2, v207
  v_add_u32_e32 v205, 0, v0
  v_mul_u32_u24_e32 v207, 0xccd, v205
  v_lshrrev_b32_e32 v207, 16, v207
  v_mul_u32_u24_e32 v208, 20, v207
  v_sub_u32_e32 v208, v205, v208
  v_mul_u32_u24_e32 v206, 36, v207
  v_lshrrev_b32_e64 v224, 2, v208
  v_lshl_add_u32 v206, v224, 3, v206
  v_bfe_u32 v205, v208, 1, 1
  v_mul_u32_u24_e32 v205, 18, v205
  v_sub_u32_e32 v205, v207, v205
  v_cmp_gt_u32_e64 s[82:83], 18, v205
  v_and_b32_e64 v220, 1, v208
  v_mul_u32_u24_e32 v220, 0x8000, v220
  v_lshl_add_u32 v220, v220, 16, v220
  s_lshl4_add_u32 m0, s51, s78
  s_nop 0
  buffer_load_dwordx4 v112, s[8:11], s51 offen lds
  buffer_load_dwordx4 v113, s[8:11], s51 offen offset:1024 lds
  v_cndmask_b32_e64 v206, -1, v206, s[82:83]
  v_and_b32_e32 v228, 0x7ffffffc, v206
  v_add_u32_e32 v205, 0x100, v0
  v_mul_u32_u24_e32 v207, 0xccd, v205
  v_lshrrev_b32_e32 v207, 16, v207
  v_mul_u32_u24_e32 v208, 20, v207
  v_sub_u32_e32 v208, v205, v208
  v_mul_u32_u24_e32 v206, 36, v207
  s_lshl4_add_u32 m0, s52, s78
  s_nop 0
  buffer_load_dwordx4 v112, s[8:11], s52 offen lds
  buffer_load_dwordx4 v113, s[8:11], s52 offen offset:1024 lds
  v_lshrrev_b32_e64 v225, 2, v208
  v_lshl_add_u32 v206, v225, 3, v206
  v_bfe_u32 v205, v208, 1, 1
  v_mul_u32_u24_e32 v205, 18, v205
  v_sub_u32_e32 v205, v207, v205
  v_cmp_gt_u32_e64 s[82:83], 18, v205
  v_and_b32_e64 v221, 1, v208
  v_mul_u32_u24_e32 v221, 0x8000, v221
  s_lshl4_add_u32 m0, s53, s78
  s_nop 0
  buffer_load_dwordx4 v112, s[8:11], s53 offen lds
  buffer_load_dwordx4 v113, s[8:11], s53 offen offset:1024 lds
  v_lshl_add_u32 v221, v221, 16, v221
  v_cndmask_b32_e64 v206, -1, v206, s[82:83]
  v_and_b32_e32 v229, 0x7ffffffc, v206
  v_add_u32_e32 v205, 0x200, v0
  v_mul_u32_u24_e32 v207, 0xccd, v205
  v_lshrrev_b32_e32 v207, 16, v207
  v_mul_u32_u24_e32 v208, 20, v207
  v_sub_u32_e64 v208, v205, v208
  s_lshl4_add_u32 m0, s54, s78
  s_nop 0
  buffer_load_dwordx4 v112, s[8:11], s54 offen lds
  buffer_load_dwordx4 v113, s[8:11], s54 offen offset:1024 lds
  v_mul_u32_u24_e32 v206, 36, v207
  v_lshrrev_b32_e32 v226, 2, v208
  v_lshl_add_u32 v206, v226, 3, v206
  v_bfe_u32 v205, v208, 1, 1
  v_mul_u32_u24_e32 v205, 18, v205
  v_sub_u32_e32 v205, v207, v205
  v_cmp_gt_u32_e64 s[82:83], 18, v205
  v_and_b32_e64 v222, 1, v208
  s_lshl4_add_u32 m0, s55, s78
  s_nop 0
  buffer_load_dwordx4 v112, s[8:11], s55 offen lds
  buffer_load_dwordx4 v113, s[8:11], s55 offen offset:1024 lds
  v_mul_u32_u24_e32 v222, 0x8000, v222
  v_lshl_add_u32 v222, v222, 16, v222
  v_cndmask_b32_e64 v206, -1, v206, s[82:83]
  v_and_b32_e32 v230, 0x7ffffffc, v206
  v_add_u32_e32 v205, 0x300, v0
  v_mul_u32_u24_e32 v207, 0xccd, v205
  v_lshrrev_b32_e32 v207, 16, v207
  v_mul_u32_u24_e32 v208, 20, v207
  s_lshl4_add_u32 m0, s56, s78
  s_nop 0
  buffer_load_dwordx4 v112, s[8:11], s56 offen lds
  buffer_load_dwordx4 v113, s[8:11], s56 offen offset:1024 lds
  v_sub_u32_e32 v208, v205, v208
  v_mul_u32_u24_e32 v206, 36, v207
  v_lshrrev_b32_e64 v227, 2, v208
  v_lshl_add_u32 v206, v227, 3, v206
  v_bfe_u32 v205, v208, 1, 1
  v_mul_u32_u24_e32 v205, 18, v205
  v_sub_u32_e32 v205, v207, v205
  v_cmp_gt_u32_e64 s[82:83], 18, v205
  s_lshl4_add_u32 m0, s51, s92
  s_nop 0
  buffer_load_dwordx4 v114, s[8:11], s51 offen lds
  buffer_load_dwordx4 v115, s[8:11], s51 offen offset:1024 lds
  v_and_b32_e64 v223, 1, v208
  v_mul_u32_u24_e32 v223, 0x8000, v223
  v_lshl_add_u32 v223, v223, 16, v223
  v_cndmask_b32_e64 v206, -1, v206, s[82:83]
  v_and_b32_e32 v231, 0x7ffffffc, v206
  s_waitcnt lgkmcnt(0)
  s_add_u32 s99, s79, 1
  s_mul_i32 s74, s99, 0x9e3779b1
  s_lshl4_add_u32 m0, s52, s92
  s_nop 0
  buffer_load_dwordx4 v114, s[8:11], s52 offen lds
  buffer_load_dwordx4 v115, s[8:11], s52 offen offset:1024 lds
  s_xor_b32 s74, s74, 0x5bd1e995
  s_mul_i32 s75, s99, 0x85ebca6b
  s_add_u32 s75, s75, 0xc2b2ae35
  s_mov_b32 s88, 0x30d40
  s_lshl4_add_u32 m0, s53, s92
  s_nop 0
  buffer_load_dwordx4 v114, s[8:11], s53 offen lds
  buffer_load_dwordx4 v115, s[8:11], s53 offen offset:1024 lds
  s_lshl4_add_u32 m0, s54, s92
  s_nop 0
  buffer_load_dwordx4 v114, s[8:11], s54 offen lds
  buffer_load_dwordx4 v115, s[8:11], s54 offen offset:1024 lds
  s_lshl4_add_u32 m0, s55, s92
  s_nop 0
  buffer_load_dwordx4 v114, s[8:11], s55 offen lds
  buffer_load_dwordx4 v115, s[8:11], s55 offen offset:1024 lds
  s_lshl4_add_u32 m0, s56, s92
  s_nop 0
  buffer_load_dwordx4 v114, s[8:11], s56 offen lds
  buffer_load_dwordx4 v115, s[8:11], s56 offen offset:1024 lds
  s_waitcnt vmcnt(12)
  s_nop 0
  ds_read_b128 a[0:3], v116 offset:0
  ds_read_b128 a[4:7], v117 offset:0
  ds_read_b128 a[8:11], v116 offset:2048
  ds_read_b128 a[12:15], v117 offset:2048
  ds_read_b128 a[16:19], v116 offset:4096
  ds_read_b128 a[20:23], v117 offset:4096
  ds_read_b128 a[24:27], v116 offset:6144
  ds_read_b128 a[28:31], v117 offset:6144
  buffer_load_dword v246, v244, s[12:15], s87 offen
  s_add_u32 s87, s87, 0xa2000
  ds_read_b128 a[32:35], v116 offset:8192
  ds_read_b128 a[36:39], v117 offset:8192
  s_waitcnt lgkmcnt(9)
  v_mfma_f32_16x16x32_bf16 v[192:195], a[184:187], a[0:3], 0
  s_mov_b32 s45, 0x1b0000
  s_waitcnt lgkmcnt(8)
  v_mfma_f32_16x16x32_bf16 v[192:195], a[184:187], a[4:7], v[192:195]
  ds_read_b128 a[40:43], v116 offset:10240
  ds_read_b128 a[44:47], v117 offset:10240
  s_waitcnt lgkmcnt(9)
  v_mfma_f32_16x16x32_bf16 v[192:195], a[184:187], a[8:11], v[192:195]
  s_mov_b32 s62, 0xa2000
  s_waitcnt lgkmcnt(8)
  v_mfma_f32_16x16x32_bf16 v[192:195], a[184:187], a[12:15], v[192:195]
  ds_read_b128 a[48:51], v116 offset:12288
  ds_read_b128 a[52:55], v117 offset:12288
  s_waitcnt lgkmcnt(7)
  s_nop 0
  v_mfma_f32_16x16x32_bf16 v[192:195], a[184:187], a[16:19], v[192:195]
  buffer_load_dword v246, v209, s[16:19], s93 offen
  s_mov_b32 s46, 0x1f8000
  v_mfma_f32_16x16x32_bf16 v[192:195], a[184:187], a[20:23], v[192:195]
  ds_read_b128 a[56:59], v116 offset:14336
  ds_read_b128 a[60:63], v117 offset:14336
  v_mfma_f32_16x16x32_bf16 v[192:195], a[184:187], a[24:27], v[192:195]
  s_mov_b32 s63, 0xbd000
  s_waitcnt lgkmcnt(6)
  s_nop 0
  v_mfma_f32_16x16x32_bf16 v[192:195], a[184:187], a[28:31], v[192:195]
  ds_read_b128 a[64:67], v116 offset:16384
  ds_read_b128 a[68:71], v117 offset:16384
  v_mfma_f32_16x16x32_bf16 v[192:195], a[184:187], a[32:35], v[192:195]
  v_mfma_f32_16x16x32_bf16 v[192:195], a[184:187], a[36:39], v[192:195]
  buffer_load_dword v246, v244, s[12:15], s87 offen
  s_add_u32 s87, s87, 0xa2000
  ds_read_b64 a[236:237], v120 offset:0
  ds_read_b64 a[238:239], v121 offset:0
  s_mov_b64 exec, 0xffff
  ds_read_b64 a[244:245], v122 offset:16384
  s_mov_b64 exec, -1
  s_waitcnt lgkmcnt(7)
  v_mfma_f32_16x16x32_bf16 v[192:195], a[184:187], a[40:43], v[192:195]
  v_mfma_f32_16x16x32_bf16 v[192:195], a[184:187], a[44:47], v[192:195]
  v_mfma_f32_16x16x32_bf16 v[192:195], a[184:187], a[48:51], v[192:195]
  v_mfma_f32_16x16x32_bf16 v[192:195], a[184:187], a[52:55], v[192:195]
  s_waitcnt lgkmcnt(4)
  s_nop 0
  v_mfma_f32_16x16x32_bf16 v[192:195], a[184:187], a[56:59], v[192:195]
  v_mfma_f32_16x16x32_bf16 v[192:195], a[184:187], a[60:63], v[192:195]
  buffer_load_dword v246, v244, s[12:15], s87 offen
  s_add_u32 s87, s87, 0xa2000
  v_mfma_f32_16x16x32_bf16 v[192:195], a[184:187], a[64:67], v[192:195]
  s_waitcnt lgkmcnt(0)
  v_mfma_f32_16x16x32_bf16 v[192:195], a[184:187], a[68:71], v[192:195]
  s_barrier
  v_mfma_f32_16x16x32_bf16 v[196:199], a[0:3], a[0:3], 0
  v_mfma_f32_16x16x32_bf16 v[196:199], a[4:7], a[4:7], v[196:199]
  s_nop 4
  s_nop 0
  v_mul_f32_e32 v193, 0xbae38e39, v192
  v_cvt_pk_bf16_f32 v248, 0, v193
  v_min_u32_e32 v123, 0x50c, v247
  buffer_load_dword v246, v123, s[36:39], s96 offen
  v_cvt_pk_bf16_f32 v249, 0, v193
  v_cvt_pk_bf16_f32 v250, 0, v193
  v_cvt_pk_bf16_f32 v251, 0, v193
  v_mul_f32_e32 v193, v193, v193
  s_nop 0
  v_mfma_f32_16x16x32_bf16 v[40:43], a[176:179], a[0:3], v[248:251]
  buffer_load_dword v246, v209, s[16:19], s93 offen offset:128
  v_mfma_f32_16x16x32_bf16 v[44:47], a[180:183], a[0:3], v[248:251]
  v_mfma_f32_16x16x32_bf16 v[48:51], a[176:179], a[4:7], v[248:251]
  v_mfma_f32_16x16x32_bf16 v[52:55], a[180:183], a[4:7], v[248:251]
  v_mfma_f32_16x16x32_bf16 v[196:199], a[8:11], a[8:11], v[196:199]
  s_nop 2
  s_nop 0
  v_cvt_pk_bf16_f32 v40, v40, v41
  v_cvt_pk_bf16_f32 v42, v42, v43
  v_cvt_pk_bf16_f32 v44, v44, v45
  v_cvt_pk_bf16_f32 v46, v46, v47
  v_accvgpr_write_b32 a0, v40
  v_accvgpr_write_b32 a1, v42
  v_accvgpr_write_b32 a2, v44
  v_accvgpr_write_b32 a3, v46
  v_mfma_f32_16x16x32_bf16 v[56:59], a[176:179], a[8:11], v[248:251]
  v_mfma_f32_16x16x32_bf16 v[60:63], a[180:183], a[8:11], v[248:251]
  v_mfma_f32_16x16x32_bf16 v[196:199], a[12:15], a[12:15], v[196:199]
  v_cvt_pk_bf16_f32 v48, v48, v49
  v_cvt_pk_bf16_f32 v50, v50, v51
  v_cvt_pk_bf16_f32 v52, v52, v53
  v_cvt_pk_bf16_f32 v54, v54, v55
  v_accvgpr_write_b32 a4, v48
  v_accvgpr_write_b32 a5, v50
  v_accvgpr_write_b32 a6, v52
  v_accvgpr_write_b32 a7, v54
  v_mfma_f32_16x16x32_bf16 v[40:43], a[176:179], a[12:15], v[248:251]
  v_mfma_f32_16x16x32_bf16 v[44:47], a[180:183], a[12:15], v[248:251]
  v_mfma_f32_16x16x32_bf16 v[196:199], a[16:19], a[16:19], v[196:199]
  v_cvt_pk_bf16_f32 v56, v56, v57
  v_cvt_pk_bf16_f32 v58, v58, v59
  v_cvt_pk_bf16_f32 v60, v60, v61
  v_cvt_pk_bf16_f32 v62, v62, v63
  v_accvgpr_write_b32 a8, v56
  v_accvgpr_write_b32 a9, v58
  v_accvgpr_write_b32 a10, v60
  v_accvgpr_write_b32 a11, v62
  v_mfma_f32_16x16x32_bf16 v[48:51], a[176:179], a[16:19], v[248:251]
  v_mfma_f32_16x16x32_bf16 v[52:55], a[180:183], a[16:19], v[248:251]
  v_mfma_f32_16x16x32_bf16 v[196:199], a[20:23], a[20:23], v[196:199]
  v_cvt_pk_bf16_f32 v40, v40, v41
  v_cvt_pk_bf16_f32 v42, v42, v43
  v_cvt_pk_bf16_f32 v44, v44, v45
  v_cvt_pk_bf16_f32 v46, v46, v47
  v_accvgpr_write_b32 a12, v40
  v_accvgpr_write_b32 a13, v42
  v_accvgpr_write_b32 a14, v44
  v_accvgpr_write_b32 a15, v46
  v_mfma_f32_16x16x32_bf16 v[56:59], a[176:179], a[20:23], v[248:251]
  v_mfma_f32_16x16x32_bf16 v[60:63], a[180:183], a[20:23], v[248:251]
  v_mfma_f32_16x16x32_bf16 v[196:199], a[24:27], a[24:27], v[196:199]
  s_waitcnt vmcnt(6)
  s_nop 0
  ds_read_b128 a[72:75], v118 offset:0
  ds_read_b128 a[76:79], v119 offset:0
  ds_read_b128 a[80:83], v118 offset:2048
  ds_read_b128 a[84:87], v119 offset:2048
  v_cvt_pk_bf16_f32 v48, v48, v49
  v_cvt_pk_bf16_f32 v50, v50, v51
  v_cvt_pk_bf16_f32 v52, v52, v53
  v_cvt_pk_bf16_f32 v54, v54, v55
  v_accvgpr_write_b32 a16, v48
  v_accvgpr_write_b32 a17, v50
  v_accvgpr_write_b32 a18, v52
  v_accvgpr_write_b32 a19, v54
  v_mfma_f32_16x16x32_bf16 v[40:43], a[176:179], a[24:27], v[248:251]
  v_mfma_f32_16x16x32_bf16 v[44:47], a[180:183], a[24:27], v[248:251]
  v_mfma_f32_16x16x32_bf16 v[196:199], a[28:31], a[28:31], v[196:199]
  ds_read_b128 a[88:91], v118 offset:4096
  ds_read_b128 a[92:95], v119 offset:4096
  ds_read_b128 a[96:99], v118 offset:6144
  ds_read_b128 a[100:103], v119 offset:6144
  v_cvt_pk_bf16_f32 v56, v56, v57
  v_cvt_pk_bf16_f32 v58, v58, v59
  s_add_u32 m0, s77, 0x2100
  s_nop 0
  s_nop 0
  buffer_load_dwordx4 v236, s[12:15], s1 offen lds
  v_cvt_pk_bf16_f32 v60, v60, v61
  v_cvt_pk_bf16_f32 v62, v62, v63
  v_accvgpr_write_b32 a20, v56
  v_accvgpr_write_b32 a21, v58
  v_accvgpr_write_b32 a22, v60
  v_accvgpr_write_b32 a23, v62
  v_mfma_f32_16x16x32_bf16 v[48:51], a[176:179], a[28:31], v[248:251]
  v_mfma_f32_16x16x32_bf16 v[52:55], a[180:183], a[28:31], v[248:251]
  v_mfma_f32_16x16x32_bf16 v[196:199], a[32:35], a[32:35], v[196:199]
  ds_read_b128 a[104:107], v118 offset:8192
  ds_read_b128 a[108:111], v119 offset:8192
  ds_read_b128 a[112:115], v118 offset:10240
  ds_read_b128 a[116:119], v119 offset:10240
  v_cvt_pk_bf16_f32 v40, v40, v41
  v_cvt_pk_bf16_f32 v42, v42, v43
  v_cvt_pk_bf16_f32 v44, v44, v45
  v_cvt_pk_bf16_f32 v46, v46, v47
  v_accvgpr_write_b32 a24, v40
  v_accvgpr_write_b32 a25, v42
  v_accvgpr_write_b32 a26, v44
  v_accvgpr_write_b32 a27, v46
  s_add_u32 m0, s77, 0x17a0
  s_nop 0
  buffer_load_dwordx4 v236, s[12:15], s1 offen offset:3456 lds
  s_waitcnt lgkmcnt(4)
  v_mfma_f32_16x16x32_bf16 v[200:203], a[184:187], a[72:75], 0
  v_mfma_f32_16x16x32_bf16 v[200:203], a[184:187], a[76:79], v[200:203]
  v_mfma_f32_16x16x32_bf16 v[56:59], a[176:179], a[32:35], v[248:251]
  v_mfma_f32_16x16x32_bf16 v[60:63], a[180:183], a[32:35], v[248:251]
  v_mfma_f32_16x16x32_bf16 v[196:199], a[36:39], a[36:39], v[196:199]
  ds_read_b128 a[120:123], v118 offset:12288
  ds_read_b128 a[124:127], v119 offset:12288
  ds_read_b128 a[128:131], v118 offset:14336
  ds_read_b128 a[132:135], v119 offset:14336
  v_cvt_pk_bf16_f32 v48, v48, v49
  v_cvt_pk_bf16_f32 v50, v50, v51
  v_cvt_pk_bf16_f32 v52, v52, v53
  v_cvt_pk_bf16_f32 v54, v54, v55
  v_accvgpr_write_b32 a28, v48
  v_accvgpr_write_b32 a29, v50
  v_accvgpr_write_b32 a30, v52
  v_accvgpr_write_b32 a31, v54
  v_mfma_f32_16x16x32_bf16 v[200:203], a[184:187], a[80:83], v[200:203]
  s_add_u32 m0, s76, 0
  s_nop 0
  buffer_load_dwordx4 v237, s[16:19], s0 offen lds
  v_mfma_f32_16x16x32_bf16 v[200:203], a[184:187], a[84:87], v[200:203]
  v_mfma_f32_16x16x32_bf16 v[40:43], a[176:179], a[36:39], v[248:251]
  v_mfma_f32_16x16x32_bf16 v[44:47], a[180:183], a[36:39], v[248:251]
  v_mfma_f32_16x16x32_bf16 v[196:199], a[40:43], a[40:43], v[196:199]
  ds_read_b128 a[136:139], v118 offset:16384
  ds_read_b128 a[140:143], v119 offset:16384
  v_add_u32_e32 v120, 0x12000, v120
  v_add_u32_e32 v121, 0x12000, v121
  v_add_u32_e32 v122, 0x12000, v122
  ds_read_b64 a[240:241], v120 offset:0
  ds_read_b64 a[242:243], v121 offset:0
  s_mov_b64 exec, 0xffff
  ds_read_b64 a[246:247], v122 offset:16384
  s_mov_b64 exec, -1
  s_nop 0
  v_cvt_pk_bf16_f32 v56, v56, v57
  v_cvt_pk_bf16_f32 v58, v58, v59
  v_cvt_pk_bf16_f32 v60, v60, v61
  v_cvt_pk_bf16_f32 v62, v62, v63
  v_accvgpr_write_b32 a32, v56
  v_accvgpr_write_b32 a33, v58
  v_accvgpr_write_b32 a34, v60
  v_accvgpr_write_b32 a35, v62
  s_add_u32 m0, s77, 0x4200
  s_nop 0
  s_nop 0
  buffer_load_dwordx4 v236, s[12:15], s57 offen lds
  v_mfma_f32_16x16x32_bf16 v[200:203], a[184:187], a[88:91], v[200:203]
  v_mfma_f32_16x16x32_bf16 v[200:203], a[184:187], a[92:95], v[200:203]
  v_mfma_f32_16x16x32_bf16 v[48:51], a[176:179], a[40:43], v[248:251]
  v_mfma_f32_16x16x32_bf16 v[52:55], a[180:183], a[40:43], v[248:251]
  v_mfma_f32_16x16x32_bf16 v[196:199], a[44:47], a[44:47], v[196:199]
  v_cvt_pk_bf16_f32 v40, v40, v41
  v_cvt_pk_bf16_f32 v42, v42, v43
  v_cvt_pk_bf16_f32 v44, v44, v45
  v_cvt_pk_bf16_f32 v46, v46, v47
  v_accvgpr_write_b32 a36, v40
  v_accvgpr_write_b32 a37, v42
  v_accvgpr_write_b32 a38, v44
  v_accvgpr_write_b32 a39, v46
  v_mfma_f32_16x16x32_bf16 v[200:203], a[184:187], a[96:99], v[200:203]
  v_mfma_f32_16x16x32_bf16 v[200:203], a[184:187], a[100:103], v[200:203]
  v_mfma_f32_16x16x32_bf16 v[56:59], a[176:179], a[44:47], v[248:251]
  s_add_u32 m0, s77, 0x38a0
  s_nop 0
  s_nop 0
  buffer_load_dwordx4 v236, s[12:15], s57 offen offset:3456 lds
  v_mfma_f32_16x16x32_bf16 v[60:63], a[180:183], a[44:47], v[248:251]
  v_mfma_f32_16x16x32_bf16 v[196:199], a[48:51], a[48:51], v[196:199]
  v_cvt_pk_bf16_f32 v48, v48, v49
  v_cvt_pk_bf16_f32 v50, v50, v51
  v_cvt_pk_bf16_f32 v52, v52, v53
  v_cvt_pk_bf16_f32 v54, v54, v55
  v_accvgpr_write_b32 a40, v48
  v_accvgpr_write_b32 a41, v50
  v_accvgpr_write_b32 a42, v52
  v_accvgpr_write_b32 a43, v54
  s_waitcnt lgkmcnt(0)
  s_nop 0
  v_mfma_f32_16x16x32_bf16 v[200:203], a[184:187], a[104:107], v[200:203]
  v_mfma_f32_16x16x32_bf16 v[200:203], a[184:187], a[108:111], v[200:203]
  v_mfma_f32_16x16x32_bf16 v[40:43], a[176:179], a[48:51], v[248:251]
  v_mfma_f32_16x16x32_bf16 v[44:47], a[180:183], a[48:51], v[248:251]
  v_mfma_f32_16x16x32_bf16 v[196:199], a[52:55], a[52:55], v[196:199]
  v_cvt_pk_bf16_f32 v56, v56, v57
  v_cvt_pk_bf16_f32 v58, v58, v59
  s_add_u32 m0, s76, 0x1080
  s_nop 0
  s_nop 0
  buffer_load_dwordx4 v237, s[16:19], s40 offen lds
  v_cvt_pk_bf16_f32 v60, v60, v61
  v_cvt_pk_bf16_f32 v62, v62, v63
  v_accvgpr_write_b32 a44, v56
  v_accvgpr_write_b32 a45, v58
  v_accvgpr_write_b32 a46, v60
  v_accvgpr_write_b32 a47, v62
  v_mfma_f32_16x16x32_bf16 v[200:203], a[184:187], a[112:115], v[200:203]
  v_mfma_f32_16x16x32_bf16 v[200:203], a[184:187], a[116:119], v[200:203]
  v_mfma_f32_16x16x32_bf16 v[48:51], a[176:179], a[52:55], v[248:251]
  v_mfma_f32_16x16x32_bf16 v[52:55], a[180:183], a[52:55], v[248:251]
  v_mfma_f32_16x16x32_bf16 v[196:199], a[56:59], a[56:59], v[196:199]
  v_cvt_pk_bf16_f32 v40, v40, v41
  v_cvt_pk_bf16_f32 v42, v42, v43
  v_cvt_pk_bf16_f32 v44, v44, v45
  v_cvt_pk_bf16_f32 v46, v46, v47
  v_accvgpr_write_b32 a48, v40
  v_accvgpr_write_b32 a49, v42
  v_accvgpr_write_b32 a50, v44
  v_accvgpr_write_b32 a51, v46
  v_mfma_f32_16x16x32_bf16 v[200:203], a[184:187], a[120:123], v[200:203]
  v_mfma_f32_16x16x32_bf16 v[200:203], a[184:187], a[124:127], v[200:203]
  v_mfma_f32_16x16x32_bf16 v[56:59], a[176:179], a[56:59], v[248:251]
  v_mfma_f32_16x16x32_bf16 v[60:63], a[180:183], a[56:59], v[248:251]
  v_mfma_f32_16x16x32_bf16 v[196:199], a[60:63], a[60:63], v[196:199]
  v_cvt_pk_bf16_f32 v48, v48, v49
  v_cvt_pk_bf16_f32 v50, v50, v51
  v_cvt_pk_bf16_f32 v52, v52, v53
  v_cvt_pk_bf16_f32 v54, v54, v55
  v_accvgpr_write_b32 a52, v48
  v_accvgpr_write_b32 a53, v50
  v_accvgpr_write_b32 a54, v52
  v_accvgpr_write_b32 a55, v54
  v_mfma_f32_16x16x32_bf16 v[200:203], a[184:187], a[128:131], v[200:203]
  v_mfma_f32_16x16x32_bf16 v[200:203], a[184:187], a[132:135], v[200:203]
  v_mfma_f32_16x16x32_bf16 v[40:43], a[176:179], a[60:63], v[248:251]
  s_add_u32 m0, s77, 0x8400
  s_nop 0
  s_nop 0
  buffer_load_dwordx4 v236, s[12:15], s58 offen lds
  v_mfma_f32_16x16x32_bf16 v[44:47], a[180:183], a[60:63], v[248:251]
  v_mfma_f32_16x16x32_bf16 v[196:199], a[64:67], a[64:67], v[196:199]
  v_cvt_pk_bf16_f32 v56, v56, v57
  v_cvt_pk_bf16_f32 v58, v58, v59
  v_cvt_pk_bf16_f32 v60, v60, v61
  v_cvt_pk_bf16_f32 v62, v62, v63
  v_accvgpr_write_b32 a56, v56
  v_accvgpr_write_b32 a57, v58
  v_accvgpr_write_b32 a58, v60
  v_accvgpr_write_b32 a59, v62
  v_mfma_f32_16x16x32_bf16 v[200:203], a[184:187], a[136:139], v[200:203]
  v_mfma_f32_16x16x32_bf16 v[200:203], a[184:187], a[140:143], v[200:203]
  v_mfma_f32_16x16x32_bf16 v[48:51], a[176:179], a[64:67], v[248:251]
  v_mfma_f32_16x16x32_bf16 v[52:55], a[180:183], a[64:67], v[248:251]
  v_mfma_f32_16x16x32_bf16 v[196:199], a[68:71], a[68:71], v[196:199]
  v_cvt_pk_bf16_f32 v40, v40, v41
  v_cvt_pk_bf16_f32 v42, v42, v43
  s_add_u32 m0, s77, 0x7aa0
  s_nop 0
  s_nop 0
  buffer_load_dwordx4 v236, s[12:15], s58 offen offset:3456 lds
  v_cvt_pk_bf16_f32 v44, v44, v45
  v_cvt_pk_bf16_f32 v46, v46, v47
  v_accvgpr_write_b32 a60, v40
  v_accvgpr_write_b32 a61, v42
  v_accvgpr_write_b32 a62, v44
  v_accvgpr_write_b32 a63, v46
  v_mfma_f32_16x16x32_bf16 v[188:191], a[72:75], a[72:75], 0
  v_cndmask_b32_e64 v196, v197, v196, s[68:69]
  v_cndmask_b32_e64 v197, v199, v198, s[68:69]
  v_mfma_f32_16x16x32_bf16 v[188:191], a[76:79], a[76:79], v[188:191]
  v_mul_f32_e32 v201, 0xbae38e39, v200
  v_cvt_pk_bf16_f32 v252, 0, v201
  v_cvt_pk_bf16_f32 v253, 0, v201
  v_cvt_pk_bf16_f32 v254, 0, v201
  v_cvt_pk_bf16_f32 v255, 0, v201
  v_mul_f32_e64 v201, v201, v201
  v_mfma_f32_16x16x32_bf16 v[56:59], a[176:179], a[68:71], v[248:251]
  v_cndmask_b32_e64 v196, v197, v196, s[66:67]
  v_mfma_f32_16x16x32_bf16 v[160:163], a[176:179], a[72:75], v[252:255]
  ds_bpermute_b32 v197, v210, v196
  v_mfma_f32_16x16x32_bf16 v[164:167], a[180:183], a[72:75], v[252:255]
  v_mfma_f32_16x16x32_bf16 v[60:63], a[180:183], a[68:71], v[248:251]
  v_cvt_pk_bf16_f32 v48, v48, v49
  v_cvt_pk_bf16_f32 v50, v50, v51
  v_cvt_pk_bf16_f32 v52, v52, v53
  v_cvt_pk_bf16_f32 v54, v54, v55
  s_add_u32 m0, s76, 0x6300
  s_nop 0
  s_nop 0
  buffer_load_dwordx4 v237, s[16:19], s41 offen lds
  v_accvgpr_write_b32 a64, v48
  v_accvgpr_write_b32 a65, v50
  v_accvgpr_write_b32 a66, v52
  v_accvgpr_write_b32 a67, v54
  v_mfma_f32_16x16x32_bf16 v[168:171], a[176:179], a[76:79], v[252:255]
  v_mfma_f32_16x16x32_bf16 v[188:191], a[80:83], a[80:83], v[188:191]
  v_mfma_f32_16x16x32_bf16 v[188:191], a[84:87], a[84:87], v[188:191]
  v_cvt_pk_bf16_f32 v56, v56, v57
  v_cvt_pk_bf16_f32 v58, v58, v59
  v_cvt_pk_bf16_f32 v60, v60, v61
  v_cvt_pk_bf16_f32 v62, v62, v63
  v_accvgpr_write_b32 a68, v56
  v_accvgpr_write_b32 a69, v58
  v_accvgpr_write_b32 a70, v60
  v_accvgpr_write_b32 a71, v62
  v_mfma_f32_16x16x32_bf16 v[172:175], a[180:183], a[76:79], v[252:255]
  v_cvt_pk_bf16_f32 v4, v168, v169
  v_cvt_pk_bf16_f32 v5, v170, v171
  v_mfma_f32_16x16x32_bf16 v[188:191], a[88:91], a[88:91], v[188:191]
  s_waitcnt lgkmcnt(0)
  v_mul_f32_e32 v197, 0x3ae38e39, v197
  v_mfma_f32_16x16x32_bf16 v[188:191], a[92:95], a[92:95], v[188:191]
  v_sub_f32_e32 v197, v197, v193
  v_max_f32_e64 v197, 0, v197
  v_mfma_f32_16x16x32_bf16 v[188:191], a[96:99], a[96:99], v[188:191]
  v_cvt_pk_bf16_f32 v6, v172, v173
  v_cvt_pk_bf16_f32 v7, v174, v175
  v_mfma_f32_16x16x32_bf16 v[188:191], a[100:103], a[100:103], v[188:191]
  s_add_u32 m0, s77, 0xa500
  s_nop 0
  s_nop 0
  buffer_load_dwordx4 v236, s[12:15], s59 offen lds
  v_mfma_f32_16x16x32_bf16 v[188:191], a[104:107], a[104:107], v[188:191]
  v_cvt_pk_bf16_f32 v197, 0, v197
  v_add_f32_e32 v197, 0x3727c5ac, v197
  v_mfma_f32_16x16x32_bf16 v[188:191], a[108:111], a[108:111], v[188:191]
  v_cvt_pk_bf16_f32 v197, 0, v197
  v_mfma_f32_16x16x32_bf16 v[188:191], a[112:115], a[112:115], v[188:191]
  v_sqrt_f32_e64 v197, v197
  v_mfma_f32_16x16x32_bf16 v[188:191], a[116:119], a[116:119], v[188:191]
  v_cvt_pk_bf16_f32 v197, 0, v197
  v_mfma_f32_16x16x32_bf16 v[188:191], a[120:123], a[120:123], v[188:191]
  v_rcp_f32_e64 v198, v197
  v_mfma_f32_16x16x32_bf16 v[188:191], a[124:127], a[124:127], v[188:191]
  v_accvgpr_write_b32 a184, v197
  v_mul_f32_e32 v242, 0x3fb8aa3b, v198
  v_mfma_f32_16x16x32_bf16 v[188:191], a[128:131], a[128:131], v[188:191]
  v_accvgpr_write_b32 a186, v198
  v_mfma_f32_16x16x32_bf16 v[188:191], a[132:135], a[132:135], v[188:191]
  v_mfma_f32_16x16x32_bf16 v[188:191], a[136:139], a[136:139], v[188:191]
  v_mfma_f32_16x16x32_bf16 v[188:191], a[140:143], a[140:143], v[188:191]
  s_mov_b32 s78, 0x4800
  v_lshlrev_b32_e64 v239, 3, v0
  v_add_u32_e32 v239, 0x1ef00, v239
  v_min_u32_e64 v241, 59, v0
  s_add_u32 m0, s77, 0x9ba0
  s_nop 0
  buffer_load_dwordx4 v236, s[12:15], s59 offen offset:3456 lds
  v_lshlrev_b32_e32 v241, 3, v241
  v_add_u32_e32 v241, 0x27d40, v241
  s_waitcnt vmcnt(5)
  s_barrier
  ds_read_b64_tr_b16 a[144:145], v234 offset:80
  ds_read_b64_tr_b16 a[146:147], v234 offset:336
  ds_read_b64_tr_b16 a[148:149], v234 offset:112
  s_add_u32 m0, s77, 0xe700
  s_nop 0
  s_nop 0
  buffer_load_dwordx4 v236, s[12:15], s60 offen lds
  ds_read_b64_tr_b16 a[150:151], v234 offset:368
  ds_read_b64_tr_b16 a[152:153], v235 offset:0
  ds_read_b64_tr_b16 a[154:155], v235 offset:256
  ds_read_b64_tr_b16 a[156:157], v234 offset:160
  ds_read_b64_tr_b16 a[158:159], v234 offset:416
  ds_read_b64_tr_b16 a[160:161], v234 offset:192
  s_add_u32 m0, s77, 0xdda0
  s_nop 0
  s_nop 0
  buffer_load_dwordx4 v236, s[12:15], s60 offen offset:3456 lds
  ds_read_b64_tr_b16 a[162:163], v234 offset:448
  ds_read_b64_tr_b16 a[164:165], v234 offset:0
  ds_read_b64_tr_b16 a[166:167], v234 offset:256
  ds_read_b64_tr_b16 a[168:169], v234 offset:32
  ds_read_b64_tr_b16 a[170:171], v234 offset:288
  ds_read_b64_tr_b16 a[172:173], v233 offset:0
  s_add_u32 m0, s76, 0xc600
  s_nop 0
  s_nop 0
  buffer_load_dwordx4 v237, s[16:19], s43 offen lds
  ds_read_b64_tr_b16 a[174:175], v233 offset:256
  ds_read_b64_tr_b16 a[220:221], v233 offset:32
  ds_read_b64_tr_b16 a[222:223], v233 offset:288
  ds_read_b64_tr_b16 a[224:225], v233 offset:64
  ds_read_b64_tr_b16 a[226:227], v233 offset:320
  ds_read_b64_tr_b16 a[228:229], v233 offset:96
  s_add_u32 m0, s76, 0x7380
  s_nop 0
  buffer_load_dwordx4 v237, s[16:19], s42 offen lds
  s_waitcnt lgkmcnt(15)
  v_mfma_f32_16x16x32_bf16 v[88:91], a[144:147], a[0:3], 0
  ds_read_b64_tr_b16 a[230:231], v233 offset:352
  buffer_load_dwordx2 v[212:213], v228, s[36:39], s96 offen
  v_cvt_pk_bf16_f32 v0, v160, v161
  v_cvt_pk_bf16_f32 v1, v162, v163
  v_cvt_pk_bf16_f32 v2, v164, v165
  v_cvt_pk_bf16_f32 v3, v166, v167
  s_nop 1
  s_nop 0
  v_mfma_f32_16x16x32_bf16 v[92:95], a[144:147], v[0:3], 0
  ds_read_b64_tr_b16 a[232:233], v234 offset:8528
  s_add_u32 m0, s77, 0x10800
  v_mfma_f32_16x16x32_bf16 v[176:179], a[176:179], a[80:83], v[252:255]
  buffer_load_dwordx2 v[214:215], v229, s[36:39], s96 offen
  buffer_load_dwordx2 v[216:217], v230, s[36:39], s96 offen
  v_mfma_f32_16x16x32_bf16 v[180:183], a[180:183], a[80:83], v[252:255]
  buffer_load_dwordx2 v[218:219], v231, s[36:39], s96 offen
  v_cmp_gt_u32_e64 s[82:83], 4, v224
  v_mfma_f32_16x16x32_bf16 v[160:163], a[176:179], a[84:87], v[252:255]
  v_cndmask_b32_e64 v188, v189, v188, s[68:69]
  v_mfma_f32_16x16x32_bf16 v[164:167], a[180:183], a[84:87], v[252:255]
  v_cvt_pk_bf16_f32 v8, v176, v177
  v_cvt_pk_bf16_f32 v9, v178, v179
  v_mfma_f32_16x16x32_bf16 v[96:99], a[148:151], a[0:3], 0
  buffer_load_dwordx4 v236, s[12:15], s61 offen lds
  ds_read_b64_tr_b16 a[234:235], v234 offset:8784
  v_mfma_f32_16x16x32_bf16 v[100:103], a[148:151], v[0:3], 0
  ds_read_b64_tr_b16 a[144:145], v234 offset:8560
  v_cvt_pk_bf16_f32 v10, v180, v181
  v_mfma_f32_16x16x32_bf16 v[104:107], a[152:155], a[0:3], 0
  ds_read_b64_tr_b16 a[146:147], v234 offset:8816
  v_cvt_pk_bf16_f32 v11, v182, v183
  v_mfma_f32_16x16x32_bf16 v[168:171], a[176:179], a[88:91], v[252:255]
  v_cvt_pk_bf16_f32 v12, v160, v161
  v_mfma_f32_16x16x32_bf16 v[172:175], a[180:183], a[88:91], v[252:255]
  v_cvt_pk_bf16_f32 v13, v162, v163
  v_cvt_pk_bf16_f32 v14, v164, v165
  v_mfma_f32_16x16x32_bf16 v[108:111], a[152:155], v[0:3], 0
  ds_read_b64_tr_b16 a[148:149], v235 offset:8448
  s_waitcnt lgkmcnt(4)
  s_nop 0
  v_mfma_f32_16x16x32_bf16 v[112:115], a[156:159], a[0:3], 0
  ds_read_b64_tr_b16 a[150:151], v235 offset:8704
  v_cvt_pk_bf16_f32 v16, v168, v169
  v_mfma_f32_16x16x32_bf16 v[116:119], a[156:159], v[0:3], 0
  ds_read_b64_tr_b16 a[152:153], v234 offset:8608
  s_add_u32 m0, s77, 0xfea0
  v_mfma_f32_16x16x32_bf16 v[120:123], a[160:163], a[0:3], 0
  buffer_load_dwordx4 v236, s[12:15], s61 offen offset:3456 lds
  ds_read_b64_tr_b16 a[154:155], v234 offset:8864
  v_mfma_f32_16x16x32_bf16 v[124:127], a[160:163], v[0:3], 0
  global_load_dwordx4 a[188:191], v204, s[94:95] offset:-4096
  ds_read_b64_tr_b16 a[156:157], v234 offset:8640
  v_mfma_f32_16x16x32_bf16 v[72:75], a[164:167], a[0:3], 0
  ds_read_b64_tr_b16 a[158:159], v234 offset:8896
  v_cvt_pk_bf16_f32 v17, v170, v171
  v_mfma_f32_16x16x32_bf16 v[76:79], a[164:167], v[0:3], 0
  ds_read_b64_tr_b16 a[160:161], v234 offset:8448
  v_cvt_pk_bf16_f32 v18, v172, v173
  v_mfma_f32_16x16x32_bf16 v[80:83], a[168:171], a[0:3], 0
  ds_read_b64_tr_b16 a[162:163], v234 offset:8704
  v_cvt_pk_bf16_f32 v19, v174, v175
  v_mfma_f32_16x16x32_bf16 v[160:163], a[176:179], a[96:99], v[252:255]
  v_cvt_pk_bf16_f32 v15, v166, v167
  v_mfma_f32_16x16x32_bf16 v[164:167], a[180:183], a[96:99], v[252:255]
  v_cndmask_b32_e64 v189, v191, v190, s[68:69]
  v_mfma_f32_16x16x32_bf16 v[176:179], a[176:179], a[92:95], v[252:255]
  v_cndmask_b32_e64 v188, v189, v188, s[66:67]
  v_mfma_f32_16x16x32_bf16 v[180:183], a[180:183], a[92:95], v[252:255]
  ds_bpermute_b32 v189, v210, v188
  v_mfma_f32_16x16x32_bf16 v[84:87], a[168:171], v[0:3], 0
  ds_read_b64_tr_b16 a[164:165], v234 offset:8480
  s_add_u32 m0, s76, 0xd680
  v_mfma_f32_16x16x32_bf16 v[128:131], a[172:175], a[0:3], 0
  buffer_load_dwordx4 v237, s[16:19], s44 offen lds
  ds_read_b64_tr_b16 a[166:167], v234 offset:8736
  v_mfma_f32_16x16x32_bf16 v[136:139], a[172:175], v[0:3], 0
  ds_read_b64_tr_b16 a[168:169], v233 offset:4224
  v_cvt_pk_bf16_f32 v24, v160, v161
  v_mfma_f32_16x16x32_bf16 v[132:135], a[220:223], a[0:3], 0
  ds_read_b64_tr_b16 a[170:171], v233 offset:4480
  v_cvt_pk_bf16_f32 v25, v162, v163
  v_mfma_f32_16x16x32_bf16 v[140:143], a[220:223], v[0:3], 0
  ds_read_b64_tr_b16 a[172:173], v233 offset:4256
  v_cvt_pk_bf16_f32 v26, v164, v165
  v_mfma_f32_16x16x32_bf16 v[144:147], a[224:227], a[0:3], 0
  global_load_dwordx4 a[192:195], v204, s[94:95] offset:-3072
  ds_read_b64_tr_b16 a[174:175], v233 offset:4512
  v_mfma_f32_16x16x32_bf16 v[152:155], a[224:227], v[0:3], 0
  ds_read_b64_tr_b16 a[220:221], v233 offset:4288
  v_cvt_pk_bf16_f32 v27, v166, v167
  v_mfma_f32_16x16x32_bf16 v[148:151], a[228:231], a[0:3], 0
  ds_read_b64_tr_b16 a[222:223], v233 offset:4544
  v_cvt_pk_bf16_f32 v20, v176, v177
  v_mfma_f32_16x16x32_bf16 v[156:159], a[228:231], v[0:3], 0
  ds_read_b64_tr_b16 a[224:225], v233 offset:4320
  s_waitcnt lgkmcnt(7)
  s_nop 0
  v_mfma_f32_16x16x32_bf16 v[88:91], a[232:235], a[4:7], v[88:91]
  ds_read_b64_tr_b16 a[226:227], v233 offset:4576
  v_cvt_pk_bf16_f32 v21, v178, v179
  v_mfma_f32_16x16x32_bf16 v[176:179], a[176:179], a[104:107], v[252:255]
  v_cvt_pk_bf16_f32 v22, v180, v181
  v_cvt_pk_bf16_f32 v23, v182, v183
  v_mfma_f32_16x16x32_bf16 v[180:183], a[180:183], a[104:107], v[252:255]
  v_mul_f32_e32 v189, 0x3ae38e39, v189
  v_mfma_f32_16x16x32_bf16 v[168:171], a[176:179], a[100:103], v[252:255]
  v_sub_f32_e64 v189, v189, v201
  v_mfma_f32_16x16x32_bf16 v[172:175], a[180:183], a[100:103], v[252:255]
  v_max_f32_e64 v189, 0, v189
  v_cvt_pk_bf16_f32 v32, v176, v177
  v_mfma_f32_16x16x32_bf16 v[92:95], a[232:235], v[4:7], v[92:95]
  global_load_dwordx4 a[196:199], v204, s[94:95] offset:-2048
  global_load_dwordx4 a[200:203], v204, s[94:95] offset:-1024
  global_load_dwordx4 a[204:207], v204, s[94:95] offset:0
  global_load_dwordx4 a[208:211], v204, s[94:95] offset:1024
  global_load_dwordx4 a[212:215], v204, s[94:95] offset:2048
  global_load_dwordx4 a[216:219], v204, s[94:95] offset:3072
  s_waitcnt vmcnt(15)
  s_barrier
  v_add_u32_e32 v233, 0x6300, v233
  v_add_u32_e32 v234, 0x6300, v234
  v_add_u32_e32 v235, 0x6300, v235
  ds_read_b64_tr_b16 a[228:229], v234 offset:80
  v_mfma_f32_16x16x32_bf16 v[96:99], a[144:147], a[4:7], v[96:99]
  ds_read_b64_tr_b16 a[230:231], v234 offset:336
  v_cvt_pk_bf16_f32 v33, v178, v179
  v_mfma_f32_16x16x32_bf16 v[100:103], a[144:147], v[4:7], v[100:103]
  ds_read_b64_tr_b16 a[232:233], v234 offset:112
  s_add_u32 m0, s77, 0x14a00
  v_mfma_f32_16x16x32_bf16 v[104:107], a[148:151], a[4:7], v[104:107]
  buffer_load_dwordx4 v236, s[12:15], s62 offen lds
  ds_read_b64_tr_b16 a[234:235], v234 offset:368
  v_mfma_f32_16x16x32_bf16 v[108:111], a[148:151], v[4:7], v[108:111]
  ds_read_b64_tr_b16 a[144:145], v235 offset:0
  v_cvt_pk_bf16_f32 v34, v180, v181
  v_mfma_f32_16x16x32_bf16 v[112:115], a[152:155], a[4:7], v[112:115]
  ds_read_b64_tr_b16 a[146:147], v235 offset:256
  v_cvt_pk_bf16_f32 v35, v182, v183
  v_mfma_f32_16x16x32_bf16 v[116:119], a[152:155], v[4:7], v[116:119]
  ds_read_b64_tr_b16 a[148:149], v234 offset:160
  v_cvt_pk_bf16_f32 v28, v168, v169
  v_mfma_f32_16x16x32_bf16 v[120:123], a[156:159], a[4:7], v[120:123]
  ds_read_b64_tr_b16 a[150:151], v234 offset:416
  v_cvt_pk_bf16_f32 v29, v170, v171
  v_mfma_f32_16x16x32_bf16 v[168:171], a[176:179], a[112:115], v[252:255]
  v_cvt_pk_bf16_f32 v30, v172, v173
  v_cvt_pk_bf16_f32 v31, v174, v175
  v_mfma_f32_16x16x32_bf16 v[172:175], a[180:183], a[112:115], v[252:255]
  v_cvt_pk_bf16_f32 v189, 0, v189
  v_mfma_f32_16x16x32_bf16 v[160:163], a[176:179], a[108:111], v[252:255]
  v_add_f32_e32 v189, 0x3727c5ac, v189
  v_mfma_f32_16x16x32_bf16 v[164:167], a[180:183], a[108:111], v[252:255]
  v_cvt_pk_bf16_f32 v189, 0, v189
  v_cvt_pk_bf16_f32 v40, v168, v169
  v_mfma_f32_16x16x32_bf16 v[124:127], a[156:159], v[4:7], v[124:127]
  ds_read_b64_tr_b16 a[152:153], v234 offset:192
  s_add_u32 m0, s77, 0x140a0
  s_lshr_b32 s84, s4, 1
  s_nop 0
  v_mfma_f32_16x16x32_bf16 v[72:75], a[160:163], a[4:7], v[72:75]
  buffer_load_dwordx4 v236, s[12:15], s62 offen offset:3456 lds
  ds_read_b64_tr_b16 a[154:155], v234 offset:448
  v_mfma_f32_16x16x32_bf16 v[76:79], a[160:163], v[4:7], v[76:79]
  ds_read_b64_tr_b16 a[156:157], v234 offset:0
  v_cvt_pk_bf16_f32 v41, v170, v171
  v_mfma_f32_16x16x32_bf16 v[80:83], a[164:167], a[4:7], v[80:83]
  ds_read_b64_tr_b16 a[158:159], v234 offset:256
  v_cvt_pk_bf16_f32 v42, v172, v173
  v_mfma_f32_16x16x32_bf16 v[84:87], a[164:167], v[4:7], v[84:87]
  ds_read_b64_tr_b16 a[160:161], v234 offset:32
  s_waitcnt lgkmcnt(5)
  s_nop 0
  v_mfma_f32_16x16x32_bf16 v[128:131], a[168:171], a[4:7], v[128:131]
  ds_read_b64_tr_b16 a[162:163], v234 offset:288
  v_cvt_pk_bf16_f32 v43, v174, v175
  v_mfma_f32_16x16x32_bf16 v[136:139], a[168:171], v[4:7], v[136:139]
  ds_read_b64_tr_b16 a[164:165], v233 offset:0
  s_add_u32 m0, s76, 0x12900
  v_mfma_f32_16x16x32_bf16 v[132:135], a[172:175], a[4:7], v[132:135]
  buffer_load_dwordx4 v237, s[16:19], s45 offen lds
  ds_read_b64_tr_b16 a[166:167], v233 offset:256
  v_mfma_f32_16x16x32_bf16 v[140:143], a[172:175], v[4:7], v[140:143]
  ds_read_b64_tr_b16 a[168:169], v233 offset:32
  v_cvt_pk_bf16_f32 v36, v160, v161
  v_mfma_f32_16x16x32_bf16 v[144:147], a[220:223], a[4:7], v[144:147]
  ds_read_b64_tr_b16 a[170:171], v233 offset:288
  v_cvt_pk_bf16_f32 v37, v162, v163
  v_mfma_f32_16x16x32_bf16 v[160:163], a[176:179], a[120:123], v[252:255]
  s_waitcnt vmcnt(17)
  v_xor_b32_e32 v212, v220, v212
  v_mfma_f32_16x16x32_bf16 v[152:155], a[220:223], v[4:7], v[152:155]
  ds_read_b64_tr_b16 a[172:173], v233 offset:64
  v_xor_b32_e64 v213, v220, v213
  v_mfma_f32_16x16x32_bf16 v[148:151], a[224:227], a[4:7], v[148:151]
  ds_read_b64_tr_b16 a[174:175], v233 offset:320
  v_cndmask_b32_e64 v213, 0, v213, s[82:83]
  v_mfma_f32_16x16x32_bf16 v[156:159], a[224:227], v[4:7], v[156:159]
  ds_read_b64_tr_b16 a[220:221], v233 offset:96
  ds_write_b64 v239, v[212:213] offset:0
  v_mfma_f32_16x16x32_bf16 v[88:91], a[228:231], a[8:11], v[88:91]
  ds_read_b64_tr_b16 a[222:223], v233 offset:352
  v_cmp_gt_u32_e64 s[82:83], 4, v225
  v_mfma_f32_16x16x32_bf16 v[92:95], a[228:231], v[8:11], v[92:95]
  ds_read_b64_tr_b16 a[224:225], v234 offset:8528
  s_add_u32 m0, s77, 0x16b00
  v_mfma_f32_16x16x32_bf16 v[96:99], a[232:235], a[8:11], v[96:99]
  buffer_load_dwordx4 v236, s[12:15], s63 offen lds
  ds_read_b64_tr_b16 a[226:227], v234 offset:8784
  v_mfma_f32_16x16x32_bf16 v[100:103], a[232:235], v[8:11], v[100:103]
  ds_read_b64_tr_b16 a[228:229], v234 offset:8560
  v_cvt_pk_bf16_f32 v38, v164, v165
  v_mfma_f32_16x16x32_bf16 v[104:107], a[144:147], a[8:11], v[104:107]
  ds_read_b64_tr_b16 a[230:231], v234 offset:8816
  v_cvt_pk_bf16_f32 v39, v166, v167
  v_mfma_f32_16x16x32_bf16 v[164:167], a[180:183], a[120:123], v[252:255]
  s_waitcnt vmcnt(17)
  v_xor_b32_e32 v214, v221, v214
  s_waitcnt vmcnt(12)
  v_accvgpr_read_b32 v184, a188
  v_accvgpr_read_b32 v185, a189
  v_mfma_f32_16x16x32_bf16 v[176:179], a[176:179], a[116:119], v[252:255]
  s_lshl_b32 s97, s4, 4
  s_add_u32 s97, s97, s5
  s_lshl_b32 s98, s97, 13
  s_add_u32 s98, s98, 0x80000
  buffer_store_dwordx4 a[248:251], v184, s[32:35], s98 offen sc1
  v_mfma_f32_16x16x32_bf16 v[180:183], a[180:183], a[116:119], v[252:255]
  buffer_store_dwordx4 a[248:251], v184, s[32:35], s98 offen offset:64 sc1
  buffer_store_dwordx4 a[248:251], v184, s[32:35], s98 offen offset:128 sc1
  s_lshl2_add_u32 s98, s5, s3
  s_min_u32 s98, s98, 56
  s_lshl_b32 s98, s98, 6
  v_mfma_f32_16x16x32_bf16 v[108:111], a[144:147], v[8:11], v[108:111]
  ds_read_b64_tr_b16 a[232:233], v235 offset:8448
  s_lshl_b32 s92, s4, 12
  s_add_u32 s98, s98, s92
  s_nop 0
  s_add_u32 s98, s98, 0x60000
  buffer_store_dword a248, v185, s[32:35], s98 offen sc1
  v_mfma_f32_16x16x32_bf16 v[112:115], a[148:151], a[8:11], v[112:115]
  ds_read_b64_tr_b16 a[234:235], v235 offset:8704
  v_accvgpr_read_b32 v185, a190
  s_lshl_b32 s97, s97, 2
  s_add_u32 s97, s97, s3
  s_lshl_b32 s97, s97, 3
  s_nop 0
  v_mfma_f32_16x16x32_bf16 v[116:119], a[148:151], v[8:11], v[116:119]
  ds_read_b64_tr_b16 a[144:145], v234 offset:8608
  s_add_u32 m0, s77, 0x161a0
  s_add_u32 s97, s97, 0x1000
  v_mov_b32_e32 v248, s74
  s_waitcnt lgkmcnt(3)
  v_mfma_f32_16x16x32_bf16 v[120:123], a[152:155], a[8:11], v[120:123]
  buffer_load_dwordx4 v236, s[12:15], s63 offen offset:3456 lds
  ds_read_b64_tr_b16 a[146:147], v234 offset:8864
  v_mov_b32_e64 v249, s75
  v_mfma_f32_16x16x32_bf16 v[124:127], a[152:155], v[8:11], v[124:127]
  ds_read_b64_tr_b16 a[148:149], v234 offset:8640
  v_accvgpr_read_b32 v251, a191
  s_xor_b32 s38, s6, 1
  v_mfma_f32_16x16x32_bf16 v[72:75], a[156:159], a[8:11], v[72:75]
  ds_read_b64_tr_b16 a[150:151], v234 offset:8896
  s_lshl_b32 s96, s5, 16
  s_lshl_b32 s37, s3, 12
  v_mfma_f32_16x16x32_bf16 v[76:79], a[156:159], v[8:11], v[76:79]
  ds_read_b64_tr_b16 a[152:153], v234 offset:8448
  s_add_u32 s96, s96, s37
  s_add_u32 s96, s96, 0x4000000
  v_mfma_f32_16x16x32_bf16 v[80:83], a[160:163], a[8:11], v[80:83]
  ds_read_b64_tr_b16 a[154:155], v234 offset:8704
  s_lshr_b32 s37, s4, 2
  s_lshl_b32 s37, s37, 20
  v_mfma_f32_16x16x32_bf16 v[84:87], a[160:163], v[8:11], v[84:87]
  ds_read_b64_tr_b16 a[156:157], v234 offset:8480
  s_add_u32 m0, s76, 0x13980
  s_add_u32 s96, s96, s37
  v_mfma_f32_16x16x32_bf16 v[128:131], a[164:167], a[8:11], v[128:131]
  buffer_load_dwordx4 v237, s[16:19], s46 offen lds
  ds_read_b64_tr_b16 a[158:159], v234 offset:8736
  s_and_b32 s37, s4, 3
  v_mfma_f32_16x16x32_bf16 v[136:139], a[164:167], v[8:11], v[136:139]
  ds_read_b64_tr_b16 a[160:161], v233 offset:4224
  s_xor_b32 s37, s37, 1
  s_lshl_b32 s37, s37, 14
  v_mfma_f32_16x16x32_bf16 v[132:135], a[168:171], a[8:11], v[132:135]
  ds_read_b64_tr_b16 a[162:163], v233 offset:4480
  s_add_u32 s96, s96, s37
  s_lshl_b32 s37, s6, 11
  v_mfma_f32_16x16x32_bf16 v[140:143], a[168:171], v[8:11], v[140:143]
  ds_read_b64_tr_b16 a[164:165], v233 offset:4256
  s_add_u32 s96, s96, s37
  v_mfma_f32_16x16x32_bf16 v[144:147], a[172:175], a[8:11], v[144:147]
  ds_read_b64_tr_b16 a[166:167], v233 offset:4512
  v_xor_b32_e32 v215, v221, v215
  v_mfma_f32_16x16x32_bf16 v[152:155], a[172:175], v[8:11], v[152:155]
  ds_read_b64_tr_b16 a[168:169], v233 offset:4288
  v_cndmask_b32_e64 v215, 0, v215, s[82:83]
  v_mfma_f32_16x16x32_bf16 v[148:151], a[220:223], a[8:11], v[148:151]
  ds_read_b64_tr_b16 a[170:171], v233 offset:4544
  ds_write_b64 v239, v[214:215] offset:2048
  v_mfma_f32_16x16x32_bf16 v[156:159], a[220:223], v[8:11], v[156:159]
  ds_read_b64_tr_b16 a[172:173], v233 offset:4320
  v_cmp_gt_u32_e64 s[82:83], 4, v226
  v_mfma_f32_16x16x32_bf16 v[88:91], a[224:227], a[12:15], v[88:91]
  ds_read_b64_tr_b16 a[174:175], v233 offset:4576
  v_xor_b32_e64 v216, v222, v216
  v_mfma_f32_16x16x32_bf16 v[92:95], a[224:227], v[12:15], v[92:95]
  v_xor_b32_e64 v217, v222, v217
  v_cndmask_b32_e64 v217, 0, v217, s[82:83]
  s_waitcnt vmcnt(17)
  s_barrier
  v_add_u32_e32 v233, 0x6300, v233
  v_add_u32_e32 v234, 0x6300, v234
  v_add_u32_e32 v235, 0x6300, v235
  ds_read_b64_tr_b16 a[220:221], v234 offset:80
  v_mfma_f32_16x16x32_bf16 v[96:99], a[228:231], a[12:15], v[96:99]
  ds_read_b64_tr_b16 a[222:223], v234 offset:336
  ds_write_b64 v239, v[216:217] offset:4096
  v_mfma_f32_16x16x32_bf16 v[100:103], a[228:231], v[12:15], v[100:103]
  ds_read_b64_tr_b16 a[224:225], v234 offset:112
  s_add_u32 m0, s77, 0x1ad00
  s_waitcnt lgkmcnt(7)
  s_nop 0
  v_mfma_f32_16x16x32_bf16 v[104:107], a[232:235], a[12:15], v[104:107]
  s_mov_b32 s47, 0x240000
  s_mov_b32 s64, 0xd8000
  buffer_load_dwordx4 v236, s[12:15], s64 offen lds
  ds_read_b64_tr_b16 a[226:227], v234 offset:368
  v_mfma_f32_16x16x32_bf16 v[108:111], a[232:235], v[12:15], v[108:111]
  ds_read_b64_tr_b16 a[228:229], v235 offset:0
  v_cmp_gt_u32_e64 s[82:83], 4, v227
  v_mfma_f32_16x16x32_bf16 v[112:115], a[144:147], a[12:15], v[112:115]
  ds_read_b64_tr_b16 a[230:231], v235 offset:256
  v_xor_b32_e64 v218, v223, v218
  v_mfma_f32_16x16x32_bf16 v[116:119], a[144:147], v[12:15], v[116:119]
  ds_read_b64_tr_b16 a[232:233], v234 offset:160
  v_xor_b32_e64 v219, v223, v219
  v_mfma_f32_16x16x32_bf16 v[120:123], a[148:151], a[12:15], v[120:123]
  ds_read_b64_tr_b16 a[234:235], v234 offset:416
  v_cndmask_b32_e64 v219, 0, v219, s[82:83]
  v_mfma_f32_16x16x32_bf16 v[124:127], a[148:151], v[12:15], v[124:127]
  ds_read_b64_tr_b16 a[144:145], v234 offset:192
  s_add_u32 m0, s77, 0x1a3a0
  v_mfma_f32_16x16x32_bf16 v[72:75], a[152:155], a[12:15], v[72:75]
  buffer_load_dwordx4 v236, s[12:15], s64 offen offset:3456 lds
  ds_read_b64_tr_b16 a[146:147], v234 offset:448
  v_mfma_f32_16x16x32_bf16 v[76:79], a[152:155], v[12:15], v[76:79]
  ds_read_b64_tr_b16 a[148:149], v234 offset:0
  ds_write_b64 v239, v[218:219] offset:6144
  v_mfma_f32_16x16x32_bf16 v[80:83], a[156:159], a[12:15], v[80:83]
  ds_read_b64_tr_b16 a[150:151], v234 offset:256
  v_mov_b32_e64 v214, 0
  v_mfma_f32_16x16x32_bf16 v[84:87], a[156:159], v[12:15], v[84:87]
  ds_read_b64_tr_b16 a[152:153], v234 offset:32
  v_mov_b32_e64 v215, 0
  v_mfma_f32_16x16x32_bf16 v[128:131], a[160:163], a[12:15], v[128:131]
  ds_read_b64_tr_b16 a[154:155], v234 offset:288
  ds_write_b64 v241, v[214:215] offset:0
  v_mfma_f32_16x16x32_bf16 v[136:139], a[160:163], v[12:15], v[136:139]
  ds_read_b64_tr_b16 a[156:157], v233 offset:0
  s_add_u32 m0, s76, 0x18c00
  v_mfma_f32_16x16x32_bf16 v[132:135], a[164:167], a[12:15], v[132:135]
  buffer_load_dwordx4 v237, s[16:19], s47 offen lds
  ds_read_b64_tr_b16 a[158:159], v233 offset:256
  v_mfma_f32_16x16x32_bf16 v[140:143], a[164:167], v[12:15], v[140:143]
  ds_read_b64_tr_b16 a[160:161], v233 offset:32
  v_cvt_pk_bf16_f32 v48, v160, v161
  v_mfma_f32_16x16x32_bf16 v[144:147], a[168:171], a[12:15], v[144:147]
  ds_read_b64_tr_b16 a[162:163], v233 offset:288
  v_cvt_pk_bf16_f32 v49, v162, v163
  v_mfma_f32_16x16x32_bf16 v[152:155], a[168:171], v[12:15], v[152:155]
  ds_read_b64_tr_b16 a[164:165], v233 offset:64
  s_waitcnt lgkmcnt(8)
  s_nop 0
  v_mfma_f32_16x16x32_bf16 v[148:151], a[172:175], a[12:15], v[148:151]
  ds_read_b64_tr_b16 a[166:167], v233 offset:320
  v_cvt_pk_bf16_f32 v50, v164, v165
  v_mfma_f32_16x16x32_bf16 v[156:159], a[172:175], v[12:15], v[156:159]
  ds_read_b64_tr_b16 a[168:169], v233 offset:96
  v_cvt_pk_bf16_f32 v51, v166, v167
  v_mfma_f32_16x16x32_bf16 v[88:91], a[220:223], a[16:19], v[88:91]
  ds_read_b64_tr_b16 a[170:171], v233 offset:352
  v_cvt_pk_bf16_f32 v44, v176, v177
  v_mfma_f32_16x16x32_bf16 v[92:95], a[220:223], v[16:19], v[92:95]
  ds_read_b64_tr_b16 a[172:173], v234 offset:8528
  s_add_u32 m0, s77, 0x1ce00
  v_mfma_f32_16x16x32_bf16 v[96:99], a[224:227], a[16:19], v[96:99]
  s_mov_b32 s48, 0x288000
  s_mov_b32 s65, 0xf3000
  buffer_load_dwordx4 v236, s[12:15], s65 offen lds
  ds_read_b64_tr_b16 a[174:175], v234 offset:8784
  v_mfma_f32_16x16x32_bf16 v[100:103], a[224:227], v[16:19], v[100:103]
  ds_read_b64_tr_b16 a[220:221], v234 offset:8560
  v_cvt_pk_bf16_f32 v45, v178, v179
  v_mfma_f32_16x16x32_bf16 v[176:179], a[176:179], a[128:131], v[252:255]
  v_cvt_pk_bf16_f32 v46, v180, v181
  v_cvt_pk_bf16_f32 v47, v182, v183
  v_mfma_f32_16x16x32_bf16 v[180:183], a[180:183], a[128:131], v[252:255]
  v_sqrt_f32_e64 v189, v189
  v_mfma_f32_16x16x32_bf16 v[168:171], a[176:179], a[124:127], v[252:255]
  v_cvt_pk_bf16_f32 v189, 0, v189
  v_mfma_f32_16x16x32_bf16 v[172:175], a[180:183], a[124:127], v[252:255]
  v_rcp_f32_e64 v190, v189
  v_mfma_f32_16x16x32_bf16 v[104:107], a[228:231], a[16:19], v[104:107]
  ds_read_b64_tr_b16 a[222:223], v234 offset:8816
  v_cvt_pk_bf16_f32 v56, v176, v177
  v_mfma_f32_16x16x32_bf16 v[108:111], a[228:231], v[16:19], v[108:111]
  ds_read_b64_tr_b16 a[224:225], v235 offset:8448
  v_cvt_pk_bf16_f32 v57, v178, v179
  v_mfma_f32_16x16x32_bf16 v[112:115], a[232:235], a[16:19], v[112:115]
  ds_read_b64_tr_b16 a[226:227], v235 offset:8704
  v_cvt_pk_bf16_f32 v58, v180, v181
  v_mfma_f32_16x16x32_bf16 v[116:119], a[232:235], v[16:19], v[116:119]
  ds_read_b64_tr_b16 a[228:229], v234 offset:8608
  s_add_u32 m0, s77, 0x1c4a0
  v_mfma_f32_16x16x32_bf16 v[120:123], a[144:147], a[16:19], v[120:123]
  buffer_load_dwordx4 v236, s[12:15], s65 offen offset:3456 lds
  ds_read_b64_tr_b16 a[230:231], v234 offset:8864
  v_mfma_f32_16x16x32_bf16 v[124:127], a[144:147], v[16:19], v[124:127]
  ds_read_b64_tr_b16 a[232:233], v234 offset:8640
  v_cvt_pk_bf16_f32 v59, v182, v183
  v_mfma_f32_16x16x32_bf16 v[72:75], a[148:151], a[16:19], v[72:75]
  ds_read_b64_tr_b16 a[234:235], v234 offset:8896
  v_cvt_pk_bf16_f32 v52, v168, v169
  v_mfma_f32_16x16x32_bf16 v[76:79], a[148:151], v[16:19], v[76:79]
  ds_read_b64_tr_b16 a[144:145], v234 offset:8448
  s_waitcnt lgkmcnt(7)
  s_nop 0
  v_mfma_f32_16x16x32_bf16 v[80:83], a[152:155], a[16:19], v[80:83]
  ds_read_b64_tr_b16 a[146:147], v234 offset:8704
  v_cvt_pk_bf16_f32 v53, v170, v171
  v_mfma_f32_16x16x32_bf16 v[168:171], a[176:179], a[136:139], v[252:255]
  v_cvt_pk_bf16_f32 v54, v172, v173
  v_cvt_pk_bf16_f32 v55, v174, v175
  v_mfma_f32_16x16x32_bf16 v[172:175], a[180:183], a[136:139], v[252:255]
  v_accvgpr_write_b32 a185, v189
  v_mfma_f32_16x16x32_bf16 v[160:163], a[176:179], a[132:135], v[252:255]
  v_mul_f32_e32 v243, 0x3fb8aa3b, v190
  v_mfma_f32_16x16x32_bf16 v[164:167], a[180:183], a[132:135], v[252:255]
  v_accvgpr_write_b32 a187, v190
  v_cvt_pk_bf16_f32 v64, v168, v169
  v_mfma_f32_16x16x32_bf16 v[84:87], a[152:155], v[16:19], v[84:87]
  ds_read_b64_tr_b16 a[148:149], v234 offset:8480
  s_add_u32 m0, s76, 0x19c80
  v_mfma_f32_16x16x32_bf16 v[128:131], a[156:159], a[16:19], v[128:131]
  buffer_load_dwordx4 v237, s[16:19], s48 offen lds
  ds_read_b64_tr_b16 a[150:151], v234 offset:8736
  v_mfma_f32_16x16x32_bf16 v[136:139], a[156:159], v[16:19], v[136:139]
  ds_read_b64_tr_b16 a[152:153], v233 offset:4224
  v_cvt_pk_bf16_f32 v65, v170, v171
  v_mfma_f32_16x16x32_bf16 v[132:135], a[160:163], a[16:19], v[132:135]
  ds_read_b64_tr_b16 a[154:155], v233 offset:4480
  v_cvt_pk_bf16_f32 v66, v172, v173
  v_mfma_f32_16x16x32_bf16 v[140:143], a[160:163], v[16:19], v[140:143]
  ds_read_b64_tr_b16 a[156:157], v233 offset:4256
  v_cvt_pk_bf16_f32 v67, v174, v175
  v_mfma_f32_16x16x32_bf16 v[144:147], a[164:167], a[16:19], v[144:147]
  ds_read_b64_tr_b16 a[158:159], v233 offset:4512
  v_cvt_pk_bf16_f32 v60, v160, v161
  v_mfma_f32_16x16x32_bf16 v[152:155], a[164:167], v[16:19], v[152:155]
  ds_read_b64_tr_b16 a[160:161], v233 offset:4288
  v_cvt_pk_bf16_f32 v61, v162, v163
  v_mfma_f32_16x16x32_bf16 v[148:151], a[168:171], a[16:19], v[148:151]
  ds_read_b64_tr_b16 a[162:163], v233 offset:4544
  v_cvt_pk_bf16_f32 v62, v164, v165
  v_mfma_f32_16x16x32_bf16 v[156:159], a[168:171], v[16:19], v[156:159]
  ds_read_b64_tr_b16 a[164:165], v233 offset:4320
  v_cvt_pk_bf16_f32 v63, v166, v167
  v_mfma_f32_16x16x32_bf16 v[176:179], a[176:179], a[140:143], v[252:255]
  s_mov_b32 s49, 0x2d0000
  v_mfma_f32_16x16x32_bf16 v[180:183], a[180:183], a[140:143], v[252:255]
  s_mov_b32 s66, 0x10e000
  s_mov_b32 s50, 0x318000
  v_mfma_f32_16x16x32_bf16 v[88:91], a[172:175], a[20:23], v[88:91]
  ds_read_b64_tr_b16 a[166:167], v233 offset:4576
  s_mov_b32 s67, 0x129000
  v_mfma_f32_16x16x32_bf16 v[92:95], a[172:175], v[20:23], v[92:95]
  v_cvt_pk_bf16_f32 v68, v176, v177
  v_cvt_pk_bf16_f32 v69, v178, v179
  s_waitcnt vmcnt(6)
  s_barrier
  v_add_u32_e32 v233, 0x6300, v233
  v_add_u32_e32 v234, 0x6300, v234
  v_add_u32_e32 v235, 0x6300, v235
  ds_read_b64_tr_b16 a[168:169], v234 offset:80
  v_mfma_f32_16x16x32_bf16 v[96:99], a[220:223], a[20:23], v[96:99]
  ds_read_b64_tr_b16 a[170:171], v234 offset:336
  buffer_store_dwordx2 v[248:249], v185, s[32:35], s97 offen sc1
  s_xor_b32 s39, s84, 1
  s_lshl_b32 s39, s39, 10
  v_mfma_f32_16x16x32_bf16 v[100:103], a[220:223], v[20:23], v[100:103]
  ds_read_b64_tr_b16 a[172:173], v234 offset:112
  s_add_u32 m0, s77, 0x2100
  s_waitcnt lgkmcnt(4)
  s_nop 0
  v_mfma_f32_16x16x32_bf16 v[104:107], a[224:227], a[20:23], v[104:107]
  buffer_load_dwordx4 v236, s[12:15], s66 offen lds
  ds_read_b64_tr_b16 a[174:175], v234 offset:368
  v_mfma_f32_16x16x32_bf16 v[108:111], a[224:227], v[20:23], v[108:111]
  ds_read_b64_tr_b16 a[220:221], v235 offset:0
  v_accvgpr_read_b32 v239, a195
  v_mfma_f32_16x16x32_bf16 v[112:115], a[228:231], a[20:23], v[112:115]
  ds_read_b64_tr_b16 a[222:223], v235 offset:256
  v_accvgpr_read_b32 v240, a197
  v_mfma_f32_16x16x32_bf16 v[116:119], a[228:231], v[20:23], v[116:119]
  ds_read_b64_tr_b16 a[224:225], v234 offset:160
  v_accvgpr_read_b32 v241, a198
  v_mfma_f32_16x16x32_bf16 v[120:123], a[232:235], a[20:23], v[120:123]
  ds_read_b64_tr_b16 a[226:227], v234 offset:416
  ds_read_b64_tr_b16 a[72:73], v239 offset:0
  v_mfma_f32_16x16x32_bf16 v[124:127], a[232:235], v[20:23], v[124:127]
  ds_read_b64_tr_b16 a[228:229], v234 offset:192
  s_add_u32 m0, s77, 0x17a0
  v_mfma_f32_16x16x32_bf16 v[72:75], a[144:147], a[20:23], v[72:75]
  buffer_load_dwordx4 v236, s[12:15], s66 offen offset:3456 lds
  ds_read_b64_tr_b16 a[230:231], v234 offset:448
  v_mfma_f32_16x16x32_bf16 v[76:79], a[144:147], v[20:23], v[76:79]
  ds_read_b64_tr_b16 a[232:233], v234 offset:0
  ds_read_b64_tr_b16 a[74:75], v239 offset:2560
  v_mfma_f32_16x16x32_bf16 v[80:83], a[148:151], a[20:23], v[80:83]
  ds_read_b64_tr_b16 a[234:235], v234 offset:256
  ds_read_b64_tr_b16 a[76:77], v240 offset:0
  v_mfma_f32_16x16x32_bf16 v[84:87], a[148:151], v[20:23], v[84:87]
  ds_read_b64_tr_b16 a[144:145], v234 offset:32
  ds_read_b64_tr_b16 a[78:79], v241 offset:0
  v_mfma_f32_16x16x32_bf16 v[128:131], a[152:155], a[20:23], v[128:131]
  ds_read_b64_tr_b16 a[146:147], v234 offset:288
  ds_read_b64_tr_b16 a[80:81], v239 offset:32
  v_mfma_f32_16x16x32_bf16 v[136:139], a[152:155], v[20:23], v[136:139]
  ds_read_b64_tr_b16 a[148:149], v233 offset:0
  s_add_u32 m0, s76, 0
  s_nop 0
  v_mfma_f32_16x16x32_bf16 v[132:135], a[156:159], a[20:23], v[132:135]
  buffer_load_dwordx4 v237, s[16:19], s49 offen lds
  ds_read_b64_tr_b16 a[150:151], v233 offset:256
  v_mfma_f32_16x16x32_bf16 v[140:143], a[156:159], v[20:23], v[140:143]
  ds_read_b64_tr_b16 a[152:153], v233 offset:32
  ds_read_b64_tr_b16 a[82:83], v239 offset:2592
  v_mfma_f32_16x16x32_bf16 v[144:147], a[160:163], a[20:23], v[144:147]
  ds_read_b64_tr_b16 a[154:155], v233 offset:288
  ds_read_b64_tr_b16 a[84:85], v240 offset:32
  v_mfma_f32_16x16x32_bf16 v[152:155], a[160:163], v[20:23], v[152:155]
  ds_read_b64_tr_b16 a[156:157], v233 offset:64
  s_waitcnt lgkmcnt(11)
  s_nop 0
  v_mfma_f32_16x16x32_bf16 v[148:151], a[164:167], a[20:23], v[148:151]
  ds_read_b64_tr_b16 a[158:159], v233 offset:320
  ds_read_b64_tr_b16 a[86:87], v241 offset:32
  v_mfma_f32_16x16x32_bf16 v[156:159], a[164:167], v[20:23], v[156:159]
  ds_read_b64_tr_b16 a[160:161], v233 offset:96
  ds_read_b64_tr_b16 a[88:89], v239 offset:64
  v_mfma_f32_16x16x32_bf16 v[88:91], a[168:171], a[24:27], v[88:91]
  ds_read_b64_tr_b16 a[162:163], v233 offset:352
  ds_read_b64_tr_b16 a[90:91], v239 offset:2624
  v_mfma_f32_16x16x32_bf16 v[92:95], a[168:171], v[24:27], v[92:95]
  ds_read_b64_tr_b16 a[164:165], v234 offset:8528
  s_add_u32 m0, s77, 0x4200
  v_mfma_f32_16x16x32_bf16 v[96:99], a[172:175], a[24:27], v[96:99]
  buffer_load_dwordx4 v236, s[12:15], s67 offen lds
  ds_read_b64_tr_b16 a[166:167], v234 offset:8784
  v_mfma_f32_16x16x32_bf16 v[100:103], a[172:175], v[24:27], v[100:103]
  ds_read_b64_tr_b16 a[168:169], v234 offset:8560
  ds_read_b64_tr_b16 a[92:93], v240 offset:64
  v_mfma_f32_16x16x32_bf16 v[104:107], a[220:223], a[24:27], v[104:107]
  ds_read_b64_tr_b16 a[170:171], v234 offset:8816
  ds_read_b64_tr_b16 a[94:95], v241 offset:64
  v_mfma_f32_16x16x32_bf16 v[108:111], a[220:223], v[24:27], v[108:111]
  ds_read_b64_tr_b16 a[172:173], v235 offset:8448
  ds_read_b64_tr_b16 a[96:97], v239 offset:96
  v_mfma_f32_16x16x32_bf16 v[112:115], a[224:227], a[24:27], v[112:115]
  ds_read_b64_tr_b16 a[174:175], v235 offset:8704
  ds_read_b64_tr_b16 a[98:99], v239 offset:2656
  v_mfma_f32_16x16x32_bf16 v[116:119], a[224:227], v[24:27], v[116:119]
  ds_read_b64_tr_b16 a[220:221], v234 offset:8608
  s_add_u32 m0, s77, 0x38a0
  v_mfma_f32_16x16x32_bf16 v[120:123], a[228:231], a[24:27], v[120:123]
  buffer_load_dwordx4 v236, s[12:15], s67 offen offset:3456 lds
  ds_read_b64_tr_b16 a[222:223], v234 offset:8864
  v_mfma_f32_16x16x32_bf16 v[124:127], a[228:231], v[24:27], v[124:127]
  ds_read_b64_tr_b16 a[224:225], v234 offset:8640
  ds_read_b64_tr_b16 a[100:101], v240 offset:96
  v_mfma_f32_16x16x32_bf16 v[72:75], a[232:235], a[24:27], v[72:75]
  ds_read_b64_tr_b16 a[226:227], v234 offset:8896
  ds_read_b64_tr_b16 a[102:103], v241 offset:96
  v_mfma_f32_16x16x32_bf16 v[76:79], a[232:235], v[24:27], v[76:79]
  ds_read_b64_tr_b16 a[228:229], v234 offset:8448
  s_waitcnt lgkmcnt(11)
  s_nop 0
  v_mfma_f32_16x16x32_bf16 v[80:83], a[144:147], a[24:27], v[80:83]
  ds_read_b64_tr_b16 a[230:231], v234 offset:8704
  ds_read_b64_tr_b16 a[104:105], v239 offset:128
  v_mfma_f32_16x16x32_bf16 v[84:87], a[144:147], v[24:27], v[84:87]
  ds_read_b64_tr_b16 a[232:233], v234 offset:8480
  s_add_u32 m0, s76, 0x1080
  v_mfma_f32_16x16x32_bf16 v[128:131], a[148:151], a[24:27], v[128:131]
  buffer_load_dwordx4 v237, s[16:19], s50 offen lds
  ds_read_b64_tr_b16 a[234:235], v234 offset:8736
  v_mfma_f32_16x16x32_bf16 v[136:139], a[148:151], v[24:27], v[136:139]
  ds_read_b64_tr_b16 a[144:145], v233 offset:4224
  ds_read_b64_tr_b16 a[106:107], v239 offset:2688
  v_mfma_f32_16x16x32_bf16 v[132:135], a[152:155], a[24:27], v[132:135]
  ds_read_b64_tr_b16 a[146:147], v233 offset:4480
  ds_read_b64_tr_b16 a[108:109], v240 offset:128
  v_mfma_f32_16x16x32_bf16 v[140:143], a[152:155], v[24:27], v[140:143]
  ds_read_b64_tr_b16 a[148:149], v233 offset:4256
  ds_read_b64_tr_b16 a[110:111], v241 offset:128
  v_mfma_f32_16x16x32_bf16 v[144:147], a[156:159], a[24:27], v[144:147]
  ds_read_b64_tr_b16 a[150:151], v233 offset:4512
  v_accvgpr_read_b32 v244, a193
  v_mfma_f32_16x16x32_bf16 v[152:155], a[156:159], v[24:27], v[152:155]
  ds_read_b64_tr_b16 a[152:153], v233 offset:4288
  v_accvgpr_read_b32 v245, a194
  v_mfma_f32_16x16x32_bf16 v[148:151], a[160:163], a[24:27], v[148:151]
  ds_read_b64_tr_b16 a[154:155], v233 offset:4544
  s_mul_i32 s100, s4, 0x240
  v_mfma_f32_16x16x32_bf16 v[156:159], a[160:163], v[24:27], v[156:159]
  ds_read_b64_tr_b16 a[156:157], v233 offset:4320
  s_xor_b32 s101, s6, 1
  v_mfma_f32_16x16x32_bf16 v[88:91], a[164:167], a[28:31], v[88:91]
  ds_read_b64_tr_b16 a[158:159], v233 offset:4576
  s_lshl_b32 s101, s101, 9
  v_mfma_f32_16x16x32_bf16 v[92:95], a[164:167], v[28:31], v[92:95]
  s_add_u32 s100, s100, s101
  v_add_u32_e32 v244, s100, v244
  s_waitcnt vmcnt(7) lgkmcnt(5)
  s_barrier
  v_add_u32_e32 v233, 0x6300, v233
  v_add_u32_e32 v234, 0x6300, v234
  v_add_u32_e32 v235, 0x6300, v235
  ds_read_b64_tr_b16 a[160:161], v234 offset:80
  v_mfma_f32_16x16x32_bf16 v[96:99], a[168:171], a[28:31], v[96:99]
  ds_read_b64_tr_b16 a[162:163], v234 offset:336
  v_cvt_pk_bf16_f32 v70, v180, v181
  v_mfma_f32_16x16x32_bf16 v[100:103], a[168:171], v[28:31], v[100:103]
  ds_read_b64_tr_b16 a[164:165], v234 offset:112
  s_add_u32 m0, s77, 0x8400
  v_mfma_f32_16x16x32_bf16 v[104:107], a[172:175], a[28:31], v[104:107]
  s_mov_b32 s51, 0x360000
  s_mov_b32 s68, 0x144000
  buffer_load_dwordx4 v236, s[12:15], s68 offen lds
  ds_read_b64_tr_b16 a[166:167], v234 offset:368
  v_mfma_f32_16x16x32_bf16 v[108:111], a[172:175], v[28:31], v[108:111]
  ds_read_b64_tr_b16 a[168:169], v235 offset:0
  v_cvt_pk_bf16_f32 v71, v182, v183
  v_mfma_f32_16x16x32_bf16 v[112:115], a[220:223], a[28:31], v[112:115]
  ds_read_b64_tr_b16 a[170:171], v235 offset:256
  s_mov_b32 s52, 0x3a8000
  v_mfma_f32_16x16x32_bf16 v[116:119], a[220:223], v[28:31], v[116:119]
  ds_read_b64_tr_b16 a[172:173], v234 offset:160
  s_mov_b32 s69, 0x15f000
  v_mfma_f32_16x16x32_bf16 v[120:123], a[224:227], a[28:31], v[120:123]
  ds_read_b64_tr_b16 a[174:175], v234 offset:416
  s_mov_b32 s53, 0x3f0000
  v_mfma_f32_16x16x32_bf16 v[124:127], a[224:227], v[28:31], v[124:127]
  ds_read_b64_tr_b16 a[220:221], v234 offset:192
  s_add_u32 m0, s77, 0x7aa0
  v_mfma_f32_16x16x32_bf16 v[72:75], a[228:231], a[28:31], v[72:75]
  buffer_load_dwordx4 v236, s[12:15], s68 offen offset:3456 lds
  ds_read_b64_tr_b16 a[222:223], v234 offset:448
  v_mfma_f32_16x16x32_bf16 v[76:79], a[228:231], v[28:31], v[76:79]
  ds_read_b64_tr_b16 a[224:225], v234 offset:0
  s_mov_b32 s70, 0x17a000
  v_mfma_f32_16x16x32_bf16 v[80:83], a[232:235], a[28:31], v[80:83]
  ds_read_b64_tr_b16 a[226:227], v234 offset:256
  s_mov_b32 s54, 0x438000
  v_mfma_f32_16x16x32_bf16 v[84:87], a[232:235], v[28:31], v[84:87]
  ds_read_b64_tr_b16 a[228:229], v234 offset:32
  s_mov_b32 s71, 0x195000
  v_mfma_f32_16x16x32_bf16 v[128:131], a[144:147], a[28:31], v[128:131]
  ds_read_b64_tr_b16 a[230:231], v234 offset:288
  v_mfma_f32_16x16x32_bf16 v[136:139], a[144:147], v[28:31], v[136:139]
  ds_read_b64_tr_b16 a[232:233], v233 offset:0
  s_add_u32 m0, s76, 0x6300
  s_waitcnt lgkmcnt(7)
  s_nop 0
  v_mfma_f32_16x16x32_bf16 v[132:135], a[148:151], a[28:31], v[132:135]
  buffer_load_dwordx4 v237, s[16:19], s51 offen lds
  ds_read_b64_tr_b16 a[234:235], v233 offset:256
  v_mfma_f32_16x16x32_bf16 v[140:143], a[148:151], v[28:31], v[140:143]
  ds_read_b64_tr_b16 a[144:145], v233 offset:32
  v_mfma_f32_16x16x32_bf16 v[144:147], a[152:155], a[28:31], v[144:147]
  ds_read_b64_tr_b16 a[146:147], v233 offset:288
  v_mfma_f32_16x16x32_bf16 v[152:155], a[152:155], v[28:31], v[152:155]
  ds_read_b64_tr_b16 a[148:149], v233 offset:64
  v_mfma_f32_16x16x32_bf16 v[148:151], a[156:159], a[28:31], v[148:151]
  ds_read_b64_tr_b16 a[150:151], v233 offset:320
  v_mfma_f32_16x16x32_bf16 v[156:159], a[156:159], v[28:31], v[156:159]
  ds_read_b64_tr_b16 a[152:153], v233 offset:96
  v_mfma_f32_16x16x32_bf16 v[88:91], a[160:163], a[32:35], v[88:91]
  ds_read_b64_tr_b16 a[154:155], v233 offset:352
  v_mfma_f32_16x16x32_bf16 v[92:95], a[160:163], v[32:35], v[92:95]
  ds_read_b64_tr_b16 a[156:157], v234 offset:8528
  s_add_u32 m0, s77, 0xa500
  v_mfma_f32_16x16x32_bf16 v[96:99], a[164:167], a[32:35], v[96:99]
  buffer_load_dwordx4 v236, s[12:15], s69 offen lds
  ds_read_b64_tr_b16 a[158:159], v234 offset:8784
  v_mfma_f32_16x16x32_bf16 v[100:103], a[164:167], v[32:35], v[100:103]
  ds_read_b64_tr_b16 a[160:161], v234 offset:8560
  v_mfma_f32_16x16x32_bf16 v[104:107], a[168:171], a[32:35], v[104:107]
  ds_read_b64_tr_b16 a[162:163], v234 offset:8816
  v_mfma_f32_16x16x32_bf16 v[108:111], a[168:171], v[32:35], v[108:111]
  ds_read_b64_tr_b16 a[164:165], v235 offset:8448
  v_mfma_f32_16x16x32_bf16 v[112:115], a[172:175], a[32:35], v[112:115]
  ds_read_b64_tr_b16 a[166:167], v235 offset:8704
  v_mfma_f32_16x16x32_bf16 v[116:119], a[172:175], v[32:35], v[116:119]
  ds_read_b64_tr_b16 a[168:169], v234 offset:8608
  s_add_u32 m0, s77, 0x9ba0
  s_waitcnt lgkmcnt(7)
  s_nop 0
  v_mfma_f32_16x16x32_bf16 v[120:123], a[220:223], a[32:35], v[120:123]
  buffer_load_dwordx4 v236, s[12:15], s69 offen offset:3456 lds
  ds_read_b64_tr_b16 a[170:171], v234 offset:8864
  v_mfma_f32_16x16x32_bf16 v[124:127], a[220:223], v[32:35], v[124:127]
  ds_read_b64_tr_b16 a[172:173], v234 offset:8640
  v_mfma_f32_16x16x32_bf16 v[72:75], a[224:227], a[32:35], v[72:75]
  ds_read_b64_tr_b16 a[174:175], v234 offset:8896
  v_mfma_f32_16x16x32_bf16 v[76:79], a[224:227], v[32:35], v[76:79]
  ds_read_b64_tr_b16 a[220:221], v234 offset:8448
  v_mfma_f32_16x16x32_bf16 v[80:83], a[228:231], a[32:35], v[80:83]
  ds_read_b64_tr_b16 a[222:223], v234 offset:8704
  v_mfma_f32_16x16x32_bf16 v[84:87], a[228:231], v[32:35], v[84:87]
  ds_read_b64_tr_b16 a[224:225], v234 offset:8480
  s_add_u32 m0, s76, 0x7380
  v_mfma_f32_16x16x32_bf16 v[128:131], a[232:235], a[32:35], v[128:131]
  buffer_load_dwordx4 v237, s[16:19], s52 offen lds
  ds_read_b64_tr_b16 a[226:227], v234 offset:8736
  v_mfma_f32_16x16x32_bf16 v[136:139], a[232:235], v[32:35], v[136:139]
  ds_read_b64_tr_b16 a[228:229], v233 offset:4224
  v_mfma_f32_16x16x32_bf16 v[132:135], a[144:147], a[32:35], v[132:135]
  ds_read_b64_tr_b16 a[230:231], v233 offset:4480
  v_mfma_f32_16x16x32_bf16 v[140:143], a[144:147], v[32:35], v[140:143]
  ds_read_b64_tr_b16 a[232:233], v233 offset:4256
  v_mfma_f32_16x16x32_bf16 v[144:147], a[148:151], a[32:35], v[144:147]
  ds_read_b64_tr_b16 a[234:235], v233 offset:4512
  v_mfma_f32_16x16x32_bf16 v[152:155], a[148:151], v[32:35], v[152:155]
  ds_read_b64_tr_b16 a[144:145], v233 offset:4288
  v_mfma_f32_16x16x32_bf16 v[148:151], a[152:155], a[32:35], v[148:151]
  ds_read_b64_tr_b16 a[146:147], v233 offset:4544
  v_mfma_f32_16x16x32_bf16 v[156:159], a[152:155], v[32:35], v[156:159]
  ds_read_b64_tr_b16 a[148:149], v233 offset:4320
  s_waitcnt lgkmcnt(7)
  v_mfma_f32_16x16x32_bf16 v[88:91], a[156:159], a[36:39], v[88:91]
  ds_read_b64_tr_b16 a[150:151], v233 offset:4576
  v_mfma_f32_16x16x32_bf16 v[92:95], a[156:159], v[36:39], v[92:95]
  s_waitcnt vmcnt(6)
  s_barrier
  s_nop 0
  v_add_u32_e32 v233, 0xfffe7400, v233
  v_add_u32_e32 v234, 0xfffe7400, v234
  v_add_u32_e32 v235, 0xfffe7400, v235
  ds_read_b64_tr_b16 a[152:153], v234 offset:80
  v_mfma_f32_16x16x32_bf16 v[96:99], a[160:163], a[36:39], v[96:99]
  ds_read_b64_tr_b16 a[154:155], v234 offset:336
  s_mov_b32 s55, 0x480000
  v_mfma_f32_16x16x32_bf16 v[100:103], a[160:163], v[36:39], v[100:103]
  ds_read_b64_tr_b16 a[156:157], v234 offset:112
  s_add_u32 m0, s77, 0xe700
  v_mfma_f32_16x16x32_bf16 v[104:107], a[164:167], a[36:39], v[104:107]
  buffer_load_dwordx4 v236, s[12:15], s70 offen lds
  ds_read_b64_tr_b16 a[158:159], v234 offset:368
  v_mfma_f32_16x16x32_bf16 v[108:111], a[164:167], v[36:39], v[108:111]
  ds_read_b64_tr_b16 a[160:161], v235 offset:0
  s_add_u32 m0, s77, 0xdda0
  v_mfma_f32_16x16x32_bf16 v[112:115], a[168:171], a[36:39], v[112:115]
  buffer_load_dwordx4 v236, s[12:15], s70 offen offset:3456 lds
  ds_read_b64_tr_b16 a[162:163], v235 offset:256
  v_mfma_f32_16x16x32_bf16 v[116:119], a[168:171], v[36:39], v[116:119]
  ds_read_b64_tr_b16 a[164:165], v234 offset:160
  s_mov_b32 s72, 0x1b0000
  v_mfma_f32_16x16x32_bf16 v[120:123], a[172:175], a[36:39], v[120:123]
  ds_read_b64_tr_b16 a[166:167], v234 offset:416
  s_mov_b32 s56, 0x4c8000
  v_mfma_f32_16x16x32_bf16 v[124:127], a[172:175], v[36:39], v[124:127]
  ds_read_b64_tr_b16 a[168:169], v234 offset:192
  s_add_u32 m0, s76, 0xc600
  v_mfma_f32_16x16x32_bf16 v[72:75], a[220:223], a[36:39], v[72:75]
  buffer_load_dwordx4 v237, s[16:19], s53 offen lds
  ds_read_b64_tr_b16 a[170:171], v234 offset:448
  v_mfma_f32_16x16x32_bf16 v[76:79], a[220:223], v[36:39], v[76:79]
  ds_read_b64_tr_b16 a[172:173], v234 offset:0
  s_mov_b32 s73, 0x1cb000
  v_mfma_f32_16x16x32_bf16 v[80:83], a[224:227], a[36:39], v[80:83]
  ds_read_b64_tr_b16 a[174:175], v234 offset:256
  v_mfma_f32_16x16x32_bf16 v[84:87], a[224:227], v[36:39], v[84:87]
  ds_read_b64_tr_b16 a[220:221], v234 offset:32
  s_add_u32 m0, s77, 0x10800
  s_waitcnt lgkmcnt(7)
  s_nop 0
  v_mfma_f32_16x16x32_bf16 v[128:131], a[228:231], a[36:39], v[128:131]
  buffer_load_dwordx4 v236, s[12:15], s71 offen lds
  ds_read_b64_tr_b16 a[222:223], v234 offset:288
  v_mfma_f32_16x16x32_bf16 v[136:139], a[228:231], v[36:39], v[136:139]
  ds_read_b64_tr_b16 a[224:225], v233 offset:0
  s_add_u32 m0, s77, 0xfea0
  v_mfma_f32_16x16x32_bf16 v[132:135], a[232:235], a[36:39], v[132:135]
  buffer_load_dwordx4 v236, s[12:15], s71 offen offset:3456 lds
  ds_read_b64_tr_b16 a[226:227], v233 offset:256
  v_mfma_f32_16x16x32_bf16 v[140:143], a[232:235], v[36:39], v[140:143]
  ds_read_b64_tr_b16 a[228:229], v233 offset:32
  v_mfma_f32_16x16x32_bf16 v[144:147], a[144:147], a[36:39], v[144:147]
  ds_read_b64_tr_b16 a[230:231], v233 offset:288
  v_mfma_f32_16x16x32_bf16 v[152:155], a[144:147], v[36:39], v[152:155]
  ds_read_b64_tr_b16 a[232:233], v233 offset:64
  s_add_u32 m0, s76, 0xd680
  v_mfma_f32_16x16x32_bf16 v[148:151], a[148:151], a[36:39], v[148:151]
  buffer_load_dwordx4 v237, s[16:19], s54 offen lds
  ds_read_b64_tr_b16 a[234:235], v233 offset:320
  v_mfma_f32_16x16x32_bf16 v[156:159], a[148:151], v[36:39], v[156:159]
  ds_read_b64_tr_b16 a[144:145], v233 offset:96
  v_mfma_f32_16x16x32_bf16 v[88:91], a[152:155], a[40:43], v[88:91]
  ds_read_b64_tr_b16 a[146:147], v233 offset:352
  v_mfma_f32_16x16x32_bf16 v[92:95], a[152:155], v[40:43], v[92:95]
  ds_read_b64_tr_b16 a[148:149], v234 offset:8528
  s_add_u32 m0, s77, 0x14a00
  v_mfma_f32_16x16x32_bf16 v[96:99], a[156:159], a[40:43], v[96:99]
  buffer_load_dwordx4 v236, s[12:15], s72 offen lds
  ds_read_b64_tr_b16 a[150:151], v234 offset:8784
  v_mfma_f32_16x16x32_bf16 v[100:103], a[156:159], v[40:43], v[100:103]
  ds_read_b64_tr_b16 a[152:153], v234 offset:8560
  s_add_u32 m0, s77, 0x140a0
  v_mfma_f32_16x16x32_bf16 v[104:107], a[160:163], a[40:43], v[104:107]
  buffer_load_dwordx4 v236, s[12:15], s72 offen offset:3456 lds
  ds_read_b64_tr_b16 a[154:155], v234 offset:8816
  v_mfma_f32_16x16x32_bf16 v[108:111], a[160:163], v[40:43], v[108:111]
  ds_read_b64_tr_b16 a[156:157], v235 offset:8448
  s_waitcnt lgkmcnt(7)
  s_nop 0
  v_mfma_f32_16x16x32_bf16 v[112:115], a[164:167], a[40:43], v[112:115]
  ds_read_b64_tr_b16 a[158:159], v235 offset:8704
  v_mfma_f32_16x16x32_bf16 v[116:119], a[164:167], v[40:43], v[116:119]
  ds_read_b64_tr_b16 a[160:161], v234 offset:8608
  s_add_u32 m0, s76, 0x12900
  v_mfma_f32_16x16x32_bf16 v[120:123], a[168:171], a[40:43], v[120:123]
  buffer_load_dwordx4 v237, s[16:19], s55 offen lds
  ds_read_b64_tr_b16 a[162:163], v234 offset:8864
  v_mfma_f32_16x16x32_bf16 v[124:127], a[168:171], v[40:43], v[124:127]
  ds_read_b64_tr_b16 a[164:165], v234 offset:8640
  v_mfma_f32_16x16x32_bf16 v[72:75], a[172:175], a[40:43], v[72:75]
  ds_read_b64_tr_b16 a[166:167], v234 offset:8896
  v_mfma_f32_16x16x32_bf16 v[76:79], a[172:175], v[40:43], v[76:79]
  ds_read_b64_tr_b16 a[168:169], v234 offset:8448
  s_add_u32 m0, s77, 0x16b00
  v_mfma_f32_16x16x32_bf16 v[80:83], a[220:223], a[40:43], v[80:83]
  buffer_load_dwordx4 v236, s[12:15], s73 offen lds
  ds_read_b64_tr_b16 a[170:171], v234 offset:8704
  v_mfma_f32_16x16x32_bf16 v[84:87], a[220:223], v[40:43], v[84:87]
  ds_read_b64_tr_b16 a[172:173], v234 offset:8480
  s_add_u32 m0, s77, 0x161a0
  v_mfma_f32_16x16x32_bf16 v[128:131], a[224:227], a[40:43], v[128:131]
  buffer_load_dwordx4 v236, s[12:15], s73 offen offset:3456 lds
  ds_read_b64_tr_b16 a[174:175], v234 offset:8736
  v_mfma_f32_16x16x32_bf16 v[136:139], a[224:227], v[40:43], v[136:139]
  ds_read_b64_tr_b16 a[220:221], v233 offset:4224
  v_mfma_f32_16x16x32_bf16 v[132:135], a[228:231], a[40:43], v[132:135]
  ds_read_b64_tr_b16 a[222:223], v233 offset:4480
  v_mfma_f32_16x16x32_bf16 v[140:143], a[228:231], v[40:43], v[140:143]
  ds_read_b64_tr_b16 a[224:225], v233 offset:4256
  s_add_u32 m0, s76, 0x13980
  v_mfma_f32_16x16x32_bf16 v[144:147], a[232:235], a[40:43], v[144:147]
  buffer_load_dwordx4 v237, s[16:19], s56 offen lds
  ds_read_b64_tr_b16 a[226:227], v233 offset:4512
  v_mfma_f32_16x16x32_bf16 v[152:155], a[232:235], v[40:43], v[152:155]
  ds_read_b64_tr_b16 a[228:229], v233 offset:4288
  s_waitcnt lgkmcnt(7)
  s_nop 0
  v_mfma_f32_16x16x32_bf16 v[148:151], a[144:147], a[40:43], v[148:151]
  ds_read_b64_tr_b16 a[230:231], v233 offset:4544
  v_mfma_f32_16x16x32_bf16 v[156:159], a[144:147], v[40:43], v[156:159]
  ds_read_b64_tr_b16 a[232:233], v233 offset:4320
  v_mfma_f32_16x16x32_bf16 v[88:91], a[148:151], a[44:47], v[88:91]
  ds_read_b64_tr_b16 a[234:235], v233 offset:4576
  v_mfma_f32_16x16x32_bf16 v[92:95], a[148:151], v[44:47], v[92:95]
  s_waitcnt vmcnt(12)
  s_barrier
  v_add_u32_e32 v233, 0x6300, v233
  v_add_u32_e32 v234, 0x6300, v234
  v_add_u32_e32 v235, 0x6300, v235
  ds_read_b64_tr_b16 a[144:145], v234 offset:80
  v_mfma_f32_16x16x32_bf16 v[96:99], a[152:155], a[44:47], v[96:99]
  ds_read_b64_tr_b16 a[146:147], v234 offset:336
  v_mfma_f32_16x16x32_bf16 v[100:103], a[152:155], v[44:47], v[100:103]
  ds_read_b64_tr_b16 a[148:149], v234 offset:112
  s_add_u32 m0, s76, 0x18c00
  v_add_u32_e32 v237, 0x80, v237
  v_mfma_f32_16x16x32_bf16 v[104:107], a[156:159], a[44:47], v[104:107]
  buffer_load_dwordx4 v237, s[16:19], s0 offen lds
  ds_read_b64_tr_b16 a[150:151], v234 offset:368
  v_mfma_f32_16x16x32_bf16 v[108:111], a[156:159], v[44:47], v[108:111]
  ds_read_b64_tr_b16 a[152:153], v235 offset:0
  v_mfma_f32_16x16x32_bf16 v[112:115], a[160:163], a[44:47], v[112:115]
  ds_read_b64_tr_b16 a[154:155], v235 offset:256
  v_mfma_f32_16x16x32_bf16 v[116:119], a[160:163], v[44:47], v[116:119]
  ds_read_b64_tr_b16 a[156:157], v234 offset:160
  v_mfma_f32_16x16x32_bf16 v[120:123], a[164:167], a[44:47], v[120:123]
  ds_read_b64_tr_b16 a[158:159], v234 offset:416
  v_mfma_f32_16x16x32_bf16 v[124:127], a[164:167], v[44:47], v[124:127]
  ds_read_b64_tr_b16 a[160:161], v234 offset:192
  s_add_u32 m0, s76, 0x19c80
  v_mfma_f32_16x16x32_bf16 v[72:75], a[168:171], a[44:47], v[72:75]
  buffer_load_dwordx4 v237, s[16:19], s40 offen lds
  ds_read_b64_tr_b16 a[162:163], v234 offset:448
  v_mfma_f32_16x16x32_bf16 v[76:79], a[168:171], v[44:47], v[76:79]
  ds_read_b64_tr_b16 a[164:165], v234 offset:0
  s_waitcnt lgkmcnt(7)
  s_nop 0
  v_mfma_f32_16x16x32_bf16 v[80:83], a[172:175], a[44:47], v[80:83]
  ds_read_b64_tr_b16 a[166:167], v234 offset:256
  v_mfma_f32_16x16x32_bf16 v[84:87], a[172:175], v[44:47], v[84:87]
  ds_read_b64_tr_b16 a[168:169], v234 offset:32
  v_mfma_f32_16x16x32_bf16 v[128:131], a[220:223], a[44:47], v[128:131]
  ds_read_b64_tr_b16 a[170:171], v234 offset:288
  v_mfma_f32_16x16x32_bf16 v[136:139], a[220:223], v[44:47], v[136:139]
  ds_read_b64_tr_b16 a[172:173], v233 offset:0
  s_add_u32 m0, s76, 0x1ad00
  v_mfma_f32_16x16x32_bf16 v[132:135], a[224:227], a[44:47], v[132:135]
  buffer_load_dwordx4 v237, s[16:19], s41 offen lds
  ds_read_b64_tr_b16 a[174:175], v233 offset:256
  v_mfma_f32_16x16x32_bf16 v[140:143], a[224:227], v[44:47], v[140:143]
  ds_read_b64_tr_b16 a[220:221], v233 offset:32
  v_mfma_f32_16x16x32_bf16 v[144:147], a[228:231], a[44:47], v[144:147]
  ds_read_b64_tr_b16 a[222:223], v233 offset:288
  v_mfma_f32_16x16x32_bf16 v[152:155], a[228:231], v[44:47], v[152:155]
  ds_read_b64_tr_b16 a[224:225], v233 offset:64
  v_mfma_f32_16x16x32_bf16 v[148:151], a[232:235], a[44:47], v[148:151]
  ds_read_b64_tr_b16 a[226:227], v233 offset:320
  v_mfma_f32_16x16x32_bf16 v[156:159], a[232:235], v[44:47], v[156:159]
  ds_read_b64_tr_b16 a[228:229], v233 offset:96
  v_mfma_f32_16x16x32_bf16 v[88:91], a[144:147], a[48:51], v[88:91]
  ds_read_b64_tr_b16 a[230:231], v233 offset:352
  v_mfma_f32_16x16x32_bf16 v[92:95], a[144:147], v[48:51], v[92:95]
  ds_read_b64_tr_b16 a[232:233], v234 offset:8528
  s_add_u32 m0, s76, 0x1bd80
  v_mfma_f32_16x16x32_bf16 v[96:99], a[148:151], a[48:51], v[96:99]
  buffer_load_dwordx4 v237, s[16:19], s42 offen lds
  ds_read_b64_tr_b16 a[234:235], v234 offset:8784
  v_mfma_f32_16x16x32_bf16 v[100:103], a[148:151], v[48:51], v[100:103]
  ds_read_b64_tr_b16 a[144:145], v234 offset:8560
  s_waitcnt lgkmcnt(7)
  s_nop 0
  v_mfma_f32_16x16x32_bf16 v[104:107], a[152:155], a[48:51], v[104:107]
  ds_read_b64_tr_b16 a[146:147], v234 offset:8816
  v_mfma_f32_16x16x32_bf16 v[108:111], a[152:155], v[48:51], v[108:111]
  ds_read_b64_tr_b16 a[148:149], v235 offset:8448
  v_mfma_f32_16x16x32_bf16 v[112:115], a[156:159], a[48:51], v[112:115]
  ds_read_b64_tr_b16 a[150:151], v235 offset:8704
  v_mfma_f32_16x16x32_bf16 v[116:119], a[156:159], v[48:51], v[116:119]
  ds_read_b64_tr_b16 a[152:153], v234 offset:8608
  s_add_u32 m0, s76, 0x1ce00
  v_mfma_f32_16x16x32_bf16 v[120:123], a[160:163], a[48:51], v[120:123]
  buffer_load_dwordx4 v237, s[16:19], s43 offen lds
  ds_read_b64_tr_b16 a[154:155], v234 offset:8864
  v_mfma_f32_16x16x32_bf16 v[124:127], a[160:163], v[48:51], v[124:127]
  ds_read_b64_tr_b16 a[156:157], v234 offset:8640
  v_mfma_f32_16x16x32_bf16 v[72:75], a[164:167], a[48:51], v[72:75]
  ds_read_b64_tr_b16 a[158:159], v234 offset:8896
  v_mfma_f32_16x16x32_bf16 v[76:79], a[164:167], v[48:51], v[76:79]
  s_mul_i32 s7, s6, 0x2400
  s_sub_u32 s93, s93, s7
  s_lshr_b32 s7, s4, 3
  s_cmp_eq_u32 s7, s6
  s_cselect_b32 s93, s93, 0x40000000
  s_nop 0
  buffer_load_dword v246, v211, s[16:19], s93 offen offset:256
  ds_read_b64_tr_b16 a[160:161], v234 offset:8448
  v_mfma_f32_16x16x32_bf16 v[80:83], a[168:171], a[48:51], v[80:83]
  ds_read_b64_tr_b16 a[162:163], v234 offset:8704
  v_mfma_f32_16x16x32_bf16 v[84:87], a[168:171], v[48:51], v[84:87]
  ds_read_b64_tr_b16 a[164:165], v234 offset:8480
  s_add_u32 m0, s76, 0x1de80
  v_mfma_f32_16x16x32_bf16 v[128:131], a[172:175], a[48:51], v[128:131]
  buffer_load_dwordx4 v237, s[16:19], s44 offen lds
  ds_read_b64_tr_b16 a[166:167], v234 offset:8736
  v_mfma_f32_16x16x32_bf16 v[136:139], a[172:175], v[48:51], v[136:139]
  ds_read_b64_tr_b16 a[168:169], v233 offset:4224
  v_mfma_f32_16x16x32_bf16 v[132:135], a[220:223], a[48:51], v[132:135]
  ds_read_b64_tr_b16 a[170:171], v233 offset:4480
  v_mfma_f32_16x16x32_bf16 v[140:143], a[220:223], v[48:51], v[140:143]
  ds_read_b64_tr_b16 a[172:173], v233 offset:4256
  s_waitcnt lgkmcnt(7)
  s_nop 0
  v_mfma_f32_16x16x32_bf16 v[144:147], a[224:227], a[48:51], v[144:147]
  ds_read_b64_tr_b16 a[174:175], v233 offset:4512
  v_mfma_f32_16x16x32_bf16 v[152:155], a[224:227], v[48:51], v[152:155]
  ds_read_b64_tr_b16 a[220:221], v233 offset:4288
  v_mfma_f32_16x16x32_bf16 v[148:151], a[228:231], a[48:51], v[148:151]
  ds_read_b64_tr_b16 a[222:223], v233 offset:4544
  v_mfma_f32_16x16x32_bf16 v[156:159], a[228:231], v[48:51], v[156:159]
  ds_read_b64_tr_b16 a[224:225], v233 offset:4320
  v_mfma_f32_16x16x32_bf16 v[88:91], a[232:235], a[52:55], v[88:91]
  ds_read_b64_tr_b16 a[226:227], v233 offset:4576
  v_mfma_f32_16x16x32_bf16 v[92:95], a[232:235], v[52:55], v[92:95]
  s_waitcnt vmcnt(13)
  s_barrier
  v_add_u32_e32 v233, 0x6300, v233
  v_add_u32_e32 v234, 0x6300, v234
  v_add_u32_e32 v235, 0x6300, v235
  ds_read_b64_tr_b16 a[228:229], v234 offset:80
  v_mfma_f32_16x16x32_bf16 v[96:99], a[144:147], a[52:55], v[96:99]
  ds_read_b64_tr_b16 a[230:231], v234 offset:336
  v_mfma_f32_16x16x32_bf16 v[100:103], a[144:147], v[52:55], v[100:103]
  ds_read_b64_tr_b16 a[232:233], v234 offset:112
  s_add_u32 m0, s76, 0
  s_nop 0
  v_mfma_f32_16x16x32_bf16 v[104:107], a[148:151], a[52:55], v[104:107]
  buffer_load_dwordx4 v237, s[16:19], s45 offen lds
  ds_read_b64_tr_b16 a[234:235], v234 offset:368
  v_mfma_f32_16x16x32_bf16 v[108:111], a[148:151], v[52:55], v[108:111]
  ds_read_b64_tr_b16 a[144:145], v235 offset:0
  v_mfma_f32_16x16x32_bf16 v[112:115], a[152:155], a[52:55], v[112:115]
  ds_read_b64_tr_b16 a[146:147], v235 offset:256
  v_mfma_f32_16x16x32_bf16 v[116:119], a[152:155], v[52:55], v[116:119]
  ds_read_b64_tr_b16 a[148:149], v234 offset:160
  v_mfma_f32_16x16x32_bf16 v[120:123], a[156:159], a[52:55], v[120:123]
  ds_read_b64_tr_b16 a[150:151], v234 offset:416
  v_mfma_f32_16x16x32_bf16 v[124:127], a[156:159], v[52:55], v[124:127]
  ds_read_b64_tr_b16 a[152:153], v234 offset:192
  s_add_u32 m0, s76, 0x1080
  s_waitcnt lgkmcnt(7)
  s_nop 0
  v_mfma_f32_16x16x32_bf16 v[72:75], a[160:163], a[52:55], v[72:75]
  buffer_load_dwordx4 v237, s[16:19], s46 offen lds
  ds_read_b64_tr_b16 a[154:155], v234 offset:448
  v_mfma_f32_16x16x32_bf16 v[76:79], a[160:163], v[52:55], v[76:79]
  ds_read_b64_tr_b16 a[156:157], v234 offset:0
  v_mfma_f32_16x16x32_bf16 v[80:83], a[164:167], a[52:55], v[80:83]
  ds_read_b64_tr_b16 a[158:159], v234 offset:256
  v_mfma_f32_16x16x32_bf16 v[84:87], a[164:167], v[52:55], v[84:87]
  ds_read_b64_tr_b16 a[160:161], v234 offset:32
  v_mfma_f32_16x16x32_bf16 v[128:131], a[168:171], a[52:55], v[128:131]
  ds_read_b64_tr_b16 a[162:163], v234 offset:288
  v_mfma_f32_16x16x32_bf16 v[136:139], a[168:171], v[52:55], v[136:139]
  ds_read_b64_tr_b16 a[164:165], v233 offset:0
  s_add_u32 m0, s76, 0x2100
  v_mfma_f32_16x16x32_bf16 v[132:135], a[172:175], a[52:55], v[132:135]
  buffer_load_dwordx4 v237, s[16:19], s47 offen lds
  ds_read_b64_tr_b16 a[166:167], v233 offset:256
  v_mfma_f32_16x16x32_bf16 v[140:143], a[172:175], v[52:55], v[140:143]
  ds_read_b64_tr_b16 a[168:169], v233 offset:32
  v_mfma_f32_16x16x32_bf16 v[144:147], a[220:223], a[52:55], v[144:147]
  ds_read_b64_tr_b16 a[170:171], v233 offset:288
  v_mfma_f32_16x16x32_bf16 v[152:155], a[220:223], v[52:55], v[152:155]
  ds_read_b64_tr_b16 a[172:173], v233 offset:64
  v_mfma_f32_16x16x32_bf16 v[148:151], a[224:227], a[52:55], v[148:151]
  ds_read_b64_tr_b16 a[174:175], v233 offset:320
  v_mfma_f32_16x16x32_bf16 v[156:159], a[224:227], v[52:55], v[156:159]
  ds_read_b64_tr_b16 a[220:221], v233 offset:96
  v_mfma_f32_16x16x32_bf16 v[88:91], a[228:231], a[56:59], v[88:91]
  ds_read_b64_tr_b16 a[222:223], v233 offset:352
  v_mfma_f32_16x16x32_bf16 v[92:95], a[228:231], v[56:59], v[92:95]
  ds_read_b64_tr_b16 a[224:225], v234 offset:8528
  s_add_u32 m0, s76, 0x3180
  s_waitcnt lgkmcnt(7)
  s_nop 0
  v_mfma_f32_16x16x32_bf16 v[96:99], a[232:235], a[56:59], v[96:99]
  buffer_load_dwordx4 v237, s[16:19], s48 offen lds
  ds_read_b64_tr_b16 a[226:227], v234 offset:8784
  v_mfma_f32_16x16x32_bf16 v[100:103], a[232:235], v[56:59], v[100:103]
  ds_read_b64_tr_b16 a[228:229], v234 offset:8560
  v_mfma_f32_16x16x32_bf16 v[104:107], a[144:147], a[56:59], v[104:107]
  ds_read_b64_tr_b16 a[230:231], v234 offset:8816
  v_mfma_f32_16x16x32_bf16 v[108:111], a[144:147], v[56:59], v[108:111]
  ds_read_b64_tr_b16 a[232:233], v235 offset:8448
  v_mfma_f32_16x16x32_bf16 v[112:115], a[148:151], a[56:59], v[112:115]
  ds_read_b64_tr_b16 a[234:235], v235 offset:8704
  v_mfma_f32_16x16x32_bf16 v[116:119], a[148:151], v[56:59], v[116:119]
  ds_read_b64_tr_b16 a[144:145], v234 offset:8608
  s_add_u32 m0, s76, 0x4200
  v_mfma_f32_16x16x32_bf16 v[120:123], a[152:155], a[56:59], v[120:123]
  buffer_load_dwordx4 v237, s[16:19], s49 offen lds
  ds_read_b64_tr_b16 a[146:147], v234 offset:8864
  v_mfma_f32_16x16x32_bf16 v[124:127], a[152:155], v[56:59], v[124:127]
  ds_read_b64_tr_b16 a[148:149], v234 offset:8640
  v_mfma_f32_16x16x32_bf16 v[72:75], a[156:159], a[56:59], v[72:75]
  ds_read_b64_tr_b16 a[150:151], v234 offset:8896
  v_mfma_f32_16x16x32_bf16 v[76:79], a[156:159], v[56:59], v[76:79]
  ds_read_b64_tr_b16 a[152:153], v234 offset:8448
  v_mfma_f32_16x16x32_bf16 v[80:83], a[160:163], a[56:59], v[80:83]
  ds_read_b64_tr_b16 a[154:155], v234 offset:8704
  v_mfma_f32_16x16x32_bf16 v[84:87], a[160:163], v[56:59], v[84:87]
  ds_read_b64_tr_b16 a[156:157], v234 offset:8480
  s_add_u32 m0, s76, 0x5280
  v_mfma_f32_16x16x32_bf16 v[128:131], a[164:167], a[56:59], v[128:131]
  buffer_load_dwordx4 v237, s[16:19], s50 offen lds
  ds_read_b64_tr_b16 a[158:159], v234 offset:8736
  v_mfma_f32_16x16x32_bf16 v[136:139], a[164:167], v[56:59], v[136:139]
  ds_read_b64_tr_b16 a[160:161], v233 offset:4224
  s_waitcnt lgkmcnt(7)
  s_nop 0
  v_mfma_f32_16x16x32_bf16 v[132:135], a[168:171], a[56:59], v[132:135]
  ds_read_b64_tr_b16 a[162:163], v233 offset:4480
  v_mfma_f32_16x16x32_bf16 v[140:143], a[168:171], v[56:59], v[140:143]
  ds_read_b64_tr_b16 a[164:165], v233 offset:4256
  v_mfma_f32_16x16x32_bf16 v[144:147], a[172:175], a[56:59], v[144:147]
  ds_read_b64_tr_b16 a[166:167], v233 offset:4512
  v_mfma_f32_16x16x32_bf16 v[152:155], a[172:175], v[56:59], v[152:155]
  ds_read_b64_tr_b16 a[168:169], v233 offset:4288
  v_mfma_f32_16x16x32_bf16 v[148:151], a[220:223], a[56:59], v[148:151]
  ds_read_b64_tr_b16 a[170:171], v233 offset:4544
  v_mfma_f32_16x16x32_bf16 v[156:159], a[220:223], v[56:59], v[156:159]
  ds_read_b64_tr_b16 a[172:173], v233 offset:4320
  v_mfma_f32_16x16x32_bf16 v[88:91], a[224:227], a[60:63], v[88:91]
  ds_read_b64_tr_b16 a[174:175], v233 offset:4576
  v_mfma_f32_16x16x32_bf16 v[92:95], a[224:227], v[60:63], v[92:95]
  s_waitcnt vmcnt(13)
  s_barrier
  v_add_u32_e32 v233, 0x6300, v233
  v_add_u32_e32 v234, 0x6300, v234
  v_add_u32_e32 v235, 0x6300, v235
  ds_read_b64_tr_b16 a[220:221], v234 offset:80
  v_mfma_f32_16x16x32_bf16 v[96:99], a[228:231], a[60:63], v[96:99]
  ds_read_b64_tr_b16 a[222:223], v234 offset:336
  v_mfma_f32_16x16x32_bf16 v[100:103], a[228:231], v[60:63], v[100:103]
  ds_read_b64_tr_b16 a[224:225], v234 offset:112
  s_add_u32 m0, s76, 0x6300
  v_mfma_f32_16x16x32_bf16 v[104:107], a[232:235], a[60:63], v[104:107]
  buffer_load_dwordx4 v237, s[16:19], s51 offen lds
  ds_read_b64_tr_b16 a[226:227], v234 offset:368
  v_mfma_f32_16x16x32_bf16 v[108:111], a[232:235], v[60:63], v[108:111]
  ds_read_b64_tr_b16 a[228:229], v235 offset:0
  v_mfma_f32_16x16x32_bf16 v[112:115], a[144:147], a[60:63], v[112:115]
  ds_read_b64_tr_b16 a[230:231], v235 offset:256
  v_mfma_f32_16x16x32_bf16 v[116:119], a[144:147], v[60:63], v[116:119]
  ds_read_b64_tr_b16 a[232:233], v234 offset:160
  s_waitcnt lgkmcnt(7)
  s_nop 0
  v_mfma_f32_16x16x32_bf16 v[120:123], a[148:151], a[60:63], v[120:123]
  ds_read_b64_tr_b16 a[234:235], v234 offset:416
  v_mfma_f32_16x16x32_bf16 v[124:127], a[148:151], v[60:63], v[124:127]
  ds_read_b64_tr_b16 a[144:145], v234 offset:192
  s_add_u32 m0, s76, 0x7380
  v_mfma_f32_16x16x32_bf16 v[72:75], a[152:155], a[60:63], v[72:75]
  buffer_load_dwordx4 v237, s[16:19], s52 offen lds
  ds_read_b64_tr_b16 a[146:147], v234 offset:448
  v_mfma_f32_16x16x32_bf16 v[76:79], a[152:155], v[60:63], v[76:79]
  ds_read_b64_tr_b16 a[148:149], v234 offset:0
  v_mfma_f32_16x16x32_bf16 v[80:83], a[156:159], a[60:63], v[80:83]
  ds_read_b64_tr_b16 a[150:151], v234 offset:256
  v_mfma_f32_16x16x32_bf16 v[84:87], a[156:159], v[60:63], v[84:87]
  ds_read_b64_tr_b16 a[152:153], v234 offset:32
  v_mfma_f32_16x16x32_bf16 v[128:131], a[160:163], a[60:63], v[128:131]
  ds_read_b64_tr_b16 a[154:155], v234 offset:288
  v_mfma_f32_16x16x32_bf16 v[136:139], a[160:163], v[60:63], v[136:139]
  ds_read_b64_tr_b16 a[156:157], v233 offset:0
  s_add_u32 m0, s76, 0x8400
  v_mfma_f32_16x16x32_bf16 v[132:135], a[164:167], a[60:63], v[132:135]
  buffer_load_dwordx4 v237, s[16:19], s53 offen lds
  ds_read_b64_tr_b16 a[158:159], v233 offset:256
  v_mfma_f32_16x16x32_bf16 v[140:143], a[164:167], v[60:63], v[140:143]
  ds_read_b64_tr_b16 a[160:161], v233 offset:32
  v_mfma_f32_16x16x32_bf16 v[144:147], a[168:171], a[60:63], v[144:147]
  ds_read_b64_tr_b16 a[162:163], v233 offset:288
  v_mfma_f32_16x16x32_bf16 v[152:155], a[168:171], v[60:63], v[152:155]
  ds_read_b64_tr_b16 a[164:165], v233 offset:64
  v_mfma_f32_16x16x32_bf16 v[148:151], a[172:175], a[60:63], v[148:151]
  ds_read_b64_tr_b16 a[166:167], v233 offset:320
  v_mfma_f32_16x16x32_bf16 v[156:159], a[172:175], v[60:63], v[156:159]
  ds_read_b64_tr_b16 a[168:169], v233 offset:96
  s_waitcnt lgkmcnt(7)
  s_nop 0
  v_mfma_f32_16x16x32_bf16 v[88:91], a[220:223], a[64:67], v[88:91]
  ds_read_b64_tr_b16 a[170:171], v233 offset:352
  v_mfma_f32_16x16x32_bf16 v[92:95], a[220:223], v[64:67], v[92:95]
  ds_read_b64_tr_b16 a[172:173], v234 offset:8528
  s_add_u32 m0, s76, 0x9480
  v_mfma_f32_16x16x32_bf16 v[96:99], a[224:227], a[64:67], v[96:99]
  buffer_load_dwordx4 v237, s[16:19], s54 offen lds
  ds_read_b64_tr_b16 a[174:175], v234 offset:8784
  v_mfma_f32_16x16x32_bf16 v[100:103], a[224:227], v[64:67], v[100:103]
  ds_read_b64_tr_b16 a[220:221], v234 offset:8560
  v_mfma_f32_16x16x32_bf16 v[104:107], a[228:231], a[64:67], v[104:107]
  ds_read_b64_tr_b16 a[222:223], v234 offset:8816
  v_mfma_f32_16x16x32_bf16 v[108:111], a[228:231], v[64:67], v[108:111]
  ds_read_b64_tr_b16 a[224:225], v235 offset:8448
  v_mfma_f32_16x16x32_bf16 v[112:115], a[232:235], a[64:67], v[112:115]
  ds_read_b64_tr_b16 a[226:227], v235 offset:8704
  v_mfma_f32_16x16x32_bf16 v[116:119], a[232:235], v[64:67], v[116:119]
  ds_read_b64_tr_b16 a[228:229], v234 offset:8608
  s_add_u32 m0, s76, 0xa500
  v_mfma_f32_16x16x32_bf16 v[120:123], a[144:147], a[64:67], v[120:123]
  buffer_load_dwordx4 v237, s[16:19], s55 offen lds
  ds_read_b64_tr_b16 a[230:231], v234 offset:8864
  v_mfma_f32_16x16x32_bf16 v[124:127], a[144:147], v[64:67], v[124:127]
  ds_read_b64_tr_b16 a[232:233], v234 offset:8640
  v_mfma_f32_16x16x32_bf16 v[72:75], a[148:151], a[64:67], v[72:75]
  ds_read_b64_tr_b16 a[234:235], v234 offset:8896
  v_mfma_f32_16x16x32_bf16 v[76:79], a[148:151], v[64:67], v[76:79]
  ds_read_b64_tr_b16 a[144:145], v234 offset:8448
  v_mfma_f32_16x16x32_bf16 v[80:83], a[152:155], a[64:67], v[80:83]
  ds_read_b64_tr_b16 a[146:147], v234 offset:8704
  v_mfma_f32_16x16x32_bf16 v[84:87], a[152:155], v[64:67], v[84:87]
  ds_read_b64_tr_b16 a[148:149], v234 offset:8480
  s_add_u32 m0, s76, 0xb580
  s_waitcnt lgkmcnt(7)
  s_nop 0
  v_mfma_f32_16x16x32_bf16 v[128:131], a[156:159], a[64:67], v[128:131]
  buffer_load_dwordx4 v237, s[16:19], s56 offen lds
  ds_read_b64_tr_b16 a[150:151], v234 offset:8736
  v_mfma_f32_16x16x32_bf16 v[136:139], a[156:159], v[64:67], v[136:139]
  ds_read_b64_tr_b16 a[152:153], v233 offset:4224
  v_mfma_f32_16x16x32_bf16 v[132:135], a[160:163], a[64:67], v[132:135]
  ds_read_b64_tr_b16 a[154:155], v233 offset:4480
  v_mfma_f32_16x16x32_bf16 v[140:143], a[160:163], v[64:67], v[140:143]
  ds_read_b64_tr_b16 a[156:157], v233 offset:4256
  v_mfma_f32_16x16x32_bf16 v[144:147], a[164:167], a[64:67], v[144:147]
  ds_read_b64_tr_b16 a[158:159], v233 offset:4512
  v_mfma_f32_16x16x32_bf16 v[152:155], a[164:167], v[64:67], v[152:155]
  ds_read_b64_tr_b16 a[160:161], v233 offset:4288
  v_mfma_f32_16x16x32_bf16 v[148:151], a[168:171], a[64:67], v[148:151]
  ds_read_b64_tr_b16 a[162:163], v233 offset:4544
  v_mfma_f32_16x16x32_bf16 v[156:159], a[168:171], v[64:67], v[156:159]
  ds_read_b64_tr_b16 a[164:165], v233 offset:4320
  v_mfma_f32_16x16x32_bf16 v[88:91], a[172:175], a[68:71], v[88:91]
  ds_read_b64_tr_b16 a[166:167], v233 offset:4576
  v_mfma_f32_16x16x32_bf16 v[92:95], a[172:175], v[68:71], v[92:95]
  s_waitcnt vmcnt(12)
  s_barrier
  v_add_u32_e32 v233, 0x6300, v233
  ds_read_b64_tr_b16 a[168:169], v233 offset:0
  v_mfma_f32_16x16x32_bf16 v[96:99], a[220:223], a[68:71], v[96:99]
  ds_read_b64_tr_b16 a[170:171], v233 offset:256
  v_cvt_pk_bf16_f32 v88, v88, v89
  v_mfma_f32_16x16x32_bf16 v[100:103], a[220:223], v[68:71], v[100:103]
  ds_read_b64_tr_b16 a[172:173], v233 offset:32
  s_add_u32 m0, s76, 0xc600
  v_add_u32_e32 v237, 0x80, v237
  v_mfma_f32_16x16x32_bf16 v[104:107], a[224:227], a[68:71], v[104:107]
  buffer_load_dwordx4 v237, s[16:19], s0 offen lds
  ds_read_b64_tr_b16 a[174:175], v233 offset:288
  v_mfma_f32_16x16x32_bf16 v[108:111], a[224:227], v[68:71], v[108:111]
  ds_read_b64_tr_b16 a[220:221], v233 offset:64
  s_waitcnt lgkmcnt(6)
  s_nop 0
  v_mfma_f32_16x16x32_bf16 v[112:115], a[228:231], a[68:71], v[112:115]
  ds_read_b64_tr_b16 a[222:223], v233 offset:320
  v_cvt_pk_bf16_f32 v89, v90, v91
  v_mfma_f32_16x16x32_bf16 v[116:119], a[228:231], v[68:71], v[116:119]
  ds_read_b64_tr_b16 a[224:225], v233 offset:96
  v_cvt_pk_bf16_f32 v90, v96, v97
  v_mfma_f32_16x16x32_bf16 v[120:123], a[232:235], a[68:71], v[120:123]
  ds_read_b64_tr_b16 a[226:227], v233 offset:352
  v_cvt_pk_bf16_f32 v91, v98, v99
  v_mfma_f32_16x16x32_bf16 v[124:127], a[232:235], v[68:71], v[124:127]
  ds_read_b64_tr_b16 a[228:229], v233 offset:4224
  s_add_u32 m0, s76, 0xd680
  v_mfma_f32_16x16x32_bf16 v[72:75], a[144:147], a[68:71], v[72:75]
  buffer_load_dwordx4 v237, s[16:19], s40 offen lds
  ds_read_b64_tr_b16 a[230:231], v233 offset:4480
  v_mfma_f32_16x16x32_bf16 v[76:79], a[144:147], v[68:71], v[76:79]
  buffer_load_dword v246, v247, s[20:23], s89 offen
  v_min_u32_e32 v247, 0xa80, v247
  buffer_load_dword v246, v247, s[24:27], s85 offen
  ds_read_b64_tr_b16 a[232:233], v233 offset:4256
  v_mfma_f32_16x16x32_bf16 v[80:83], a[148:151], a[68:71], v[80:83]
  ds_read_b64_tr_b16 a[234:235], v233 offset:4512
  v_cvt_pk_bf16_f32 v104, v104, v105
  v_mfma_f32_16x16x32_bf16 v[84:87], a[148:151], v[68:71], v[84:87]
  ds_read_b64_tr_b16 a[144:145], v233 offset:4288
  v_cvt_pk_bf16_f32 v105, v106, v107
  v_mfma_f32_16x16x32_bf16 v[128:131], a[152:155], a[68:71], v[128:131]
  ds_read_b64_tr_b16 a[146:147], v233 offset:4544
  v_accvgpr_read_b32 v96, a184
  v_mfma_f32_16x16x32_bf16 v[136:139], a[152:155], v[68:71], v[136:139]
  ds_read_b64_tr_b16 a[148:149], v233 offset:4320
  v_mov_b32_e64 v97, 0
  v_mfma_f32_16x16x32_bf16 v[132:135], a[156:159], a[68:71], v[132:135]
  ds_read_b64_tr_b16 a[150:151], v233 offset:4576
  v_lshrrev_b32_e64 v96, 16, v96
  v_mfma_f32_16x16x32_bf16 v[140:143], a[156:159], v[68:71], v[140:143]
  ds_read_b64_tr_b16 a[152:153], v233 offset:8448
  s_add_u32 m0, s76, 0xe700
  v_mfma_f32_16x16x32_bf16 v[144:147], a[160:163], a[68:71], v[144:147]
  buffer_load_dwordx4 v237, s[16:19], s41 offen lds
  ds_read_b64_tr_b16 a[154:155], v233 offset:8704
  v_mfma_f32_16x16x32_bf16 v[152:155], a[160:163], v[68:71], v[152:155]
  ds_read_b64_tr_b16 a[156:157], v233 offset:8480
  s_waitcnt lgkmcnt(7)
  s_nop 0
  v_mfma_f32_16x16x32_bf16 v[148:151], a[164:167], a[68:71], v[148:151]
  ds_read_b64_tr_b16 a[158:159], v233 offset:8736
  v_mov_b32_dpp v104, v96 quad_perm:[0,1,2,3] row_mask:0x8 bank_mask:0xf
  v_mfma_f32_16x16x32_bf16 v[156:159], a[164:167], v[68:71], v[156:159]
  ds_read_b64_tr_b16 a[160:161], v233 offset:8512
  v_mov_b32_dpp v105, v97 quad_perm:[0,1,2,3] row_mask:0x8 bank_mask:0xf
  v_cvt_pk_bf16_f32 v92, v92, v93
  v_cvt_pk_bf16_f32 v93, v94, v95
  v_cvt_pk_bf16_f32 v94, v100, v101
  v_cvt_pk_bf16_f32 v95, v102, v103
  v_mfma_f32_16x16x32_bf16 v[160:163], a[168:171], a[0:3], 0
  ds_read_b64_tr_b16 a[162:163], v233 offset:8768
  v_cvt_pk_bf16_f32 v106, v108, v109
  v_cvt_pk_bf16_f32 v107, v110, v111
  v_accvgpr_read_b32 v100, a185
  v_mov_b32_e32 v101, 0
  v_lshrrev_b32_e32 v100, 16, v100
  v_mfma_f32_16x16x32_bf16 v[168:171], a[168:171], v[0:3], 0
  ds_read_b64_tr_b16 a[164:165], v233 offset:8544
  v_mov_b32_dpp v106, v100 quad_perm:[0,1,2,3] row_mask:0x8 bank_mask:0xf
  v_mov_b32_dpp v107, v101 quad_perm:[0,1,2,3] row_mask:0x8 bank_mask:0xf
  v_cvt_pk_bf16_f32 v112, v112, v113
  v_cvt_pk_bf16_f32 v113, v114, v115
  v_cvt_pk_bf16_f32 v114, v120, v121
  v_mfma_f32_16x16x32_bf16 v[164:167], a[172:175], a[0:3], 0
  ds_read_b64_tr_b16 a[166:167], v233 offset:8800
  v_cvt_pk_bf16_f32 v115, v122, v123
  v_cvt_pk_bf16_f32 v116, v116, v117
  v_cvt_pk_bf16_f32 v117, v118, v119
  v_cvt_pk_bf16_f32 v118, v124, v125
  v_cvt_pk_bf16_f32 v119, v126, v127
  v_mfma_f32_16x16x32_bf16 v[172:175], a[172:175], v[0:3], 0
  ds_read_b64_tr_b16 a[168:169], v233 offset:12672
  s_add_u32 m0, s76, 0xf780
  v_cvt_pk_bf16_f32 v72, v72, v73
  v_cvt_pk_bf16_f32 v73, v74, v75
  v_cvt_pk_bf16_f32 v74, v80, v81
  v_cvt_pk_bf16_f32 v75, v82, v83
  v_mfma_f32_16x16x32_bf16 v[176:179], a[220:223], a[0:3], 0
  buffer_load_dwordx4 v237, s[16:19], s42 offen lds
  ds_read_b64_tr_b16 a[170:171], v233 offset:12928
  v_cvt_pk_bf16_f32 v76, v76, v77
  v_cvt_pk_bf16_f32 v77, v78, v79
  v_cvt_pk_bf16_f32 v78, v84, v85
  v_cvt_pk_bf16_f32 v79, v86, v87
  v_mfma_f32_16x16x32_bf16 v[80:83], a[72:75], v[88:91], 0
  v_cvt_pk_bf16_f32 v128, v128, v129
  v_mfma_f32_16x16x32_bf16 v[84:87], a[80:83], v[88:91], 0
  v_cvt_pk_bf16_f32 v129, v130, v131
  v_mfma_f32_16x16x32_bf16 v[96:99], a[88:91], v[88:91], 0
  v_cvt_pk_bf16_f32 v130, v132, v133
  v_mfma_f32_16x16x32_bf16 v[100:103], a[96:99], v[88:91], 0
  v_cvt_pk_bf16_f32 v131, v134, v135
  v_mfma_f32_16x16x32_bf16 v[120:123], a[104:107], v[88:91], 0
  v_pk_max_i16 v128, v128, 0
  v_mfma_f32_16x16x16_bf16 v[80:83], a[78:79], v[104:105], v[80:83]
  v_pk_max_i16 v129, v129, 0
  v_mfma_f32_16x16x16_bf16 v[84:87], a[86:87], v[104:105], v[84:87]
  v_pk_max_i16 v130, v130, 0
  v_mfma_f32_16x16x16_bf16 v[96:99], a[94:95], v[104:105], v[96:99]
  v_pk_max_i16 v131, v131, 0
  v_mfma_f32_16x16x16_bf16 v[100:103], a[102:103], v[104:105], v[100:103]
  v_cvt_pk_bf16_f32 v136, v136, v137
  v_mfma_f32_16x16x16_bf16 v[120:123], a[110:111], v[104:105], v[120:123]
  v_cvt_pk_bf16_f32 v137, v138, v139
  v_mfma_f32_16x16x32_bf16 v[192:195], a[72:75], v[92:95], 0
  v_cvt_pk_bf16_f32 v138, v140, v141
  v_mfma_f32_16x16x32_bf16 v[196:199], a[80:83], v[92:95], 0
  v_cvt_pk_bf16_f32 v139, v142, v143
  v_mfma_f32_16x16x32_bf16 v[200:203], a[88:91], v[92:95], 0
  v_pk_max_i16 v136, v136, 0
  v_mfma_f32_16x16x32_bf16 v[204:207], a[96:99], v[92:95], 0
  v_pk_max_i16 v137, v137, 0
  v_mfma_f32_16x16x32_bf16 v[208:211], a[104:107], v[92:95], 0
  v_pk_max_i16 v138, v138, 0
  v_mfma_f32_16x16x16_bf16 v[192:195], a[78:79], v[106:107], v[192:195]
  v_pk_max_i16 v139, v139, 0
  v_mfma_f32_16x16x16_bf16 v[196:199], a[86:87], v[106:107], v[196:199]
  v_cvt_pk_bf16_f32 v144, v144, v145
  v_mfma_f32_16x16x16_bf16 v[200:203], a[94:95], v[106:107], v[200:203]
  v_cvt_pk_bf16_f32 v145, v146, v147
  v_mfma_f32_16x16x16_bf16 v[204:207], a[102:103], v[106:107], v[204:207]
  v_cvt_pk_bf16_f32 v146, v148, v149
  v_mfma_f32_16x16x16_bf16 v[208:211], a[110:111], v[106:107], v[208:211]
  v_accvgpr_read_b32 v239, a200
  v_accvgpr_read_b32 v240, a201
  ds_write_b64 v239, v[112:113] offset:0
  ds_write_b64 v239, v[114:115] offset:32
  ds_write_b64 v240, v[104:105] offset:0
  ds_write_b64 v239, v[116:117] offset:1568
  v_mfma_f32_16x16x32_bf16 v[184:187], a[220:223], v[0:3], 0
  ds_read_b64_tr_b16 a[172:173], v233 offset:12704
  ds_write_b64 v239, v[118:119] offset:1600
  ds_write_b64 v240, v[106:107] offset:1568
  v_accvgpr_read_b32 v241, a199
  v_max3_f32 v124, v80, v81, v82
  v_max3_f32 v126, v83, v84, v85
  v_mfma_f32_16x16x32_bf16 v[180:183], a[224:227], a[0:3], 0
  ds_read_b64_tr_b16 a[174:175], v233 offset:12960
  v_max3_f32 v124, v86, v87, v124
  v_max3_f32 v126, v96, v97, v126
  v_max3_f32 v124, v98, v99, v124
  v_max3_f32 v126, v100, v101, v126
  v_max3_f32 v124, v102, v103, v124
  v_mfma_f32_16x16x32_bf16 v[188:191], a[224:227], v[0:3], 0
  ds_read_b64_tr_b16 a[220:221], v233 offset:12736
  v_max3_f32 v126, v120, v121, v126
  v_max_f32_e32 v124, v124, v126
  v_mul_f32_e32 v124, v242, v124
  v_fma_f32 v80, v80, v242, -v124
  v_fma_f32 v81, v81, v242, -v124
  v_mfma_f32_16x16x32_bf16 v[160:163], a[228:231], a[4:7], v[160:163]
  ds_read_b64_tr_b16 a[222:223], v233 offset:12992
  v_fma_f32 v82, v82, v242, -v124
  v_fma_f32 v83, v83, v242, -v124
  v_fma_f32 v84, v84, v242, -v124
  v_fma_f32 v85, v85, v242, -v124
  v_fma_f32 v86, v86, v242, -v124
  v_mfma_f32_16x16x32_bf16 v[168:171], a[228:231], v[4:7], v[168:171]
  ds_read_b64_tr_b16 a[224:225], v233 offset:12768
  s_add_u32 m0, s76, 0x10800
  v_fma_f32 v87, v87, v242, -v124
  v_fma_f32 v96, v96, v242, -v124
  v_fma_f32 v97, v97, v242, -v124
  v_fma_f32 v98, v98, v242, -v124
  v_mfma_f32_16x16x32_bf16 v[164:167], a[232:235], a[4:7], v[164:167]
  buffer_load_dwordx4 v237, s[16:19], s43 offen lds
  ds_read_b64_tr_b16 a[226:227], v233 offset:13024
  v_fma_f32 v99, v99, v242, -v124
  v_fma_f32 v100, v100, v242, -v124
  v_fma_f32 v101, v101, v242, -v124
  v_fma_f32 v102, v102, v242, -v124
  v_mfma_f32_16x16x32_bf16 v[172:175], a[232:235], v[4:7], v[172:175]
  ds_read_b64_tr_b16 a[228:229], v233 offset:16896
  v_fma_f32 v103, v103, v242, -v124
  v_fma_f32 v120, v120, v242, -v124
  v_fma_f32 v121, v121, v242, -v124
  v_accvgpr_read_b32 v124, a184
  s_waitcnt lgkmcnt(3)
  v_mfma_f32_16x16x32_bf16 v[176:179], a[144:147], a[4:7], v[176:179]
  ds_read_b64_tr_b16 a[230:231], v233 offset:17152
  v_exp_f32_e32 v80, v80
  v_exp_f32_e64 v81, v81
  v_cvt_pk_bf16_f32 v147, v150, v151
  v_mfma_f32_16x16x32_bf16 v[184:187], a[144:147], v[4:7], v[184:187]
  ds_read_b64_tr_b16 a[232:233], v233 offset:16928
  v_exp_f32_e32 v82, v82
  v_add_f32_e32 v125, v80, v81
  v_exp_f32_e64 v83, v83
  v_mfma_f32_16x16x32_bf16 v[180:183], a[148:151], a[4:7], v[180:183]
  ds_read_b64_tr_b16 a[234:235], v233 offset:17184
  v_exp_f32_e32 v84, v84
  v_add_f32_e32 v126, v82, v83
  v_exp_f32_e64 v85, v85
  v_mfma_f32_16x16x32_bf16 v[188:191], a[148:151], v[4:7], v[188:191]
  ds_read_b64_tr_b16 a[144:145], v233 offset:16960
  v_add_f32_e32 v125, v84, v125
  v_exp_f32_e32 v86, v86
  v_add_f32_e64 v126, v85, v126
  v_pk_max_i16 v144, v144, 0
  v_mfma_f32_16x16x32_bf16 v[160:163], a[152:155], a[8:11], v[160:163]
  ds_read_b64_tr_b16 a[146:147], v233 offset:17216
  v_exp_f32_e32 v87, v87
  v_add_f32_e32 v125, v86, v125
  v_exp_f32_e64 v96, v96
  v_mfma_f32_16x16x32_bf16 v[168:171], a[152:155], v[8:11], v[168:171]
  ds_read_b64_tr_b16 a[148:149], v233 offset:16992
  s_add_u32 m0, s76, 0x11880
  v_add_f32_e32 v126, v87, v126
  v_exp_f32_e32 v97, v97
  v_add_f32_e64 v125, v96, v125
  v_mfma_f32_16x16x32_bf16 v[164:167], a[156:159], a[8:11], v[164:167]
  buffer_load_dwordx4 v237, s[16:19], s44 offen lds
  ds_read_b64_tr_b16 a[150:151], v233 offset:17248
  v_exp_f32_e32 v98, v98
  v_add_f32_e32 v126, v97, v126
  v_pk_max_i16 v145, v145, 0
  v_mfma_f32_16x16x32_bf16 v[172:175], a[156:159], v[8:11], v[172:175]
  ds_read_b64_tr_b16 a[152:153], v233 offset:21120
  v_exp_f32_e32 v99, v99
  v_add_f32_e32 v125, v98, v125
  v_exp_f32_e64 v100, v100
  v_mfma_f32_16x16x32_bf16 v[176:179], a[160:163], a[8:11], v[176:179]
  ds_read_b64_tr_b16 a[154:155], v233 offset:21376
  v_add_f32_e32 v126, v99, v126
  v_exp_f32_e32 v101, v101
  v_add_f32_e64 v125, v100, v125
  v_pk_max_i16 v146, v146, 0
  v_mfma_f32_16x16x32_bf16 v[184:187], a[160:163], v[8:11], v[184:187]
  ds_read_b64_tr_b16 a[156:157], v233 offset:21152
  v_exp_f32_e32 v102, v102
  v_add_f32_e32 v126, v101, v126
  v_exp_f32_e64 v103, v103
  v_mfma_f32_16x16x32_bf16 v[180:183], a[164:167], a[8:11], v[180:183]
  ds_read_b64_tr_b16 a[158:159], v233 offset:21408
  v_add_f32_e32 v125, v102, v125
  v_exp_f32_e32 v120, v120
  v_add_f32_e64 v126, v103, v126
  v_pk_max_i16 v147, v147, 0
  v_mfma_f32_16x16x32_bf16 v[188:191], a[164:167], v[8:11], v[188:191]
  ds_read_b64_tr_b16 a[160:161], v233 offset:21184
  v_exp_f32_e32 v121, v121
  v_add_f32_e32 v125, v120, v125
  v_add_f32_e32 v125, v125, v126
  v_add_f32_e32 v125, v121, v125
  v_mfma_f32_16x16x32_bf16 v[160:163], a[168:171], a[12:15], v[160:163]
  ds_read_b64_tr_b16 a[162:163], v233 offset:21440
  v_mul_f32_e32 v125, v124, v125
  v_rcp_f32_e32 v126, v125
  v_cvt_pk_bf16_f32 v152, v152, v153
  v_mul_f32_e64 v80, v126, v80
  v_mfma_f32_16x16x32_bf16 v[168:171], a[168:171], v[12:15], v[168:171]
  ds_read_b64_tr_b16 a[164:165], v233 offset:21216
  v_mul_f32_e32 v81, v126, v81
  v_mul_f32_e32 v82, v126, v82
  v_mul_f32_e32 v83, v126, v83
  v_mul_f32_e32 v84, v126, v84
  v_mul_f32_e64 v85, v126, v85
  v_mfma_f32_16x16x32_bf16 v[164:167], a[172:175], a[12:15], v[164:167]
  ds_read_b64_tr_b16 a[166:167], v233 offset:21472
  v_mul_f32_e32 v86, v126, v86
  v_mul_f32_e32 v87, v126, v87
  v_mul_f32_e32 v96, v126, v96
  v_mul_f32_e32 v97, v126, v97
  v_mul_f32_e64 v98, v126, v98
  v_mfma_f32_16x16x32_bf16 v[172:175], a[172:175], v[12:15], v[172:175]
  v_mul_f32_e32 v99, v126, v99
  v_mul_f32_e32 v100, v126, v100
  v_mul_f32_e32 v101, v126, v101
  v_mul_f32_e32 v102, v126, v102
  v_mul_f32_e32 v103, v126, v103
  v_mul_f32_e32 v120, v126, v120
  s_waitcnt vmcnt(14)
  s_barrier
  v_add_u32_e32 v233, 0xfffe7400, v233
  ds_read_b64_tr_b16 a[168:169], v233 offset:0
  v_mfma_f32_16x16x32_bf16 v[176:179], a[220:223], a[12:15], v[176:179]
  ds_read_b64_tr_b16 a[170:171], v233 offset:256
  v_mul_f32_e64 v121, v126, v121
  v_cvt_pk_bf16_f32 v80, v80, v81
  v_cvt_pk_bf16_f32 v81, v82, v83
  v_cvt_pk_bf16_f32 v82, v84, v85
  v_cvt_pk_bf16_f32 v83, v86, v87
  v_mfma_f32_16x16x32_bf16 v[184:187], a[220:223], v[12:15], v[184:187]
  ds_read_b64_tr_b16 a[172:173], v233 offset:32
  s_add_u32 m0, s76, 0x12900
  v_cvt_pk_bf16_f32 v84, v96, v97
  v_cvt_pk_bf16_f32 v85, v98, v99
  v_cvt_pk_bf16_f32 v86, v100, v101
  s_waitcnt lgkmcnt(3)
  s_nop 0
  v_mfma_f32_16x16x32_bf16 v[180:183], a[224:227], a[12:15], v[180:183]
  buffer_load_dwordx4 v237, s[16:19], s45 offen lds
  ds_read_b64_tr_b16 a[174:175], v233 offset:288
  v_cvt_pk_bf16_f32 v87, v102, v103
  v_cvt_pk_bf16_f32 v96, v120, v121
  v_mov_b32_e64 v97, 0
  ds_write_b64 v241, v[80:81] offset:0
  v_mfma_f32_16x16x32_bf16 v[188:191], a[224:227], v[12:15], v[188:191]
  ds_read_b64_tr_b16 a[220:221], v233 offset:64
  s_xor_b32 s37, s96, 0x708000
  buffer_store_dwordx4 a[248:251], v251, s[32:35], s37 offen sc1
  ds_write_b64 v241, v[82:83] offset:8
  ds_write_b64 v241, v[84:85] offset:16
  ds_write_b64 v241, v[86:87] offset:24
  v_mfma_f32_16x16x32_bf16 v[160:163], a[228:231], a[16:19], v[160:163]
  ds_read_b64_tr_b16 a[222:223], v233 offset:320
  ds_write_b64 v241, v[96:97] offset:32
  v_accvgpr_read_b32 v239, a196
  v_accvgpr_read_b32 v240, a202
  v_cvt_pk_bf16_f32 v153, v154, v155
  v_cvt_pk_bf16_f32 v154, v156, v157
  v_mfma_f32_16x16x32_bf16 v[168:171], a[228:231], v[16:19], v[168:171]
  ds_read_b64_tr_b16 a[224:225], v233 offset:96
  v_cvt_pk_bf16_f32 v155, v158, v159
  v_pk_max_i16 v152, v152, 0
  v_pk_max_i16 v153, v153, 0
  v_pk_max_i16 v154, v154, 0
  v_pk_max_i16 v155, v155, 0
  v_mfma_f32_16x16x32_bf16 v[164:167], a[232:235], a[16:19], v[164:167]
  ds_read_b64_tr_b16 a[226:227], v233 offset:352
  v_max3_f32 v116, v192, v193, v194
  v_max3_f32 v118, v195, v196, v197
  v_max3_f32 v116, v198, v199, v116
  v_max3_f32 v118, v200, v201, v118
  v_max3_f32 v116, v202, v203, v116
  v_mfma_f32_16x16x32_bf16 v[172:175], a[232:235], v[16:19], v[172:175]
  ds_read_b64_tr_b16 a[228:229], v233 offset:4224
  s_add_u32 m0, s76, 0x13980
  v_max3_f32 v118, v204, v205, v118
  v_max3_f32 v116, v206, v207, v116
  v_max3_f32 v118, v208, v209, v118
  v_max_f32_e64 v116, v116, v118
  v_mfma_f32_16x16x32_bf16 v[176:179], a[144:147], a[16:19], v[176:179]
  buffer_load_dwordx4 v237, s[16:19], s46 offen lds
  ds_read_b64_tr_b16 a[230:231], v233 offset:4480
  v_mul_f32_e64 v116, v243, v116
  v_fma_f32 v192, v192, v243, -v116
  v_fma_f32 v193, v193, v243, -v116
  v_fma_f32 v194, v194, v243, -v116
  v_mfma_f32_16x16x32_bf16 v[184:187], a[144:147], v[16:19], v[184:187]
  ds_read_b64_tr_b16 a[232:233], v233 offset:4256
  v_fma_f32 v195, v195, v243, -v116
  v_fma_f32 v196, v196, v243, -v116
  v_fma_f32 v197, v197, v243, -v116
  v_fma_f32 v198, v198, v243, -v116
  v_fma_f32 v199, v199, v243, -v116
  v_mfma_f32_16x16x32_bf16 v[180:183], a[148:151], a[16:19], v[180:183]
  ds_read_b64_tr_b16 a[234:235], v233 offset:4512
  v_fma_f32 v200, v200, v243, -v116
  v_fma_f32 v201, v201, v243, -v116
  v_fma_f32 v202, v202, v243, -v116
  v_fma_f32 v203, v203, v243, -v116
  v_fma_f32 v204, v204, v243, -v116
  v_mfma_f32_16x16x32_bf16 v[188:191], a[148:151], v[16:19], v[188:191]
  ds_read_b64_tr_b16 a[144:145], v233 offset:4288
  v_fma_f32 v205, v205, v243, -v116
  v_fma_f32 v206, v206, v243, -v116
  v_fma_f32 v207, v207, v243, -v116
  v_fma_f32 v208, v208, v243, -v116
  v_fma_f32 v209, v209, v243, -v116
  v_mfma_f32_16x16x32_bf16 v[160:163], a[152:155], a[20:23], v[160:163]
  ds_read_b64_tr_b16 a[146:147], v233 offset:4544
  v_accvgpr_read_b32 v116, a185
  v_exp_f32_e32 v192, v192
  v_exp_f32_e32 v193, v193
  v_mfma_f32_16x16x32_bf16 v[168:171], a[152:155], v[20:23], v[168:171]
  ds_read_b64_tr_b16 a[148:149], v233 offset:4320
  v_exp_f32_e32 v194, v194
  v_add_f32_e32 v117, v192, v193
  v_exp_f32_e64 v195, v195
  v_mfma_f32_16x16x32_bf16 v[164:167], a[156:159], a[20:23], v[164:167]
  ds_read_b64_tr_b16 a[150:151], v233 offset:4576
  v_exp_f32_e32 v196, v196
  v_add_f32_e32 v118, v194, v195
  v_exp_f32_e64 v197, v197
  v_mfma_f32_16x16x32_bf16 v[172:175], a[156:159], v[20:23], v[172:175]
  ds_read_b64_tr_b16 a[152:153], v233 offset:8448
  s_add_u32 m0, s76, 0x14a00
  v_add_f32_e32 v117, v196, v117
  v_exp_f32_e32 v198, v198
  v_add_f32_e64 v118, v197, v118
  v_mfma_f32_16x16x32_bf16 v[176:179], a[160:163], a[20:23], v[176:179]
  buffer_load_dwordx4 v237, s[16:19], s47 offen lds
  ds_read_b64_tr_b16 a[154:155], v233 offset:8704
  v_exp_f32_e32 v199, v199
  v_add_f32_e32 v117, v198, v117
  v_mfma_f32_16x16x32_bf16 v[184:187], a[160:163], v[20:23], v[184:187]
  ds_read_b64_tr_b16 a[156:157], v233 offset:8480
  v_exp_f32_e32 v200, v200
  v_add_f32_e32 v118, v199, v118
  v_exp_f32_e64 v201, v201
  v_mfma_f32_16x16x32_bf16 v[180:183], a[164:167], a[20:23], v[180:183]
  ds_read_b64_tr_b16 a[158:159], v233 offset:8736
  v_add_f32_e32 v117, v200, v117
  v_exp_f32_e32 v202, v202
  v_add_f32_e64 v118, v201, v118
  v_mfma_f32_16x16x32_bf16 v[188:191], a[164:167], v[20:23], v[188:191]
  ds_read_b64_tr_b16 a[160:161], v233 offset:8512
  v_exp_f32_e32 v203, v203
  v_add_f32_e32 v117, v202, v117
  s_waitcnt lgkmcnt(4)
  v_mfma_f32_16x16x32_bf16 v[160:163], a[168:171], a[24:27], v[160:163]
  ds_read_b64_tr_b16 a[162:163], v233 offset:8768
  v_exp_f32_e32 v204, v204
  v_add_f32_e32 v118, v203, v118
  v_exp_f32_e32 v205, v205
  v_mfma_f32_16x16x32_bf16 v[168:171], a[168:171], v[24:27], v[168:171]
  ds_read_b64_tr_b16 a[164:165], v233 offset:8544
  v_add_f32_e32 v117, v204, v117
  v_exp_f32_e32 v206, v206
  v_add_f32_e64 v118, v205, v118
  v_mfma_f32_16x16x32_bf16 v[164:167], a[172:175], a[24:27], v[164:167]
  ds_read_b64_tr_b16 a[166:167], v233 offset:8800
  v_exp_f32_e32 v207, v207
  v_add_f32_e32 v117, v206, v117
  v_exp_f32_e64 v208, v208
  v_mfma_f32_16x16x32_bf16 v[172:175], a[172:175], v[24:27], v[172:175]
  ds_read_b64_tr_b16 a[168:169], v233 offset:12672
  s_add_u32 m0, s76, 0x15a80
  v_add_f32_e32 v118, v207, v118
  v_exp_f32_e32 v209, v209
  v_add_f32_e64 v117, v208, v117
  v_mfma_f32_16x16x32_bf16 v[176:179], a[220:223], a[24:27], v[176:179]
  buffer_load_dwordx4 v237, s[16:19], s48 offen lds
  ds_read_b64_tr_b16 a[170:171], v233 offset:12928
  v_add_f32_e32 v117, v117, v118
  v_add_f32_e32 v117, v209, v117
  v_mul_f32_e64 v117, v116, v117
  v_mfma_f32_16x16x32_bf16 v[184:187], a[220:223], v[24:27], v[184:187]
  ds_read_b64_tr_b16 a[172:173], v233 offset:12704
  v_rcp_f32_e64 v118, v117
  v_mfma_f32_16x16x32_bf16 v[180:183], a[224:227], a[24:27], v[180:183]
  ds_read_b64_tr_b16 a[174:175], v233 offset:12960
  v_mul_f32_e32 v192, v118, v192
  v_mul_f32_e32 v193, v118, v193
  v_mul_f32_e32 v194, v118, v194
  v_mul_f32_e32 v195, v118, v195
  v_mul_f32_e64 v196, v118, v196
  v_mfma_f32_16x16x32_bf16 v[188:191], a[224:227], v[24:27], v[188:191]
  ds_read_b64_tr_b16 a[220:221], v233 offset:12736
  v_mul_f32_e32 v197, v118, v197
  v_mul_f32_e32 v198, v118, v198
  v_mul_f32_e32 v199, v118, v199
  v_mul_f32_e32 v200, v118, v200
  v_mul_f32_e64 v201, v118, v201
  v_mfma_f32_16x16x32_bf16 v[160:163], a[228:231], a[28:31], v[160:163]
  ds_read_b64_tr_b16 a[222:223], v233 offset:12992
  v_mul_f32_e32 v202, v118, v202
  v_mul_f32_e32 v203, v118, v203
  v_mul_f32_e32 v204, v118, v204
  v_mul_f32_e32 v205, v118, v205
  v_mul_f32_e64 v206, v118, v206
  v_mfma_f32_16x16x32_bf16 v[168:171], a[228:231], v[28:31], v[168:171]
  ds_read_b64_tr_b16 a[224:225], v233 offset:12768
  s_add_u32 m0, s76, 0x16b00
  v_mul_f32_e32 v207, v118, v207
  v_mul_f32_e32 v208, v118, v208
  v_mul_f32_e64 v209, v118, v209
  v_cvt_pk_bf16_f32 v192, v192, v193
  v_mfma_f32_16x16x32_bf16 v[164:167], a[232:235], a[28:31], v[164:167]
  buffer_load_dwordx4 v237, s[16:19], s49 offen lds
  ds_read_b64_tr_b16 a[226:227], v233 offset:13024
  v_cvt_pk_bf16_f32 v193, v194, v195
  v_cvt_pk_bf16_f32 v194, v196, v197
  v_cvt_pk_bf16_f32 v195, v198, v199
  v_cvt_pk_bf16_f32 v196, v200, v201
  v_mfma_f32_16x16x32_bf16 v[172:175], a[232:235], v[28:31], v[172:175]
  ds_read_b64_tr_b16 a[228:229], v233 offset:16896
  v_cvt_pk_bf16_f32 v197, v202, v203
  v_cvt_pk_bf16_f32 v198, v204, v205
  v_cvt_pk_bf16_f32 v199, v206, v207
  v_cvt_pk_bf16_f32 v200, v208, v209
  v_mov_b32_e64 v201, 0
  v_mfma_f32_16x16x32_bf16 v[176:179], a[144:147], a[28:31], v[176:179]
  ds_read_b64_tr_b16 a[230:231], v233 offset:17152
  ds_write_b64 v241, v[192:193] offset:2592
  ds_write_b64 v241, v[194:195] offset:2600
  ds_write_b64 v241, v[196:197] offset:2608
  ds_write_b64 v241, v[198:199] offset:2616
  ds_write_b64 v241, v[200:201] offset:2624
  v_mfma_f32_16x16x32_bf16 v[212:215], a[72:75], v[72:75], 0
  v_mfma_f32_16x16x32_bf16 v[184:187], a[144:147], v[28:31], v[184:187]
  ds_read_b64_tr_b16 a[232:233], v233 offset:16928
  v_mfma_f32_16x16x32_bf16 v[216:219], a[80:83], v[72:75], 0
  v_mfma_f32_16x16x32_bf16 v[180:183], a[148:151], a[28:31], v[180:183]
  ds_read_b64_tr_b16 a[234:235], v233 offset:17184
  v_mfma_f32_16x16x32_bf16 v[220:223], a[88:91], v[72:75], 0
  v_mfma_f32_16x16x32_bf16 v[188:191], a[148:151], v[28:31], v[188:191]
  ds_read_b64_tr_b16 a[144:145], v233 offset:16960
  s_xor_b32 s37, s96, 0x708000
  buffer_store_dwordx4 a[248:251], v251, s[32:35], s37 offen offset:1024 sc1
  v_mfma_f32_16x16x32_bf16 v[224:227], a[96:99], v[72:75], 0
  s_waitcnt lgkmcnt(3)
  s_nop 0
  v_mfma_f32_16x16x32_bf16 v[160:163], a[152:155], a[32:35], v[160:163]
  ds_read_b64_tr_b16 a[146:147], v233 offset:17216
  v_mfma_f32_16x16x32_bf16 v[228:231], a[104:107], v[72:75], 0
  v_mfma_f32_16x16x32_bf16 v[168:171], a[152:155], v[32:35], v[168:171]
  ds_read_b64_tr_b16 a[148:149], v233 offset:16992
  s_add_u32 m0, s76, 0x17b80
  v_mfma_f32_16x16x16_bf16 v[212:215], a[76:77], v[104:105], v[212:215]
  v_mfma_f32_16x16x32_bf16 v[164:167], a[156:159], a[32:35], v[164:167]
  buffer_load_dwordx4 v237, s[16:19], s50 offen lds
  ds_read_b64_tr_b16 a[150:151], v233 offset:17248
  v_mfma_f32_16x16x16_bf16 v[216:219], a[84:85], v[104:105], v[216:219]
  v_mfma_f32_16x16x32_bf16 v[172:175], a[156:159], v[32:35], v[172:175]
  ds_read_b64_tr_b16 a[152:153], v233 offset:21120
  v_mfma_f32_16x16x16_bf16 v[220:223], a[92:93], v[104:105], v[220:223]
  v_mfma_f32_16x16x32_bf16 v[176:179], a[160:163], a[32:35], v[176:179]
  ds_read_b64_tr_b16 a[154:155], v233 offset:21376
  v_mfma_f32_16x16x16_bf16 v[224:227], a[100:101], v[104:105], v[224:227]
  v_mfma_f32_16x16x32_bf16 v[184:187], a[160:163], v[32:35], v[184:187]
  ds_read_b64_tr_b16 a[156:157], v233 offset:21152
  v_mfma_f32_16x16x16_bf16 v[228:231], a[108:109], v[104:105], v[228:231]
  v_max3_f32 v116, v212, v213, v214
  v_max3_f32 v118, v215, v216, v217
  v_max3_f32 v116, v218, v219, v116
  v_max3_f32 v118, v220, v221, v118
  v_max3_f32 v116, v222, v223, v116
  v_max3_f32 v118, v224, v225, v118
  v_mfma_f32_16x16x32_bf16 v[180:183], a[164:167], a[32:35], v[180:183]
  ds_read_b64_tr_b16 a[158:159], v233 offset:21408
  v_max3_f32 v116, v226, v227, v116
  v_max3_f32 v118, v228, v229, v118
  v_max_f32_e32 v116, v116, v118
  v_mul_f32_e32 v116, v242, v116
  v_fma_f32 v212, v212, v242, -v116
  v_mfma_f32_16x16x32_bf16 v[188:191], a[164:167], v[32:35], v[188:191]
  ds_read_b64_tr_b16 a[160:161], v233 offset:21184
  v_fma_f32 v213, v213, v242, -v116
  v_fma_f32 v214, v214, v242, -v116
  v_fma_f32 v215, v215, v242, -v116
  v_fma_f32 v216, v216, v242, -v116
  v_fma_f32 v217, v217, v242, -v116
  v_mfma_f32_16x16x32_bf16 v[160:163], a[168:171], a[36:39], v[160:163]
  ds_read_b64_tr_b16 a[162:163], v233 offset:21440
  v_fma_f32 v218, v218, v242, -v116
  v_fma_f32 v219, v219, v242, -v116
  v_fma_f32 v220, v220, v242, -v116
  v_fma_f32 v221, v221, v242, -v116
  v_fma_f32 v222, v222, v242, -v116
  v_mfma_f32_16x16x32_bf16 v[168:171], a[168:171], v[36:39], v[168:171]
  ds_read_b64_tr_b16 a[164:165], v233 offset:21216
  v_fma_f32 v223, v223, v242, -v116
  v_fma_f32 v224, v224, v242, -v116
  v_fma_f32 v225, v225, v242, -v116
  v_fma_f32 v226, v226, v242, -v116
  v_fma_f32 v227, v227, v242, -v116
  v_mfma_f32_16x16x32_bf16 v[164:167], a[172:175], a[36:39], v[164:167]
  ds_read_b64_tr_b16 a[166:167], v233 offset:21472
  v_fma_f32 v228, v228, v242, -v116
  v_fma_f32 v229, v229, v242, -v116
  v_exp_f32_e64 v212, v212
  v_mfma_f32_16x16x32_bf16 v[172:175], a[172:175], v[36:39], v[172:175]
  v_exp_f32_e32 v213, v213
  v_exp_f32_e32 v214, v214
  v_add_f32_e64 v117, v212, v213
  s_waitcnt vmcnt(16)
  s_barrier
  v_add_u32_e32 v233, 0x6300, v233
  ds_read_b64_tr_b16 a[168:169], v233 offset:0
  v_mfma_f32_16x16x32_bf16 v[176:179], a[220:223], a[36:39], v[176:179]
  ds_read_b64_tr_b16 a[170:171], v233 offset:256
  ds_read_b64_tr_b16 a[112:113], v240 offset:0
  ds_read_b64_tr_b16 a[114:115], v240 offset:1568
  ds_read_b64_tr_b16 a[116:117], v239 offset:0
  ds_read_b64_tr_b16 a[118:119], v239 offset:2592
  ds_read_b64_tr_b16 a[120:121], v239 offset:32
  v_mfma_f32_16x16x32_bf16 v[184:187], a[220:223], v[36:39], v[184:187]
  ds_read_b64_tr_b16 a[172:173], v233 offset:32
  s_add_u32 m0, s76, 0x18c00
  ds_read_b64_tr_b16 a[122:123], v239 offset:2624
  ds_read_b64_tr_b16 a[124:125], v239 offset:64
  ds_read_b64_tr_b16 a[126:127], v239 offset:2656
  ds_read_b64_tr_b16 a[128:129], v240 offset:3136
  v_mfma_f32_16x16x32_bf16 v[180:183], a[224:227], a[36:39], v[180:183]
  buffer_load_dwordx4 v237, s[16:19], s51 offen lds
  ds_read_b64_tr_b16 a[174:175], v233 offset:288
  ds_read_b64_tr_b16 a[130:131], v240 offset:4704
  ds_read_b64_tr_b16 a[132:133], v239 offset:5184
  ds_read_b64_tr_b16 a[134:135], v239 offset:7776
  ds_read_b64_tr_b16 a[136:137], v239 offset:5216
  v_mfma_f32_16x16x32_bf16 v[188:191], a[224:227], v[36:39], v[188:191]
  ds_read_b64_tr_b16 a[220:221], v233 offset:64
  ds_read_b64_tr_b16 a[138:139], v239 offset:7808
  ds_read_b64_tr_b16 a[140:141], v239 offset:5248
  ds_read_b64_tr_b16 a[142:143], v239 offset:7840
  v_exp_f32_e64 v215, v215
  v_mfma_f32_16x16x32_bf16 v[160:163], a[228:231], a[40:43], v[160:163]
  ds_read_b64_tr_b16 a[222:223], v233 offset:320
  s_waitcnt lgkmcnt(15)
  v_mfma_f32_16x16x32_bf16 v[108:111], a[116:119], a[112:115], 0
  v_exp_f32_e32 v216, v216
  s_waitcnt lgkmcnt(13)
  v_mfma_f32_16x16x32_bf16 v[124:127], a[120:123], a[112:115], 0
  v_add_f32_e32 v118, v214, v215
  s_waitcnt lgkmcnt(10)
  s_nop 0
  v_mfma_f32_16x16x32_bf16 v[208:211], a[124:127], a[112:115], 0
  ds_read_b64_tr_b16 a[112:113], v240 offset:6272
  ds_read_b64_tr_b16 a[114:115], v240 offset:7840
  ds_read_b64_tr_b16 a[116:117], v239 offset:10368
  ds_read_b64_tr_b16 a[118:119], v239 offset:12960
  ds_read_b64_tr_b16 a[120:121], v239 offset:10400
  ds_read_b64_tr_b16 a[122:123], v239 offset:12992
  v_mfma_f32_16x16x32_bf16 v[168:171], a[228:231], v[40:43], v[168:171]
  ds_read_b64_tr_b16 a[224:225], v233 offset:96
  ds_read_b64_tr_b16 a[124:125], v239 offset:10432
  ds_read_b64_tr_b16 a[126:127], v239 offset:13024
  s_waitcnt lgkmcnt(10)
  v_mfma_f32_16x16x32_bf16 v[108:111], a[132:135], a[128:131], v[108:111]
  v_exp_f32_e32 v217, v217
  v_mfma_f32_16x16x32_bf16 v[124:127], a[136:139], a[128:131], v[124:127]
  v_add_f32_e64 v117, v216, v117
  v_mfma_f32_16x16x32_bf16 v[208:211], a[140:143], a[128:131], v[208:211]
  ds_read_b64_tr_b16 a[128:129], v240 offset:9408
  ds_read_b64_tr_b16 a[130:131], v240 offset:10976
  ds_read_b64_tr_b16 a[132:133], v239 offset:15552
  ds_read_b64_tr_b16 a[134:135], v239 offset:18144
  ds_read_b64_tr_b16 a[136:137], v239 offset:15584
  ds_read_b64_tr_b16 a[138:139], v239 offset:18176
  v_mfma_f32_16x16x32_bf16 v[164:167], a[232:235], a[40:43], v[164:167]
  ds_read_b64_tr_b16 a[226:227], v233 offset:352
  ds_read_b64_tr_b16 a[140:141], v239 offset:15616
  ds_read_b64_tr_b16 a[142:143], v239 offset:18208
  s_waitcnt lgkmcnt(12)
  v_mfma_f32_16x16x32_bf16 v[108:111], a[116:119], a[112:115], v[108:111]
  v_exp_f32_e32 v218, v218
  v_mfma_f32_16x16x32_bf16 v[124:127], a[120:123], a[112:115], v[124:127]
  v_add_f32_e32 v118, v217, v118
  s_waitcnt lgkmcnt(9)
  v_mfma_f32_16x16x32_bf16 v[208:211], a[124:127], a[112:115], v[208:211]
  v_exp_f32_e32 v219, v219
  v_add_f32_e32 v117, v218, v117
  v_exp_f32_e32 v220, v220
  v_add_f32_e32 v118, v219, v118
  v_mfma_f32_16x16x32_bf16 v[172:175], a[232:235], v[40:43], v[172:175]
  ds_read_b64_tr_b16 a[228:229], v233 offset:4224
  s_add_u32 m0, s76, 0x19c80
  s_waitcnt lgkmcnt(5)
  v_mfma_f32_16x16x32_bf16 v[108:111], a[132:135], a[128:131], v[108:111]
  v_exp_f32_e32 v221, v221
  s_waitcnt lgkmcnt(2)
  v_mfma_f32_16x16x32_bf16 v[124:127], a[136:139], a[128:131], v[124:127]
  v_add_f32_e32 v117, v220, v117
  s_waitcnt lgkmcnt(1)
  v_mfma_f32_16x16x32_bf16 v[208:211], a[140:143], a[128:131], v[208:211]
  v_accvgpr_read_b32 v239, a188
  s_lshl_b32 s100, s4, 4
  s_add_u32 s100, s100, s5
  s_lshl_b32 s101, s100, 13
  s_add_u32 s101, s101, 0x80000
  buffer_store_dwordx4 v[108:111], v239, s[32:35], s101 offen sc1
  v_mfma_f32_16x16x32_bf16 v[176:179], a[144:147], a[40:43], v[176:179]
  buffer_load_dwordx4 v237, s[16:19], s52 offen lds
  ds_read_b64_tr_b16 a[230:231], v233 offset:4480
  buffer_store_dwordx4 v[124:127], v239, s[32:35], s101 offen offset:64 sc1
  buffer_store_dwordx4 v[208:211], v239, s[32:35], s101 offen offset:128 sc1
  v_exp_f32_e64 v222, v222
  v_mfma_f32_16x16x32_bf16 v[184:187], a[144:147], v[40:43], v[184:187]
  ds_read_b64_tr_b16 a[232:233], v233 offset:4256
  v_add_f32_e32 v118, v221, v118
  v_exp_f32_e32 v223, v223
  v_add_f32_e64 v117, v222, v117
  v_mfma_f32_16x16x32_bf16 v[180:183], a[148:151], a[40:43], v[180:183]
  ds_read_b64_tr_b16 a[234:235], v233 offset:4512
  v_exp_f32_e32 v224, v224
  v_add_f32_e32 v118, v223, v118
  v_exp_f32_e64 v225, v225
  v_mfma_f32_16x16x32_bf16 v[188:191], a[148:151], v[40:43], v[188:191]
  ds_read_b64_tr_b16 a[144:145], v233 offset:4288
  s_xor_b32 s37, s96, 0x70c000
  buffer_store_dwordx4 a[248:251], v251, s[32:35], s37 offen sc1
  v_add_f32_e32 v117, v224, v117
  v_exp_f32_e32 v226, v226
  v_mfma_f32_16x16x32_bf16 v[160:163], a[152:155], a[44:47], v[160:163]
  ds_read_b64_tr_b16 a[146:147], v233 offset:4544
  v_add_f32_e32 v118, v225, v118
  v_exp_f32_e32 v227, v227
  v_add_f32_e64 v117, v226, v117
  v_mfma_f32_16x16x32_bf16 v[168:171], a[152:155], v[44:47], v[168:171]
  ds_read_b64_tr_b16 a[148:149], v233 offset:4320
  v_exp_f32_e32 v228, v228
  v_add_f32_e32 v118, v227, v118
  v_exp_f32_e64 v229, v229
  v_mfma_f32_16x16x32_bf16 v[164:167], a[156:159], a[44:47], v[164:167]
  ds_read_b64_tr_b16 a[150:151], v233 offset:4576
  v_add_f32_e32 v117, v228, v117
  v_add_f32_e32 v117, v117, v118
  v_add_f32_e32 v117, v229, v117
  v_rcp_f32_e32 v118, v117
  v_mfma_f32_16x16x32_bf16 v[172:175], a[156:159], v[44:47], v[172:175]
  ds_read_b64_tr_b16 a[152:153], v233 offset:8448
  s_add_u32 m0, s76, 0x1ad00
  v_mul_f32_e32 v212, v118, v212
  v_mul_f32_e32 v213, v118, v213
  v_mul_f32_e32 v214, v118, v214
  v_mul_f32_e32 v215, v118, v215
  v_mfma_f32_16x16x32_bf16 v[176:179], a[160:163], a[44:47], v[176:179]
  buffer_load_dwordx4 v237, s[16:19], s53 offen lds
  ds_read_b64_tr_b16 a[154:155], v233 offset:8704
  v_mul_f32_e32 v216, v118, v216
  v_mul_f32_e32 v217, v118, v217
  v_mul_f32_e32 v218, v118, v218
  v_mul_f32_e32 v219, v118, v219
  v_mfma_f32_16x16x32_bf16 v[184:187], a[160:163], v[44:47], v[184:187]
  ds_read_b64_tr_b16 a[156:157], v233 offset:8480
  v_mul_f32_e32 v220, v118, v220
  v_mul_f32_e32 v221, v118, v221
  v_mul_f32_e32 v222, v118, v222
  v_mul_f32_e32 v223, v118, v223
  v_mul_f32_e64 v224, v118, v224
  v_mfma_f32_16x16x32_bf16 v[180:183], a[164:167], a[44:47], v[180:183]
  ds_read_b64_tr_b16 a[158:159], v233 offset:8736
  v_mul_f32_e32 v225, v118, v225
  v_mul_f32_e32 v226, v118, v226
  v_mul_f32_e32 v227, v118, v227
  v_mul_f32_e32 v228, v118, v228
  v_mul_f32_e64 v229, v118, v229
  v_mfma_f32_16x16x32_bf16 v[188:191], a[164:167], v[44:47], v[188:191]
  ds_read_b64_tr_b16 a[160:161], v233 offset:8512
  v_cvt_pk_bf16_f32 v88, v212, v213
  v_cvt_pk_bf16_f32 v89, v214, v215
  v_mfma_f32_16x16x32_bf16 v[160:163], a[168:171], a[48:51], v[160:163]
  ds_read_b64_tr_b16 a[162:163], v233 offset:8768
  v_cvt_pk_bf16_f32 v90, v216, v217
  v_cvt_pk_bf16_f32 v91, v218, v219
  v_mfma_f32_16x16x32_bf16 v[168:171], a[168:171], v[48:51], v[168:171]
  ds_read_b64_tr_b16 a[164:165], v233 offset:8544
  v_cvt_pk_bf16_f32 v92, v220, v221
  v_cvt_pk_bf16_f32 v93, v222, v223
  v_mfma_f32_16x16x32_bf16 v[164:167], a[172:175], a[48:51], v[164:167]
  ds_read_b64_tr_b16 a[166:167], v233 offset:8800
  v_cvt_pk_bf16_f32 v94, v224, v225
  v_cvt_pk_bf16_f32 v95, v226, v227
  v_mfma_f32_16x16x32_bf16 v[172:175], a[172:175], v[48:51], v[172:175]
  ds_read_b64_tr_b16 a[168:169], v233 offset:12672
  s_add_u32 m0, s76, 0x1bd80
  v_cvt_pk_bf16_f32 v112, v228, v229
  v_mfma_f32_16x16x32_bf16 v[176:179], a[220:223], a[48:51], v[176:179]
  buffer_load_dwordx4 v237, s[16:19], s54 offen lds
  ds_read_b64_tr_b16 a[170:171], v233 offset:12928
  v_mov_b32_e64 v113, 0
  v_mfma_f32_16x16x32_bf16 v[80:83], a[72:75], v[76:79], 0
  v_mfma_f32_16x16x32_bf16 v[184:187], a[220:223], v[48:51], v[184:187]
  ds_read_b64_tr_b16 a[172:173], v233 offset:12704
  v_mfma_f32_16x16x32_bf16 v[84:87], a[80:83], v[76:79], 0
  v_mfma_f32_16x16x32_bf16 v[180:183], a[224:227], a[48:51], v[180:183]
  ds_read_b64_tr_b16 a[174:175], v233 offset:12960
  v_mfma_f32_16x16x32_bf16 v[96:99], a[88:91], v[76:79], 0
  v_mfma_f32_16x16x32_bf16 v[188:191], a[224:227], v[48:51], v[188:191]
  ds_read_b64_tr_b16 a[220:221], v233 offset:12736
  v_mfma_f32_16x16x32_bf16 v[100:103], a[96:99], v[76:79], 0
  s_waitcnt lgkmcnt(3)
  s_nop 0
  v_mfma_f32_16x16x32_bf16 v[160:163], a[228:231], a[52:55], v[160:163]
  ds_read_b64_tr_b16 a[222:223], v233 offset:12992
  v_mfma_f32_16x16x32_bf16 v[120:123], a[104:107], v[76:79], 0
  v_mfma_f32_16x16x32_bf16 v[168:171], a[228:231], v[52:55], v[168:171]
  ds_read_b64_tr_b16 a[224:225], v233 offset:12768
  s_add_u32 m0, s76, 0x1ce00
  v_mfma_f32_16x16x16_bf16 v[80:83], a[76:77], v[106:107], v[80:83]
  v_mfma_f32_16x16x32_bf16 v[164:167], a[232:235], a[52:55], v[164:167]
  buffer_load_dwordx4 v237, s[16:19], s55 offen lds
  ds_read_b64_tr_b16 a[226:227], v233 offset:13024
  v_mfma_f32_16x16x16_bf16 v[84:87], a[84:85], v[106:107], v[84:87]
  v_mfma_f32_16x16x32_bf16 v[172:175], a[232:235], v[52:55], v[172:175]
  ds_read_b64_tr_b16 a[228:229], v233 offset:16896
  v_mfma_f32_16x16x16_bf16 v[96:99], a[92:93], v[106:107], v[96:99]
  v_mfma_f32_16x16x32_bf16 v[176:179], a[144:147], a[52:55], v[176:179]
  ds_read_b64_tr_b16 a[230:231], v233 offset:17152
  v_mfma_f32_16x16x16_bf16 v[100:103], a[100:101], v[106:107], v[100:103]
  v_mfma_f32_16x16x32_bf16 v[184:187], a[144:147], v[52:55], v[184:187]
  ds_read_b64_tr_b16 a[232:233], v233 offset:16928
  v_mfma_f32_16x16x16_bf16 v[120:123], a[108:109], v[106:107], v[120:123]
  v_max3_f32 v116, v80, v81, v82
  v_max3_f32 v118, v83, v84, v85
  v_max3_f32 v116, v86, v87, v116
  v_mfma_f32_16x16x32_bf16 v[180:183], a[148:151], a[52:55], v[180:183]
  ds_read_b64_tr_b16 a[234:235], v233 offset:17184
  v_max3_f32 v118, v96, v97, v118
  v_max3_f32 v116, v98, v99, v116
  v_mfma_f32_16x16x32_bf16 v[188:191], a[148:151], v[52:55], v[188:191]
  ds_read_b64_tr_b16 a[144:145], v233 offset:16960
  v_max3_f32 v118, v100, v101, v118
  v_max3_f32 v116, v102, v103, v116
  v_mfma_f32_16x16x32_bf16 v[160:163], a[152:155], a[56:59], v[160:163]
  ds_read_b64_tr_b16 a[146:147], v233 offset:17216
  v_max3_f32 v118, v120, v121, v118
  v_max_f32_e64 v116, v116, v118
  v_mfma_f32_16x16x32_bf16 v[168:171], a[152:155], v[56:59], v[168:171]
  ds_read_b64_tr_b16 a[148:149], v233 offset:16992
  s_add_u32 m0, s76, 0x1de80
  v_mul_f32_e64 v116, v243, v116
  v_mfma_f32_16x16x32_bf16 v[164:167], a[156:159], a[56:59], v[164:167]
  buffer_load_dwordx4 v237, s[16:19], s56 offen lds
  ds_read_b64_tr_b16 a[150:151], v233 offset:17248
  v_fma_f32 v80, v80, v243, -v116
  v_mfma_f32_16x16x32_bf16 v[172:175], a[156:159], v[56:59], v[172:175]
  ds_read_b64_tr_b16 a[152:153], v233 offset:21120
  v_fma_f32 v81, v81, v243, -v116
  v_fma_f32 v82, v82, v243, -v116
  v_mfma_f32_16x16x32_bf16 v[176:179], a[160:163], a[56:59], v[176:179]
  ds_read_b64_tr_b16 a[154:155], v233 offset:21376
  v_fma_f32 v83, v83, v243, -v116
  v_fma_f32 v84, v84, v243, -v116
  v_mfma_f32_16x16x32_bf16 v[184:187], a[160:163], v[56:59], v[184:187]
  ds_read_b64_tr_b16 a[156:157], v233 offset:21152
  v_fma_f32 v85, v85, v243, -v116
  v_fma_f32 v86, v86, v243, -v116
  v_mfma_f32_16x16x32_bf16 v[180:183], a[164:167], a[56:59], v[180:183]
  ds_read_b64_tr_b16 a[158:159], v233 offset:21408
  v_fma_f32 v87, v87, v243, -v116
  v_fma_f32 v96, v96, v243, -v116
  v_mfma_f32_16x16x32_bf16 v[188:191], a[164:167], v[56:59], v[188:191]
  ds_read_b64_tr_b16 a[160:161], v233 offset:21184
  s_xor_b32 s37, s96, 0x70c000
  buffer_store_dwordx4 a[248:251], v251, s[32:35], s37 offen offset:1024 sc1
  v_mfma_f32_16x16x32_bf16 v[160:163], a[168:171], a[60:63], v[160:163]
  ds_read_b64_tr_b16 a[162:163], v233 offset:21440
  v_fma_f32 v97, v97, v243, -v116
  v_fma_f32 v98, v98, v243, -v116
  v_mfma_f32_16x16x32_bf16 v[168:171], a[168:171], v[60:63], v[168:171]
  ds_read_b64_tr_b16 a[164:165], v233 offset:21216
  v_fma_f32 v99, v99, v243, -v116
  s_waitcnt lgkmcnt(6)
  s_nop 0
  v_mfma_f32_16x16x32_bf16 v[164:167], a[172:175], a[60:63], v[164:167]
  ds_read_b64_tr_b16 a[166:167], v233 offset:21472
  v_fma_f32 v100, v100, v243, -v116
  v_fma_f32 v101, v101, v243, -v116
  v_mfma_f32_16x16x32_bf16 v[172:175], a[172:175], v[60:63], v[172:175]
  v_fma_f32 v102, v102, v243, -v116
  v_fma_f32 v103, v103, v243, -v116
  v_fma_f32 v120, v120, v243, -v116
  s_waitcnt vmcnt(19)
  s_barrier
  v_add_u32_e32 v233, 0x6300, v233
  ds_read_b64_tr_b16 a[168:169], v233 offset:0
  v_mfma_f32_16x16x32_bf16 v[176:179], a[220:223], a[60:63], v[176:179]
  ds_read_b64_tr_b16 a[170:171], v233 offset:256
  v_fma_f32 v121, v121, v243, -v116
  v_mfma_f32_16x16x32_bf16 v[184:187], a[220:223], v[60:63], v[184:187]
  ds_read_b64_tr_b16 a[172:173], v233 offset:32
  s_add_u32 m0, s76, 0
  s_nop 0
  v_add_u32_e32 v237, 0x80, v237
  v_mfma_f32_16x16x32_bf16 v[180:183], a[224:227], a[60:63], v[180:183]
  buffer_load_dwordx4 v237, s[16:19], s0 offen lds
  ds_read_b64_tr_b16 a[174:175], v233 offset:288
  v_mfma_f32_16x16x32_bf16 v[188:191], a[224:227], v[60:63], v[188:191]
  ds_read_b64_tr_b16 a[220:221], v233 offset:64
  v_accvgpr_read_b32 v239, a216
  s_lshl_b32 s100, s4, 9
  s_nop 0
  v_mfma_f32_16x16x32_bf16 v[160:163], a[228:231], a[64:67], v[160:163]
  ds_read_b64_tr_b16 a[222:223], v233 offset:320
  s_add_u32 s100, s100, 0x1000
  buffer_load_dwordx2 v[246:247], v239, s[32:35], s100 offen sc1
  v_mfma_f32_16x16x32_bf16 v[168:171], a[228:231], v[64:67], v[168:171]
  ds_read_b64_tr_b16 a[224:225], v233 offset:96
  v_exp_f32_e64 v80, v80
  v_mfma_f32_16x16x32_bf16 v[164:167], a[232:235], a[64:67], v[164:167]
  ds_read_b64_tr_b16 a[226:227], v233 offset:352
  v_exp_f32_e64 v81, v81
  v_mfma_f32_16x16x32_bf16 v[172:175], a[232:235], v[64:67], v[172:175]
  ds_read_b64_tr_b16 a[228:229], v233 offset:4224
  s_add_u32 m0, s76, 0x1080
  v_mfma_f32_16x16x32_bf16 v[176:179], a[144:147], a[64:67], v[176:179]
  buffer_load_dwordx4 v237, s[16:19], s40 offen lds
  ds_read_b64_tr_b16 a[230:231], v233 offset:4480
  v_mfma_f32_16x16x32_bf16 v[184:187], a[144:147], v[64:67], v[184:187]
  ds_read_b64_tr_b16 a[232:233], v233 offset:4256
  v_exp_f32_e64 v82, v82
  v_mfma_f32_16x16x32_bf16 v[180:183], a[148:151], a[64:67], v[180:183]
  ds_read_b64_tr_b16 a[234:235], v233 offset:4512
  v_add_f32_e64 v117, v80, v81
  v_mfma_f32_16x16x32_bf16 v[188:191], a[148:151], v[64:67], v[188:191]
  ds_read_b64_tr_b16 a[144:145], v233 offset:4288
  s_waitcnt lgkmcnt(6)
  v_mfma_f32_16x16x32_bf16 v[160:163], a[152:155], a[68:71], v[160:163]
  ds_read_b64_tr_b16 a[146:147], v233 offset:4544
  v_exp_f32_e32 v83, v83
  v_mfma_f32_16x16x32_bf16 v[168:171], a[152:155], v[68:71], v[168:171]
  ds_read_b64_tr_b16 a[148:149], v233 offset:4320
  v_exp_f32_e64 v84, v84
  v_mfma_f32_16x16x32_bf16 v[164:167], a[156:159], a[68:71], v[164:167]
  ds_read_b64_tr_b16 a[150:151], v233 offset:4576
  v_add_f32_e64 v118, v82, v83
  v_cvt_pk_bf16_f32 v160, v160, v161
  v_mfma_f32_16x16x32_bf16 v[172:175], a[156:159], v[68:71], v[172:175]
  ds_read_b64_tr_b16 a[152:153], v233 offset:8448
  s_add_u32 m0, s76, 0x4200
  v_cvt_pk_bf16_f32 v161, v162, v163
  v_mfma_f32_16x16x32_bf16 v[176:179], a[160:163], a[68:71], v[176:179]
  buffer_load_dwordx4 v244, s[16:19], s0 offen lds
  ds_read_b64_tr_b16 a[154:155], v233 offset:8704
  v_cvt_pk_bf16_f32 v162, v164, v165
  v_mfma_f32_16x16x32_bf16 v[184:187], a[160:163], v[68:71], v[184:187]
  ds_read_b64_tr_b16 a[156:157], v233 offset:8480
  v_cvt_pk_bf16_f32 v163, v166, v167
  v_pk_max_i16 v160, v160, 0
  v_mfma_f32_16x16x32_bf16 v[180:183], a[164:167], a[68:71], v[180:183]
  ds_read_b64_tr_b16 a[158:159], v233 offset:8736
  v_pk_max_i16 v161, v161, 0
  v_pk_max_i16 v162, v162, 0
  v_mfma_f32_16x16x32_bf16 v[188:191], a[164:167], v[68:71], v[188:191]
  ds_read_b64_tr_b16 a[160:161], v233 offset:8512
  s_mul_i32 s37, s4, 0x120
  s_add_u32 s38, s6, 0
  s_lshl_b32 s38, s38, 5
  v_mfma_f32_16x16x32_bf16 v[192:195], a[168:171], a[0:3], 0
  ds_read_b64_tr_b16 a[162:163], v233 offset:8768
  s_add_u32 s38, s38, s37
  s_mul_i32 s57, s38, 0x480
  s_add_u32 s38, s6, 1
  v_mfma_f32_16x16x32_bf16 v[196:199], a[168:171], v[0:3], 0
  ds_read_b64_tr_b16 a[164:165], v233 offset:8544
  s_lshl_b32 s38, s38, 5
  s_add_u32 s38, s38, s37
  s_mul_i32 s58, s38, 0x480
  v_mfma_f32_16x16x32_bf16 v[132:135], a[172:175], a[0:3], 0
  ds_read_b64_tr_b16 a[166:167], v233 offset:8800
  s_add_u32 s38, s6, 2
  s_lshl_b32 s38, s38, 5
  s_add_u32 s38, s38, s37
  s_nop 0
  v_mfma_f32_16x16x32_bf16 v[140:143], a[172:175], v[0:3], 0
  ds_read_b64_tr_b16 a[168:169], v233 offset:12672
  s_add_u32 m0, s76, 0x2100
  s_mul_i32 s59, s38, 0x480
  s_add_u32 s38, s6, 3
  v_mfma_f32_16x16x32_bf16 v[200:203], a[220:223], a[0:3], 0
  buffer_load_dwordx4 v237, s[16:19], s41 offen lds
  ds_read_b64_tr_b16 a[170:171], v233 offset:12928
  s_lshl_b32 s38, s38, 5
  s_add_u32 s38, s38, s37
  v_mfma_f32_16x16x32_bf16 v[204:207], a[220:223], v[0:3], 0
  ds_read_b64_tr_b16 a[172:173], v233 offset:12704
  s_mul_i32 s60, s38, 0x480
  s_add_u32 s38, s6, 4
  s_waitcnt lgkmcnt(5)
  v_mfma_f32_16x16x32_bf16 v[148:151], a[224:227], a[0:3], 0
  ds_read_b64_tr_b16 a[174:175], v233 offset:12960
  s_lshl_b32 s38, s38, 5
  s_add_u32 s38, s38, s37
  s_mul_i32 s61, s38, 0x480
  v_mfma_f32_16x16x32_bf16 v[156:159], a[224:227], v[0:3], 0
  ds_read_b64_tr_b16 a[220:221], v233 offset:12736
  s_add_u32 s38, s6, 5
  s_lshl_b32 s38, s38, 5
  s_add_u32 s38, s38, s37
  v_mfma_f32_16x16x32_bf16 v[192:195], a[228:231], a[4:7], v[192:195]
  ds_read_b64_tr_b16 a[222:223], v233 offset:12992
  s_mul_i32 s62, s38, 0x480
  s_add_u32 s38, s6, 6
  s_lshl_b32 s38, s38, 5
  v_mfma_f32_16x16x32_bf16 v[196:199], a[228:231], v[4:7], v[196:199]
  ds_read_b64_tr_b16 a[224:225], v233 offset:12768
  s_add_u32 m0, s76, 0x3180
  s_add_u32 s38, s38, s37
  s_nop 0
  s_mul_i32 s63, s38, 0x480
  v_mfma_f32_16x16x32_bf16 v[132:135], a[232:235], a[4:7], v[132:135]
  buffer_load_dwordx4 v237, s[16:19], s42 offen lds
  ds_read_b64_tr_b16 a[226:227], v233 offset:13024
  s_add_u32 s38, s6, 7
  s_lshl_b32 s38, s38, 5
  v_mfma_f32_16x16x32_bf16 v[140:143], a[232:235], v[4:7], v[140:143]
  ds_read_b64_tr_b16 a[228:229], v233 offset:16896
  s_add_u32 s38, s38, s37
  s_mul_i32 s64, s38, 0x480
  s_xor_b32 s38, s6, 1
  v_mfma_f32_16x16x32_bf16 v[200:203], a[144:147], a[4:7], v[200:203]
  ds_read_b64_tr_b16 a[230:231], v233 offset:17152
  s_lshl_b32 s38, s38, 8
  s_add_u32 s38, s38, s37
  s_mul_i32 s65, s38, 0x480
  v_mfma_f32_16x16x32_bf16 v[204:207], a[144:147], v[4:7], v[204:207]
  ds_read_b64_tr_b16 a[232:233], v233 offset:16928
  v_accvgpr_read_b32 v234, a209
  v_accvgpr_read_b32 v235, a210
  v_accvgpr_read_b32 v236, a213
  v_mfma_f32_16x16x32_bf16 v[148:151], a[148:151], a[4:7], v[148:151]
  ds_read_b64_tr_b16 a[234:235], v233 offset:17184
  s_xor_b32 s38, s6, 1
  s_lshl_b32 s38, s38, 6
  s_mul_i32 s37, s4, 0xa200
  v_mfma_f32_16x16x32_bf16 v[156:159], a[148:151], v[4:7], v[156:159]
  ds_read_b64_tr_b16 a[144:145], v233 offset:16960
  v_xor_b32_e32 v234, s38, v234
  v_xor_b32_e32 v235, s38, v235
  v_add_u32_e64 v235, s37, v235
  v_mfma_f32_16x16x32_bf16 v[192:195], a[152:155], a[8:11], v[192:195]
  ds_read_b64_tr_b16 a[146:147], v233 offset:17216
  v_accvgpr_read_b32 v252, a214
  v_accvgpr_read_b32 v253, a217
  v_accvgpr_read_b32 v254, a218
  v_mfma_f32_16x16x32_bf16 v[196:199], a[152:155], v[8:11], v[196:199]
  ds_read_b64_tr_b16 a[148:149], v233 offset:16992
  s_add_u32 m0, s76, 0x5280
  s_xor_b32 s38, s6, 1
  s_nop 0
  s_andn2_b32 s98, s96, 0x800
  v_mfma_f32_16x16x32_bf16 v[132:135], a[156:159], a[8:11], v[132:135]
  buffer_load_dwordx4 v244, s[16:19], s41 offen lds
  ds_read_b64_tr_b16 a[150:151], v233 offset:17248
  s_xor_b32 s98, s98, 0x4000
  s_lshl_b32 s97, s5, 13
  v_mfma_f32_16x16x32_bf16 v[140:143], a[156:159], v[8:11], v[140:143]
  ds_read_b64_tr_b16 a[152:153], v233 offset:21120
  s_lshl_b32 s37, s3, 7
  s_add_u32 s97, s97, s37
  s_add_u32 s97, s97, 0x4000
  v_mfma_f32_16x16x32_bf16 v[200:203], a[160:163], a[8:11], v[200:203]
  ds_read_b64_tr_b16 a[154:155], v233 offset:21376
  s_lshl_b32 s37, s4, 9
  s_add_u32 s71, s97, s37
  s_lshl_b32 s37, s4, 3
  v_mfma_f32_16x16x32_bf16 v[204:207], a[160:163], v[8:11], v[204:207]
  ds_read_b64_tr_b16 a[156:157], v233 offset:21152
  s_add_u32 s97, s97, s37
  s_add_u32 s39, s39, s97
  s_waitcnt lgkmcnt(5)
  v_mfma_f32_16x16x32_bf16 v[148:151], a[164:167], a[8:11], v[148:151]
  ds_read_b64_tr_b16 a[158:159], v233 offset:21408
  s_andn2_b32 s69, s96, 0x30c800
  s_lshl_b32 s37, s4, 8
  s_add_u32 s69, s69, s37
  v_mfma_f32_16x16x32_bf16 v[156:159], a[164:167], v[8:11], v[156:159]
  ds_read_b64_tr_b16 a[160:161], v233 offset:21184
  s_lshl_b32 s37, s38, 21
  s_add_u32 s69, s69, s37
  s_lshl_b32 s73, s5, 9
  v_mfma_f32_16x16x32_bf16 v[192:195], a[168:171], a[12:15], v[192:195]
  ds_read_b64_tr_b16 a[162:163], v233 offset:21440
  s_add_u32 s73, s73, 0x24000
  s_lshl_b32 s37, s3, 7
  s_add_u32 s73, s73, s37
  v_mfma_f32_16x16x32_bf16 v[196:199], a[168:171], v[12:15], v[196:199]
  ds_read_b64_tr_b16 a[164:165], v233 offset:21216
  s_lshl_b32 s37, s4, 3
  s_add_u32 s70, s73, s37
  s_mul_i32 s86, s5, 0x24000
  v_mfma_f32_16x16x32_bf16 v[132:135], a[172:175], a[12:15], v[132:135]
  ds_read_b64_tr_b16 a[166:167], v233 offset:21472
  s_add_u32 s85, s37, 0x400
  s_add_u32 s85, s85, s86
  s_sub_u32 s37, s73, s71
  v_mfma_f32_16x16x32_bf16 v[140:143], a[172:175], v[12:15], v[140:143]
  v_bfe_u32 v255, v232, 4, 1
  v_mad_u32_u24 v253, v255, s37, v253
  s_lshl_b32 s37, s4, 6
  s_add_u32 s86, s86, s37
  s_waitcnt vmcnt(18)
  s_barrier
  v_add_u32_e32 v233, 0x6300, v233
  ds_read_b64_tr_b16 a[168:169], v233 offset:0
  v_mfma_f32_16x16x32_bf16 v[200:203], a[220:223], a[12:15], v[200:203]
  ds_read_b64_tr_b16 a[170:171], v233 offset:256
  s_xor_b32 s37, s96, 0x1c08000
  buffer_store_dwordx4 a[248:251], v251, s[32:35], s37 offen sc1
  v_mfma_f32_16x16x32_bf16 v[204:207], a[220:223], v[12:15], v[204:207]
  ds_read_b64_tr_b16 a[172:173], v233 offset:32
  s_add_u32 m0, s76, 0x6300
  v_pk_max_i16 v163, v163, 0
  v_mfma_f32_16x16x32_bf16 v[148:151], a[224:227], a[12:15], v[148:151]
  buffer_load_dwordx4 v237, s[16:19], s43 offen lds
  ds_read_b64_tr_b16 a[174:175], v233 offset:288
  v_cvt_pk_bf16_f32 v168, v168, v169
  v_mfma_f32_16x16x32_bf16 v[156:159], a[224:227], v[12:15], v[156:159]
  ds_read_b64_tr_b16 a[220:221], v233 offset:64
  s_waitcnt vmcnt(7)
  s_nop 0
  v_cmp_eq_u64_e64 s[94:95], v[246:247], s[74:75]
  v_mfma_f32_16x16x32_bf16 v[192:195], a[228:231], a[16:19], v[192:195]
  ds_read_b64_tr_b16 a[222:223], v233 offset:320
s_cmp_lg_u64 s[94:95], -1
  s_cbranch_scc1 Lslow0
Lret0:
  v_cvt_pk_bf16_f32 v169, v170, v171
  v_mfma_f32_16x16x32_bf16 v[196:199], a[228:231], v[16:19], v[196:199]
  ds_read_b64_tr_b16 a[224:225], v233 offset:96
  v_cvt_pk_bf16_f32 v170, v172, v173
  v_cvt_pk_bf16_f32 v171, v174, v175
  v_mfma_f32_16x16x32_bf16 v[132:135], a[232:235], a[16:19], v[132:135]
  ds_read_b64_tr_b16 a[226:227], v233 offset:352
  v_pk_max_i16 v168, v168, 0
  v_pk_max_i16 v169, v169, 0
  v_mfma_f32_16x16x32_bf16 v[140:143], a[232:235], v[16:19], v[140:143]
  ds_read_b64_tr_b16 a[228:229], v233 offset:4224
  s_add_u32 m0, s76, 0x7380
  v_pk_max_i16 v170, v170, 0
  v_mfma_f32_16x16x32_bf16 v[200:203], a[144:147], a[16:19], v[200:203]
  buffer_load_dwordx4 v237, s[16:19], s44 offen lds
  ds_read_b64_tr_b16 a[230:231], v233 offset:4480
  v_pk_max_i16 v171, v171, 0
  v_mfma_f32_16x16x32_bf16 v[204:207], a[144:147], v[16:19], v[204:207]
  ds_read_b64_tr_b16 a[232:233], v233 offset:4256
  v_cvt_pk_bf16_f32 v176, v176, v177
  s_waitcnt lgkmcnt(6)
  s_nop 0
  v_mfma_f32_16x16x32_bf16 v[148:151], a[148:151], a[16:19], v[148:151]
  ds_read_b64_tr_b16 a[234:235], v233 offset:4512
  v_cvt_pk_bf16_f32 v177, v178, v179
  v_cvt_pk_bf16_f32 v178, v180, v181
  v_mfma_f32_16x16x32_bf16 v[156:159], a[148:151], v[16:19], v[156:159]
  ds_read_b64_tr_b16 a[144:145], v233 offset:4288
  s_xor_b32 s37, s96, 0x1c08000
  buffer_store_dwordx4 a[248:251], v251, s[32:35], s37 offen offset:1024 sc1
  v_mfma_f32_16x16x32_bf16 v[192:195], a[152:155], a[20:23], v[192:195]
  ds_read_b64_tr_b16 a[146:147], v233 offset:4544
  v_cvt_pk_bf16_f32 v179, v182, v183
  v_pk_max_i16 v176, v176, 0
  v_mfma_f32_16x16x32_bf16 v[196:199], a[152:155], v[20:23], v[196:199]
  ds_read_b64_tr_b16 a[148:149], v233 offset:4320
  v_pk_max_i16 v177, v177, 0
  v_pk_max_i16 v178, v178, 0
  v_mfma_f32_16x16x32_bf16 v[132:135], a[156:159], a[20:23], v[132:135]
  ds_read_b64_tr_b16 a[150:151], v233 offset:4576
  v_pk_max_i16 v179, v179, 0
  v_cvt_pk_bf16_f32 v184, v184, v185
  v_mfma_f32_16x16x32_bf16 v[140:143], a[156:159], v[20:23], v[140:143]
  ds_read_b64_tr_b16 a[152:153], v233 offset:8448
  s_add_u32 m0, s76, 0xa500
  v_cvt_pk_bf16_f32 v185, v186, v187
  v_mfma_f32_16x16x32_bf16 v[200:203], a[160:163], a[20:23], v[200:203]
  buffer_load_dwordx4 v244, s[16:19], s43 offen lds
  ds_read_b64_tr_b16 a[154:155], v233 offset:8704
  v_cvt_pk_bf16_f32 v186, v188, v189
  v_mfma_f32_16x16x32_bf16 v[204:207], a[160:163], v[20:23], v[204:207]
  ds_read_b64_tr_b16 a[156:157], v233 offset:8480
  v_cvt_pk_bf16_f32 v187, v190, v191
  v_pk_max_i16 v184, v184, 0
  v_mfma_f32_16x16x32_bf16 v[148:151], a[164:167], a[20:23], v[148:151]
  ds_read_b64_tr_b16 a[158:159], v233 offset:8736
  v_pk_max_i16 v185, v185, 0
  v_pk_max_i16 v186, v186, 0
  v_mfma_f32_16x16x32_bf16 v[156:159], a[164:167], v[20:23], v[156:159]
  ds_read_b64_tr_b16 a[160:161], v233 offset:8512
  v_pk_max_i16 v187, v187, 0
  v_mfma_f32_16x16x32_bf16 v[192:195], a[168:171], a[24:27], v[192:195]
  ds_read_b64_tr_b16 a[162:163], v233 offset:8768
  v_exp_f32_e64 v85, v85
  v_mfma_f32_16x16x32_bf16 v[196:199], a[168:171], v[24:27], v[196:199]
  ds_read_b64_tr_b16 a[164:165], v233 offset:8544
  v_add_f32_e64 v117, v84, v117
  v_mfma_f32_16x16x32_bf16 v[132:135], a[172:175], a[24:27], v[132:135]
  ds_read_b64_tr_b16 a[166:167], v233 offset:8800
  v_exp_f32_e64 v86, v86
  v_mfma_f32_16x16x32_bf16 v[140:143], a[172:175], v[24:27], v[140:143]
  ds_read_b64_tr_b16 a[168:169], v233 offset:12672
  s_add_u32 m0, s76, 0x8400
  s_waitcnt lgkmcnt(6)
  v_mfma_f32_16x16x32_bf16 v[200:203], a[220:223], a[24:27], v[200:203]
  buffer_load_dwordx4 v237, s[16:19], s45 offen lds
  ds_read_b64_tr_b16 a[170:171], v233 offset:12928
  v_add_f32_e32 v118, v85, v118
  v_mfma_f32_16x16x32_bf16 v[204:207], a[220:223], v[24:27], v[204:207]
  ds_read_b64_tr_b16 a[172:173], v233 offset:12704
  v_exp_f32_e64 v87, v87
  v_mfma_f32_16x16x32_bf16 v[148:151], a[224:227], a[24:27], v[148:151]
  ds_read_b64_tr_b16 a[174:175], v233 offset:12960
  v_add_f32_e64 v117, v86, v117
  v_mfma_f32_16x16x32_bf16 v[156:159], a[224:227], v[24:27], v[156:159]
  ds_read_b64_tr_b16 a[220:221], v233 offset:12736
  v_exp_f32_e64 v96, v96
  v_mfma_f32_16x16x32_bf16 v[192:195], a[228:231], a[28:31], v[192:195]
  ds_read_b64_tr_b16 a[222:223], v233 offset:12992
  v_add_f32_e64 v118, v87, v118
  v_mfma_f32_16x16x32_bf16 v[196:199], a[228:231], v[28:31], v[196:199]
  ds_read_b64_tr_b16 a[224:225], v233 offset:12768
  s_add_u32 m0, s76, 0x9480
  v_mfma_f32_16x16x32_bf16 v[132:135], a[232:235], a[28:31], v[132:135]
  buffer_load_dwordx4 v237, s[16:19], s46 offen lds
  ds_read_b64_tr_b16 a[226:227], v233 offset:13024
  v_mfma_f32_16x16x32_bf16 v[140:143], a[232:235], v[28:31], v[140:143]
  ds_read_b64_tr_b16 a[228:229], v233 offset:16896
  v_exp_f32_e64 v97, v97
  v_mfma_f32_16x16x32_bf16 v[200:203], a[144:147], a[28:31], v[200:203]
  ds_read_b64_tr_b16 a[230:231], v233 offset:17152
  v_add_f32_e64 v117, v96, v117
  v_mfma_f32_16x16x32_bf16 v[204:207], a[144:147], v[28:31], v[204:207]
  ds_read_b64_tr_b16 a[232:233], v233 offset:16928
  v_exp_f32_e64 v98, v98
  v_mfma_f32_16x16x32_bf16 v[148:151], a[148:151], a[28:31], v[148:151]
  ds_read_b64_tr_b16 a[234:235], v233 offset:17184
  v_add_f32_e64 v118, v97, v118
  v_mfma_f32_16x16x32_bf16 v[156:159], a[148:151], v[28:31], v[156:159]
  ds_read_b64_tr_b16 a[144:145], v233 offset:16960
  v_accvgpr_read_b32 v239, a192
  v_accvgpr_read_b32 v240, a189
  v_mfma_f32_16x16x32_bf16 v[192:195], a[152:155], a[32:35], v[192:195]
  ds_read_b64_tr_b16 a[146:147], v233 offset:17216
  s_lshl2_add_u32 s101, s5, s3
  s_min_u32 s101, s101, 56
  v_mfma_f32_16x16x32_bf16 v[196:199], a[152:155], v[32:35], v[196:199]
  ds_read_b64_tr_b16 a[148:149], v233 offset:16992
  s_add_u32 m0, s76, 0xb580
  s_waitcnt lgkmcnt(6)
  v_mfma_f32_16x16x32_bf16 v[132:135], a[156:159], a[32:35], v[132:135]
  buffer_load_dwordx4 v244, s[16:19], s45 offen lds
  ds_read_b64_tr_b16 a[150:151], v233 offset:17248
  s_lshl_b32 s101, s101, 7
  v_mfma_f32_16x16x32_bf16 v[140:143], a[156:159], v[32:35], v[140:143]
  ds_read_b64_tr_b16 a[152:153], v233 offset:21120
  s_lshl_b32 s100, s4, 17
  s_add_u32 s101, s101, s100
  v_mfma_f32_16x16x32_bf16 v[200:203], a[160:163], a[32:35], v[200:203]
  ds_read_b64_tr_b16 a[154:155], v233 offset:21376
  s_add_u32 s101, s101, 0x80000
  s_add_u32 s100, s101, 0x10000
  v_mfma_f32_16x16x32_bf16 v[204:207], a[160:163], v[32:35], v[204:207]
  ds_read_b64_tr_b16 a[156:157], v233 offset:21152
  buffer_load_dwordx4 v[108:111], v239, s[32:35], s101 offen sc1
  buffer_load_dwordx4 v[124:127], v239, s[32:35], s100 offen sc1
  v_mfma_f32_16x16x32_bf16 v[148:151], a[164:167], a[32:35], v[148:151]
  ds_read_b64_tr_b16 a[158:159], v233 offset:21408
  v_exp_f32_e64 v99, v99
  v_mfma_f32_16x16x32_bf16 v[156:159], a[164:167], v[32:35], v[156:159]
  ds_read_b64_tr_b16 a[160:161], v233 offset:21184
  v_add_f32_e64 v117, v98, v117
  v_mfma_f32_16x16x32_bf16 v[192:195], a[168:171], a[36:39], v[192:195]
  ds_read_b64_tr_b16 a[162:163], v233 offset:21440
  v_exp_f32_e64 v100, v100
  v_mfma_f32_16x16x32_bf16 v[196:199], a[168:171], v[36:39], v[196:199]
  ds_read_b64_tr_b16 a[164:165], v233 offset:21216
  v_add_f32_e64 v118, v99, v118
  v_mfma_f32_16x16x32_bf16 v[132:135], a[172:175], a[36:39], v[132:135]
  ds_read_b64_tr_b16 a[166:167], v233 offset:21472
  v_exp_f32_e64 v101, v101
  v_mfma_f32_16x16x32_bf16 v[140:143], a[172:175], v[36:39], v[140:143]
  v_add_f32_e32 v117, v100, v117
  v_exp_f32_e32 v102, v102
  s_barrier
  s_nop 0
  v_add_u32_e32 v233, 0x6300, v233
  ds_read_b64_tr_b16 a[168:169], v233 offset:0
  v_mfma_f32_16x16x32_bf16 v[200:203], a[220:223], a[36:39], v[200:203]
  ds_read_b64_tr_b16 a[170:171], v233 offset:256
  v_add_f32_e64 v118, v101, v118
  v_mfma_f32_16x16x32_bf16 v[204:207], a[220:223], v[36:39], v[204:207]
  ds_read_b64_tr_b16 a[172:173], v233 offset:32
  s_add_u32 m0, s76, 0xc600
  v_mfma_f32_16x16x32_bf16 v[148:151], a[224:227], a[36:39], v[148:151]
  buffer_load_dwordx4 v237, s[16:19], s47 offen lds
  ds_read_b64_tr_b16 a[174:175], v233 offset:288
  v_mfma_f32_16x16x32_bf16 v[156:159], a[224:227], v[36:39], v[156:159]
  ds_read_b64_tr_b16 a[220:221], v233 offset:64
  s_waitcnt lgkmcnt(6)
  v_mfma_f32_16x16x32_bf16 v[192:195], a[228:231], a[40:43], v[192:195]
  ds_read_b64_tr_b16 a[222:223], v233 offset:320
  v_exp_f32_e32 v103, v103
  v_mfma_f32_16x16x32_bf16 v[196:199], a[228:231], v[40:43], v[196:199]
  ds_read_b64_tr_b16 a[224:225], v233 offset:96
  v_add_f32_e64 v117, v102, v117
  v_mfma_f32_16x16x32_bf16 v[132:135], a[232:235], a[40:43], v[132:135]
  ds_read_b64_tr_b16 a[226:227], v233 offset:352
  v_exp_f32_e64 v120, v120
  v_mfma_f32_16x16x32_bf16 v[140:143], a[232:235], v[40:43], v[140:143]
  ds_read_b64_tr_b16 a[228:229], v233 offset:4224
  s_add_u32 m0, s76, 0xd680
  v_add_f32_e64 v118, v103, v118
  v_mfma_f32_16x16x32_bf16 v[200:203], a[144:147], a[40:43], v[200:203]
  buffer_load_dwordx4 v237, s[16:19], s48 offen lds
  ds_read_b64_tr_b16 a[230:231], v233 offset:4480
  v_mfma_f32_16x16x32_bf16 v[204:207], a[144:147], v[40:43], v[204:207]
  ds_read_b64_tr_b16 a[232:233], v233 offset:4256
  v_exp_f32_e64 v121, v121
  v_mfma_f32_16x16x32_bf16 v[148:151], a[148:151], a[40:43], v[148:151]
  ds_read_b64_tr_b16 a[234:235], v233 offset:4512
  v_add_f32_e32 v117, v120, v117
  v_add_f32_e32 v117, v117, v118
  v_mfma_f32_16x16x32_bf16 v[156:159], a[148:151], v[40:43], v[156:159]
  ds_read_b64_tr_b16 a[144:145], v233 offset:4288
  s_xor_b32 s37, s96, 0x1c0c000
  buffer_store_dwordx4 a[248:251], v251, s[32:35], s37 offen sc1
  v_mfma_f32_16x16x32_bf16 v[192:195], a[152:155], a[44:47], v[192:195]
  ds_read_b64_tr_b16 a[146:147], v233 offset:4544
  v_add_f32_e64 v117, v121, v117
  v_mfma_f32_16x16x32_bf16 v[196:199], a[152:155], v[44:47], v[196:199]
  ds_read_b64_tr_b16 a[148:149], v233 offset:4320
  v_rcp_f32_e64 v118, v117
  v_mfma_f32_16x16x32_bf16 v[132:135], a[156:159], a[44:47], v[132:135]
  ds_read_b64_tr_b16 a[150:151], v233 offset:4576
  v_mul_f32_e32 v80, v118, v80
  v_mul_f32_e32 v81, v118, v81
  v_mfma_f32_16x16x32_bf16 v[140:143], a[156:159], v[44:47], v[140:143]
  ds_read_b64_tr_b16 a[152:153], v233 offset:8448
  s_add_u32 m0, s76, 0x10800
  v_mul_f32_e64 v82, v118, v82
  v_mfma_f32_16x16x32_bf16 v[200:203], a[160:163], a[44:47], v[200:203]
  buffer_load_dwordx4 v244, s[16:19], s47 offen lds
  ds_read_b64_tr_b16 a[154:155], v233 offset:8704
  v_mul_f32_e64 v83, v118, v83
  v_mfma_f32_16x16x32_bf16 v[204:207], a[160:163], v[44:47], v[204:207]
  ds_read_b64_tr_b16 a[156:157], v233 offset:8480
  v_mul_f32_e32 v84, v118, v84
  s_waitcnt lgkmcnt(6)
  v_mfma_f32_16x16x32_bf16 v[148:151], a[164:167], a[44:47], v[148:151]
  ds_read_b64_tr_b16 a[158:159], v233 offset:8736
  v_mul_f32_e32 v85, v118, v85
  v_mul_f32_e32 v86, v118, v86
  v_mfma_f32_16x16x32_bf16 v[156:159], a[164:167], v[44:47], v[156:159]
  ds_read_b64_tr_b16 a[160:161], v233 offset:8512
  v_mul_f32_e32 v87, v118, v87
  v_mul_f32_e32 v96, v118, v96
  v_mfma_f32_16x16x32_bf16 v[192:195], a[168:171], a[48:51], v[192:195]
  ds_read_b64_tr_b16 a[162:163], v233 offset:8768
  v_mul_f32_e32 v97, v118, v97
  v_mul_f32_e32 v98, v118, v98
  v_mfma_f32_16x16x32_bf16 v[196:199], a[168:171], v[48:51], v[196:199]
  ds_read_b64_tr_b16 a[164:165], v233 offset:8544
  v_mul_f32_e32 v99, v118, v99
  v_mul_f32_e32 v100, v118, v100
  v_mfma_f32_16x16x32_bf16 v[132:135], a[172:175], a[48:51], v[132:135]
  ds_read_b64_tr_b16 a[166:167], v233 offset:8800
  v_mul_f32_e32 v101, v118, v101
  v_mul_f32_e32 v102, v118, v102
  v_mfma_f32_16x16x32_bf16 v[140:143], a[172:175], v[48:51], v[140:143]
  ds_read_b64_tr_b16 a[168:169], v233 offset:12672
  s_add_u32 m0, s76, 0xe700
  v_mul_f32_e64 v103, v118, v103
  v_mfma_f32_16x16x32_bf16 v[200:203], a[220:223], a[48:51], v[200:203]
  buffer_load_dwordx4 v237, s[16:19], s49 offen lds
  ds_read_b64_tr_b16 a[170:171], v233 offset:12928
  v_mul_f32_e64 v120, v118, v120
  v_mfma_f32_16x16x32_bf16 v[204:207], a[220:223], v[48:51], v[204:207]
  ds_read_b64_tr_b16 a[172:173], v233 offset:12704
  v_mul_f32_e64 v121, v118, v121
  v_cvt_pk_bf16_f32 v80, v80, v81
  v_mfma_f32_16x16x32_bf16 v[148:151], a[224:227], a[48:51], v[148:151]
  ds_read_b64_tr_b16 a[174:175], v233 offset:12960
  v_cvt_pk_bf16_f32 v81, v82, v83
  v_cvt_pk_bf16_f32 v82, v84, v85
  v_mfma_f32_16x16x32_bf16 v[156:159], a[224:227], v[48:51], v[156:159]
  ds_read_b64_tr_b16 a[220:221], v233 offset:12736
  v_cvt_pk_bf16_f32 v83, v86, v87
  v_cvt_pk_bf16_f32 v84, v96, v97
  v_mfma_f32_16x16x32_bf16 v[192:195], a[228:231], a[52:55], v[192:195]
  ds_read_b64_tr_b16 a[222:223], v233 offset:12992
  v_cvt_pk_bf16_f32 v85, v98, v99
  v_cvt_pk_bf16_f32 v86, v100, v101
  v_mfma_f32_16x16x32_bf16 v[196:199], a[228:231], v[52:55], v[196:199]
  ds_read_b64_tr_b16 a[224:225], v233 offset:12768
  s_add_u32 m0, s76, 0xf780
  v_cvt_pk_bf16_f32 v87, v102, v103
  v_mfma_f32_16x16x32_bf16 v[132:135], a[232:235], a[52:55], v[132:135]
  buffer_load_dwordx4 v237, s[16:19], s50 offen lds
  ds_read_b64_tr_b16 a[226:227], v233 offset:13024
  v_cvt_pk_bf16_f32 v114, v120, v121
  v_mfma_f32_16x16x32_bf16 v[140:143], a[232:235], v[52:55], v[140:143]
  ds_read_b64_tr_b16 a[228:229], v233 offset:16896
  v_mov_b32_e32 v115, 0
  s_waitcnt lgkmcnt(6)
  v_mfma_f32_16x16x32_bf16 v[200:203], a[144:147], a[52:55], v[200:203]
  ds_read_b64_tr_b16 a[230:231], v233 offset:17152
  v_mfma_f32_16x16x32_bf16 v[204:207], a[144:147], v[52:55], v[204:207]
  ds_read_b64_tr_b16 a[232:233], v233 offset:16928
  v_mfma_f32_16x16x32_bf16 v[148:151], a[148:151], a[52:55], v[148:151]
  ds_read_b64_tr_b16 a[234:235], v233 offset:17184
  v_mfma_f32_16x16x32_bf16 v[156:159], a[148:151], v[52:55], v[156:159]
  ds_read_b64_tr_b16 a[144:145], v233 offset:16960
  v_mfma_f32_16x16x32_bf16 v[192:195], a[152:155], a[56:59], v[192:195]
  ds_read_b64_tr_b16 a[146:147], v233 offset:17216
  v_mfma_f32_16x16x32_bf16 v[196:199], a[152:155], v[56:59], v[196:199]
  ds_read_b64_tr_b16 a[148:149], v233 offset:16992
  s_add_u32 m0, s76, 0x11880
  v_mfma_f32_16x16x32_bf16 v[132:135], a[156:159], a[56:59], v[132:135]
  buffer_load_dwordx4 v244, s[16:19], s49 offen lds
  ds_read_b64_tr_b16 a[150:151], v233 offset:17248
  v_mfma_f32_16x16x32_bf16 v[140:143], a[156:159], v[56:59], v[140:143]
  ds_read_b64_tr_b16 a[152:153], v233 offset:21120
  v_mfma_f32_16x16x32_bf16 v[200:203], a[160:163], a[56:59], v[200:203]
  ds_read_b64_tr_b16 a[154:155], v233 offset:21376
  v_mfma_f32_16x16x32_bf16 v[204:207], a[160:163], v[56:59], v[204:207]
  ds_read_b64_tr_b16 a[156:157], v233 offset:21152
  v_mfma_f32_16x16x32_bf16 v[148:151], a[164:167], a[56:59], v[148:151]
  ds_read_b64_tr_b16 a[158:159], v233 offset:21408
  v_mfma_f32_16x16x32_bf16 v[156:159], a[164:167], v[56:59], v[156:159]
  ds_read_b64_tr_b16 a[160:161], v233 offset:21184
  v_mfma_f32_16x16x32_bf16 v[192:195], a[168:171], a[60:63], v[192:195]
  ds_read_b64_tr_b16 a[162:163], v233 offset:21440
  v_mfma_f32_16x16x32_bf16 v[196:199], a[168:171], v[60:63], v[196:199]
  ds_read_b64_tr_b16 a[164:165], v233 offset:21216
  s_waitcnt lgkmcnt(7)
  v_mfma_f32_16x16x32_bf16 v[132:135], a[172:175], a[60:63], v[132:135]
  ds_read_b64_tr_b16 a[166:167], v233 offset:21472
  v_mfma_f32_16x16x32_bf16 v[140:143], a[172:175], v[60:63], v[140:143]
  s_waitcnt vmcnt(17)
  s_barrier
  s_nop 0
  v_add_u32_e32 v233, 0xfffe7400, v233
  ds_read_b64_tr_b16 a[168:169], v233 offset:0
  v_mfma_f32_16x16x32_bf16 v[200:203], a[220:223], a[60:63], v[200:203]
  ds_read_b64_tr_b16 a[170:171], v233 offset:256
  s_waitcnt vmcnt(7)
  v_add_f32_e32 v108, v124, v108
  v_mfma_f32_16x16x32_bf16 v[204:207], a[220:223], v[60:63], v[204:207]
  ds_read_b64_tr_b16 a[172:173], v233 offset:32
  s_add_u32 m0, s76, 0x12900
  v_add_f32_e64 v109, v125, v109
  v_mfma_f32_16x16x32_bf16 v[148:151], a[224:227], a[60:63], v[148:151]
  buffer_load_dwordx4 v237, s[16:19], s51 offen lds
  ds_read_b64_tr_b16 a[174:175], v233 offset:288
  v_add_f32_e64 v110, v126, v110
  v_mfma_f32_16x16x32_bf16 v[156:159], a[224:227], v[60:63], v[156:159]
  ds_read_b64_tr_b16 a[220:221], v233 offset:64
  s_xor_b32 s37, s96, 0x1c0c000
  buffer_store_dwordx4 a[248:251], v251, s[32:35], s37 offen offset:1024 sc1
  v_mfma_f32_16x16x32_bf16 v[192:195], a[228:231], a[64:67], v[192:195]
  ds_read_b64_tr_b16 a[222:223], v233 offset:320
  v_add_f32_e64 v111, v127, v111
  v_cmp_u_f32_e64 s[94:95], v108, v109
  v_mfma_f32_16x16x32_bf16 v[196:199], a[228:231], v[64:67], v[196:199]
  ds_read_b64_tr_b16 a[224:225], v233 offset:96
  v_cmp_u_f32_e64 vcc, v110, v111
  v_mfma_f32_16x16x32_bf16 v[132:135], a[232:235], a[64:67], v[132:135]
  ds_read_b64_tr_b16 a[226:227], v233 offset:352
s_or_b64 s[94:95], s[94:95], vcc
  s_cbranch_scc1 Lslow1
Lret1:
  v_add_f32_dpp v108, v108, v108 row_ror:4 row_mask:0xf bank_mask:0xf
  v_mfma_f32_16x16x32_bf16 v[140:143], a[232:235], v[64:67], v[140:143]
  ds_read_b64_tr_b16 a[228:229], v245 offset:0
  s_add_u32 m0, s76, 0x13980
  v_add_f32_dpp v109, v109, v109 row_ror:4 row_mask:0xf bank_mask:0xf
  v_mfma_f32_16x16x32_bf16 v[200:203], a[144:147], a[64:67], v[200:203]
  buffer_load_dwordx4 v237, s[16:19], s52 offen lds
  ds_read_b64_tr_b16 a[230:231], v245 offset:256
  v_add_f32_dpp v110, v110, v110 row_ror:4 row_mask:0xf bank_mask:0xf
  v_mfma_f32_16x16x32_bf16 v[204:207], a[144:147], v[64:67], v[204:207]
  ds_read_b64_tr_b16 a[232:233], v245 offset:32
  v_add_f32_dpp v111, v111, v111 row_ror:4 row_mask:0xf bank_mask:0xf
  v_add_f32_dpp v108, v108, v108 row_ror:8 row_mask:0xf bank_mask:0xf
  v_mfma_f32_16x16x32_bf16 v[148:151], a[148:151], a[64:67], v[148:151]
  ds_read_b64_tr_b16 a[234:235], v245 offset:288
  v_add_f32_dpp v109, v109, v109 row_ror:8 row_mask:0xf bank_mask:0xf
  v_add_f32_dpp v110, v110, v110 row_ror:8 row_mask:0xf bank_mask:0xf
  v_mfma_f32_16x16x32_bf16 v[156:159], a[148:151], v[64:67], v[156:159]
  ds_read_b64_tr_b16 a[144:145], v233 offset:4224
  v_add_f32_dpp v111, v111, v111 row_ror:8 row_mask:0xf bank_mask:0xf
  s_waitcnt lgkmcnt(6)
  v_mfma_f32_16x16x32_bf16 v[192:195], a[152:155], a[68:71], v[192:195]
  ds_read_b64_tr_b16 a[146:147], v233 offset:4480
  v_permlane32_swap_b32 v108, v110
  v_permlane32_swap_b32 v109, v111
  v_mfma_f32_16x16x32_bf16 v[196:199], a[152:155], v[68:71], v[196:199]
  ds_read_b64_tr_b16 a[148:149], v233 offset:4256
  v_add_f32_e32 v108, v110, v108
  v_add_f32_e64 v109, v111, v109
  v_mfma_f32_16x16x32_bf16 v[132:135], a[156:159], a[68:71], v[132:135]
  ds_read_b64_tr_b16 a[150:151], v233 offset:4512
  v_cvt_pk_bf16_f32 v108, v108, v109
  s_lshl2_add_u32 s101, s5, s3
  v_mfma_f32_16x16x32_bf16 v[140:143], a[156:159], v[68:71], v[140:143]
  ds_read_b64_tr_b16 a[152:153], v233 offset:4288
  s_add_u32 m0, s76, 0x16b00
  s_min_u32 s101, s101, 56
  v_mfma_f32_16x16x32_bf16 v[200:203], a[160:163], a[68:71], v[200:203]
  buffer_load_dwordx4 v244, s[16:19], s51 offen lds
  ds_read_b64_tr_b16 a[154:155], v233 offset:4544
  s_lshl_b32 s101, s101, 6
  v_mfma_f32_16x16x32_bf16 v[204:207], a[160:163], v[68:71], v[204:207]
  ds_read_b64_tr_b16 a[156:157], v233 offset:4320
  s_lshl_b32 s100, s4, 12
  s_add_u32 s101, s101, s100
  s_nop 0
  v_mfma_f32_16x16x32_bf16 v[148:151], a[164:167], a[68:71], v[148:151]
  ds_read_b64_tr_b16 a[158:159], v233 offset:4576
  s_add_u32 s101, s101, 0x60000
  buffer_store_dword v108, v240, s[32:35], s101 offen sc1
  v_mfma_f32_16x16x32_bf16 v[156:159], a[164:167], v[68:71], v[156:159]
  ds_read_b64_tr_b16 a[160:161], v245 offset:2112
  v_cvt_pk_bf16_f32 v192, v192, v193
  v_cvt_pk_bf16_f32 v193, v194, v195
  v_mfma_f32_16x16x32_bf16 v[208:211], a[168:171], a[0:3], 0
  ds_read_b64_tr_b16 a[162:163], v245 offset:2368
  v_cvt_pk_bf16_f32 v194, v132, v133
  v_cvt_pk_bf16_f32 v195, v134, v135
  v_mfma_f32_16x16x32_bf16 v[212:215], a[168:171], v[0:3], 0
  ds_read_b64_tr_b16 a[164:165], v245 offset:2144
  v_pk_max_i16 v192, v192, 0
  v_pk_max_i16 v193, v193, 0
  v_mfma_f32_16x16x32_bf16 v[164:167], a[172:175], a[0:3], 0
  ds_read_b64_tr_b16 a[166:167], v245 offset:2400
  v_pk_max_i16 v194, v194, 0
  v_pk_max_i16 v195, v195, 0
  v_mfma_f32_16x16x32_bf16 v[172:175], a[172:175], v[0:3], 0
  ds_read_b64_tr_b16 a[168:169], v233 offset:8448
  s_add_u32 m0, s76, 0x14a00
  v_cvt_pk_bf16_f32 v196, v196, v197
  v_mfma_f32_16x16x32_bf16 v[216:219], a[220:223], a[0:3], 0
  buffer_load_dwordx4 v237, s[16:19], s53 offen lds
  ds_read_b64_tr_b16 a[170:171], v233 offset:8704
  v_cvt_pk_bf16_f32 v197, v198, v199
  v_mfma_f32_16x16x32_bf16 v[220:223], a[220:223], v[0:3], 0
  ds_read_b64_tr_b16 a[172:173], v233 offset:8480
  v_cvt_pk_bf16_f32 v198, v140, v141
  s_waitcnt lgkmcnt(6)
  s_nop 0
  v_mfma_f32_16x16x32_bf16 v[180:183], a[224:227], a[0:3], 0
  ds_read_b64_tr_b16 a[174:175], v233 offset:8736
  v_cvt_pk_bf16_f32 v199, v142, v143
  v_pk_max_i16 v196, v196, 0
  v_mfma_f32_16x16x32_bf16 v[188:191], a[224:227], v[0:3], 0
  ds_read_b64_tr_b16 a[220:221], v233 offset:8512
  v_pk_max_i16 v197, v197, 0
  v_pk_max_i16 v198, v198, 0
  v_mfma_f32_16x16x32_bf16 v[224:227], a[228:231], a[0:3], 0
  ds_read_b64_tr_b16 a[222:223], v233 offset:8768
  v_pk_max_i16 v199, v199, 0
  v_cvt_pk_bf16_f32 v200, v200, v201
  v_mfma_f32_16x16x32_bf16 v[228:231], a[228:231], v[0:3], 0
  ds_read_b64_tr_b16 a[224:225], v233 offset:8544
  s_add_u32 m0, s76, 0x15a80
  v_cvt_pk_bf16_f32 v201, v202, v203
  v_mfma_f32_16x16x32_bf16 v[132:135], a[232:235], a[0:3], 0
  buffer_load_dwordx4 v237, s[16:19], s54 offen lds
  ds_read_b64_tr_b16 a[226:227], v233 offset:8800
  v_cvt_pk_bf16_f32 v202, v148, v149
  v_mfma_f32_16x16x32_bf16 v[140:143], a[232:235], v[0:3], 0
  ds_read_b64_tr_b16 a[228:229], v245 offset:4224
  v_cvt_pk_bf16_f32 v203, v150, v151
  v_pk_max_i16 v200, v200, 0
  v_mfma_f32_16x16x32_bf16 v[208:211], a[144:147], a[4:7], v[208:211]
  ds_read_b64_tr_b16 a[230:231], v245 offset:4480
  v_pk_max_i16 v201, v201, 0
  v_pk_max_i16 v202, v202, 0
  v_mfma_f32_16x16x32_bf16 v[212:215], a[144:147], v[4:7], v[212:215]
  ds_read_b64_tr_b16 a[232:233], v245 offset:4256
  v_pk_max_i16 v203, v203, 0
  v_cvt_pk_bf16_f32 v204, v204, v205
  v_mfma_f32_16x16x32_bf16 v[164:167], a[148:151], a[4:7], v[164:167]
  ds_read_b64_tr_b16 a[234:235], v245 offset:4512
  v_cvt_pk_bf16_f32 v205, v206, v207
  v_cvt_pk_bf16_f32 v206, v156, v157
  v_mfma_f32_16x16x32_bf16 v[172:175], a[148:151], v[4:7], v[172:175]
  ds_read_b64_tr_b16 a[144:145], v233 offset:12672
  v_cvt_pk_bf16_f32 v207, v158, v159
  v_pk_max_i16 v204, v204, 0
  v_mfma_f32_16x16x32_bf16 v[216:219], a[152:155], a[4:7], v[216:219]
  ds_read_b64_tr_b16 a[146:147], v233 offset:12928
  v_pk_max_i16 v205, v205, 0
  v_pk_max_i16 v206, v206, 0
  v_mfma_f32_16x16x32_bf16 v[220:223], a[152:155], v[4:7], v[220:223]
  ds_read_b64_tr_b16 a[148:149], v233 offset:12704
  s_add_u32 m0, s76, 0x17b80
  v_pk_max_i16 v207, v207, 0
  v_mfma_f32_16x16x32_bf16 v[180:183], a[156:159], a[4:7], v[180:183]
  buffer_load_dwordx4 v244, s[16:19], s53 offen lds
  ds_read_b64_tr_b16 a[150:151], v233 offset:12960
  v_mfma_f32_16x16x32_bf16 v[188:191], a[156:159], v[4:7], v[188:191]
  ds_read_b64_tr_b16 a[152:153], v233 offset:12736
  s_waitcnt lgkmcnt(6)
  s_nop 0
  v_mfma_f32_16x16x32_bf16 v[224:227], a[160:163], a[4:7], v[224:227]
  ds_read_b64_tr_b16 a[154:155], v233 offset:12992
  v_mfma_f32_16x16x32_bf16 v[228:231], a[160:163], v[4:7], v[228:231]
  ds_read_b64_tr_b16 a[156:157], v233 offset:12768
  v_mfma_f32_16x16x32_bf16 v[132:135], a[164:167], a[4:7], v[132:135]
  ds_read_b64_tr_b16 a[158:159], v233 offset:13024
  v_mfma_f32_16x16x32_bf16 v[140:143], a[164:167], v[4:7], v[140:143]
  ds_read_b64_tr_b16 a[160:161], v245 offset:6336
  v_mfma_f32_16x16x32_bf16 v[208:211], a[168:171], a[8:11], v[208:211]
  ds_read_b64_tr_b16 a[162:163], v245 offset:6592
  v_mfma_f32_16x16x32_bf16 v[212:215], a[168:171], v[8:11], v[212:215]
  ds_read_b64_tr_b16 a[164:165], v245 offset:6368
  v_mfma_f32_16x16x32_bf16 v[164:167], a[172:175], a[8:11], v[164:167]
  ds_read_b64_tr_b16 a[166:167], v245 offset:6624
  v_mfma_f32_16x16x32_bf16 v[172:175], a[172:175], v[8:11], v[172:175]
  s_barrier
  s_nop 0
  v_add_u32_e32 v233, 0x6300, v233
  v_add_u32_e32 v245, 0x6300, v245
  ds_read_b64_tr_b16 a[168:169], v233 offset:0
  v_mfma_f32_16x16x32_bf16 v[216:219], a[220:223], a[8:11], v[216:219]
  ds_read_b64_tr_b16 a[170:171], v233 offset:256
  v_mfma_f32_16x16x32_bf16 v[220:223], a[220:223], v[8:11], v[220:223]
  ds_read_b64_tr_b16 a[172:173], v233 offset:32
  s_add_u32 m0, s76, 0x18c00
  v_mfma_f32_16x16x32_bf16 v[180:183], a[224:227], a[8:11], v[180:183]
  buffer_load_dwordx4 v237, s[16:19], s55 offen lds
  ds_read_b64_tr_b16 a[174:175], v233 offset:288
  v_mfma_f32_16x16x32_bf16 v[188:191], a[224:227], v[8:11], v[188:191]
  ds_read_b64_tr_b16 a[220:221], v233 offset:64
  v_mfma_f32_16x16x32_bf16 v[224:227], a[228:231], a[8:11], v[224:227]
  ds_read_b64_tr_b16 a[222:223], v233 offset:320
  v_mfma_f32_16x16x32_bf16 v[228:231], a[228:231], v[8:11], v[228:231]
  ds_read_b64_tr_b16 a[224:225], v233 offset:96
  s_waitcnt lgkmcnt(7)
  s_nop 0
  v_mfma_f32_16x16x32_bf16 v[132:135], a[232:235], a[8:11], v[132:135]
  ds_read_b64_tr_b16 a[226:227], v233 offset:352
  v_mfma_f32_16x16x32_bf16 v[140:143], a[232:235], v[8:11], v[140:143]
  v_accvgpr_read_b32 v242, a211
  v_accvgpr_read_b32 v243, a212
  s_xor_b32 s7, s6, 1
  s_lshl_b32 s7, s7, 6
  v_xor_b32_e32 v242, s7, v242
  v_xor_b32_e32 v243, s7, v243
  s_mul_i32 s7, s3, 0x820
  s_add_u32 m0, s7, 0x23f00
  s_mul_i32 s7, s4, 0xa200
  buffer_load_dwordx4 v242, s[24:27], s7 offen lds
  buffer_load_dwordx4 v243, s[24:27], s7 offen offset:1024 lds
  ds_read_b64_tr_b16 a[228:229], v245 offset:0
  v_mfma_f32_16x16x32_bf16 v[208:211], a[144:147], a[12:15], v[208:211]
  ds_read_b64_tr_b16 a[230:231], v245 offset:256
  s_xor_b32 s37, s96, 0x2000000
  buffer_store_dwordx4 a[248:251], v251, s[32:35], s37 offen sc1
  v_mfma_f32_16x16x32_bf16 v[212:215], a[144:147], v[12:15], v[212:215]
  ds_read_b64_tr_b16 a[232:233], v245 offset:32
  v_mfma_f32_16x16x32_bf16 v[164:167], a[148:151], a[12:15], v[164:167]
  ds_read_b64_tr_b16 a[234:235], v245 offset:288
  v_mfma_f32_16x16x32_bf16 v[172:175], a[148:151], v[12:15], v[172:175]
  ds_read_b64_tr_b16 a[144:145], v233 offset:4224
  v_mfma_f32_16x16x32_bf16 v[216:219], a[152:155], a[12:15], v[216:219]
  ds_read_b64_tr_b16 a[146:147], v233 offset:4480
  v_mfma_f32_16x16x32_bf16 v[220:223], a[152:155], v[12:15], v[220:223]
  ds_read_b64_tr_b16 a[148:149], v233 offset:4256
  v_mfma_f32_16x16x32_bf16 v[180:183], a[156:159], a[12:15], v[180:183]
  ds_read_b64_tr_b16 a[150:151], v233 offset:4512
  v_mfma_f32_16x16x32_bf16 v[188:191], a[156:159], v[12:15], v[188:191]
  ds_read_b64_tr_b16 a[152:153], v233 offset:4288
  s_add_u32 m0, s76, 0x19c80
  v_mfma_f32_16x16x32_bf16 v[224:227], a[160:163], a[12:15], v[224:227]
  buffer_load_dwordx4 v237, s[16:19], s56 offen lds
  ds_read_b64_tr_b16 a[154:155], v233 offset:4544
  v_mfma_f32_16x16x32_bf16 v[228:231], a[160:163], v[12:15], v[228:231]
  ds_read_b64_tr_b16 a[156:157], v233 offset:4320
  v_mfma_f32_16x16x32_bf16 v[132:135], a[164:167], a[12:15], v[132:135]
  ds_read_b64_tr_b16 a[158:159], v233 offset:4576
  v_mfma_f32_16x16x32_bf16 v[140:143], a[164:167], v[12:15], v[140:143]
  ds_read_b64_tr_b16 a[160:161], v245 offset:2112
  s_waitcnt lgkmcnt(7)
  s_nop 0
  v_mfma_f32_16x16x32_bf16 v[208:211], a[168:171], a[16:19], v[208:211]
  ds_read_b64_tr_b16 a[162:163], v245 offset:2368
  v_mfma_f32_16x16x32_bf16 v[212:215], a[168:171], v[16:19], v[212:215]
  ds_read_b64_tr_b16 a[164:165], v245 offset:2144
  v_mfma_f32_16x16x32_bf16 v[164:167], a[172:175], a[16:19], v[164:167]
  ds_read_b64_tr_b16 a[166:167], v245 offset:2400
  v_mfma_f32_16x16x32_bf16 v[172:175], a[172:175], v[16:19], v[172:175]
  ds_read_b64_tr_b16 a[168:169], v233 offset:8448
  v_mfma_f32_16x16x32_bf16 v[216:219], a[220:223], a[16:19], v[216:219]
  ds_read_b64_tr_b16 a[170:171], v233 offset:8704
  v_mfma_f32_16x16x32_bf16 v[220:223], a[220:223], v[16:19], v[220:223]
  ds_read_b64_tr_b16 a[172:173], v233 offset:8480
  v_mfma_f32_16x16x32_bf16 v[180:183], a[224:227], a[16:19], v[180:183]
  ds_read_b64_tr_b16 a[174:175], v233 offset:8736
  v_mfma_f32_16x16x32_bf16 v[188:191], a[224:227], v[16:19], v[188:191]
  ds_read_b64_tr_b16 a[220:221], v233 offset:8512
  v_mfma_f32_16x16x32_bf16 v[224:227], a[228:231], a[16:19], v[224:227]
  ds_read_b64_tr_b16 a[222:223], v233 offset:8768
  v_mfma_f32_16x16x32_bf16 v[228:231], a[228:231], v[16:19], v[228:231]
  ds_read_b64_tr_b16 a[224:225], v233 offset:8544
  s_add_u32 m0, s76, 0x1ce00
  v_mfma_f32_16x16x32_bf16 v[132:135], a[232:235], a[16:19], v[132:135]
  buffer_load_dwordx4 v244, s[16:19], s55 offen lds
  ds_read_b64_tr_b16 a[226:227], v233 offset:8800
  v_mfma_f32_16x16x32_bf16 v[140:143], a[232:235], v[16:19], v[140:143]
  ds_read_b64_tr_b16 a[228:229], v245 offset:4224
  v_mfma_f32_16x16x32_bf16 v[208:211], a[144:147], a[20:23], v[208:211]
  ds_read_b64_tr_b16 a[230:231], v245 offset:4480
  v_mfma_f32_16x16x32_bf16 v[212:215], a[144:147], v[20:23], v[212:215]
  ds_read_b64_tr_b16 a[232:233], v245 offset:4256
  s_waitcnt lgkmcnt(7)
  s_nop 0
  v_mfma_f32_16x16x32_bf16 v[164:167], a[148:151], a[20:23], v[164:167]
  ds_read_b64_tr_b16 a[234:235], v245 offset:4512
  v_mfma_f32_16x16x32_bf16 v[172:175], a[148:151], v[20:23], v[172:175]
  ds_read_b64_tr_b16 a[144:145], v233 offset:12672
  v_mfma_f32_16x16x32_bf16 v[216:219], a[152:155], a[20:23], v[216:219]
  ds_read_b64_tr_b16 a[146:147], v233 offset:12928
  v_mfma_f32_16x16x32_bf16 v[220:223], a[152:155], v[20:23], v[220:223]
  ds_read_b64_tr_b16 a[148:149], v233 offset:12704
  v_mfma_f32_16x16x32_bf16 v[180:183], a[156:159], a[20:23], v[180:183]
  ds_read_b64_tr_b16 a[150:151], v233 offset:12960
  v_mfma_f32_16x16x32_bf16 v[188:191], a[156:159], v[20:23], v[188:191]
  ds_read_b64_tr_b16 a[152:153], v233 offset:12736
  v_mfma_f32_16x16x32_bf16 v[224:227], a[160:163], a[20:23], v[224:227]
  ds_read_b64_tr_b16 a[154:155], v233 offset:12992
  v_mfma_f32_16x16x32_bf16 v[228:231], a[160:163], v[20:23], v[228:231]
  ds_read_b64_tr_b16 a[156:157], v233 offset:12768
  v_mfma_f32_16x16x32_bf16 v[132:135], a[164:167], a[20:23], v[132:135]
  ds_read_b64_tr_b16 a[158:159], v233 offset:13024
  v_mfma_f32_16x16x32_bf16 v[140:143], a[164:167], v[20:23], v[140:143]
  ds_read_b64_tr_b16 a[160:161], v245 offset:6336
  v_accvgpr_read_b32 v241, a203
  v_accvgpr_read_b32 v239, a204
  v_mfma_f32_16x16x32_bf16 v[208:211], a[168:171], a[24:27], v[208:211]
  ds_read_b64_tr_b16 a[162:163], v245 offset:6592
  v_accvgpr_read_b32 v240, a205
  s_mov_b32 s92, 0
  v_mfma_f32_16x16x32_bf16 v[212:215], a[168:171], v[24:27], v[212:215]
  ds_read_b64_tr_b16 a[164:165], v245 offset:6368
  s_mov_b32 s93, -1
  s_lshl_b32 s101, s4, 12
  s_nop 0
  v_mfma_f32_16x16x32_bf16 v[164:167], a[172:175], a[24:27], v[164:167]
  ds_read_b64_tr_b16 a[166:167], v245 offset:6624
  s_add_u32 s101, s101, 0x60000
  buffer_load_dwordx4 v[124:127], v241, s[32:35], s101 offen sc1
  v_mfma_f32_16x16x32_bf16 v[172:175], a[172:175], v[24:27], v[172:175]
  s_waitcnt vmcnt(4)
  s_barrier
  v_add_u32_e32 v233, 0x6300, v233
  v_add_u32_e32 v245, 0x6300, v245
  ds_read_b64_tr_b16 a[168:169], v233 offset:0
  s_waitcnt lgkmcnt(5)
  s_nop 0
  v_mfma_f32_16x16x32_bf16 v[216:219], a[220:223], a[24:27], v[216:219]
  ds_read_b64_tr_b16 a[170:171], v233 offset:256
  v_mfma_f32_16x16x32_bf16 v[220:223], a[220:223], v[24:27], v[220:223]
  ds_read_b64_tr_b16 a[172:173], v233 offset:32
  s_add_u32 m0, s76, 0
  s_mov_b32 s66, 0x400
  v_add_u32_e32 v242, s66, v234
  v_add_u32_e64 v243, s66, v235
  v_mfma_f32_16x16x32_bf16 v[180:183], a[224:227], a[24:27], v[180:183]
  buffer_load_dwordx4 v242, s[20:23], s57 offen lds
  ds_read_b64_tr_b16 a[174:175], v233 offset:288
  v_mfma_f32_16x16x32_bf16 v[188:191], a[224:227], v[24:27], v[188:191]
  ds_read_b64_tr_b16 a[220:221], v233 offset:64
  v_mfma_f32_16x16x32_bf16 v[224:227], a[228:231], a[24:27], v[224:227]
  ds_read_b64_tr_b16 a[222:223], v233 offset:320
  v_mfma_f32_16x16x32_bf16 v[228:231], a[228:231], v[24:27], v[228:231]
  ds_read_b64_tr_b16 a[224:225], v233 offset:96
  v_mfma_f32_16x16x32_bf16 v[132:135], a[232:235], a[24:27], v[132:135]
  ds_read_b64_tr_b16 a[226:227], v233 offset:352
  v_mfma_f32_16x16x32_bf16 v[140:143], a[232:235], v[24:27], v[140:143]
  ds_read_b64_tr_b16 a[228:229], v245 offset:0
  s_xor_b32 s37, s96, 0x2000000
  buffer_store_dwordx4 a[248:251], v251, s[32:35], s37 offen offset:1024 sc1
  v_mfma_f32_16x16x32_bf16 v[208:211], a[144:147], a[28:31], v[208:211]
  ds_read_b64_tr_b16 a[230:231], v245 offset:256
  v_mfma_f32_16x16x32_bf16 v[212:215], a[144:147], v[28:31], v[212:215]
  ds_read_b64_tr_b16 a[232:233], v245 offset:32
  s_add_u32 m0, s76, 0x1080
  v_mfma_f32_16x16x32_bf16 v[164:167], a[148:151], a[28:31], v[164:167]
  buffer_load_dwordx4 v242, s[20:23], s58 offen lds
  ds_read_b64_tr_b16 a[234:235], v245 offset:288
  v_mfma_f32_16x16x32_bf16 v[172:175], a[148:151], v[28:31], v[172:175]
  ds_read_b64_tr_b16 a[144:145], v233 offset:4224
  v_mfma_f32_16x16x32_bf16 v[216:219], a[152:155], a[28:31], v[216:219]
  ds_read_b64_tr_b16 a[146:147], v233 offset:4480
  v_mfma_f32_16x16x32_bf16 v[220:223], a[152:155], v[28:31], v[220:223]
  ds_read_b64_tr_b16 a[148:149], v233 offset:4256
  v_mfma_f32_16x16x32_bf16 v[180:183], a[156:159], a[28:31], v[180:183]
  ds_read_b64_tr_b16 a[150:151], v233 offset:4512
  v_mfma_f32_16x16x32_bf16 v[188:191], a[156:159], v[28:31], v[188:191]
  ds_read_b64_tr_b16 a[152:153], v233 offset:4288
  s_waitcnt lgkmcnt(7)
  s_nop 0
  v_mfma_f32_16x16x32_bf16 v[224:227], a[160:163], a[28:31], v[224:227]
  ds_read_b64_tr_b16 a[154:155], v233 offset:4544
  v_mfma_f32_16x16x32_bf16 v[228:231], a[160:163], v[28:31], v[228:231]
  ds_read_b64_tr_b16 a[156:157], v233 offset:4320
  s_add_u32 m0, s76, 0x2100
  v_mfma_f32_16x16x32_bf16 v[132:135], a[164:167], a[28:31], v[132:135]
  buffer_load_dwordx4 v242, s[20:23], s59 offen lds
  ds_read_b64_tr_b16 a[158:159], v233 offset:4576
  v_mfma_f32_16x16x32_bf16 v[140:143], a[164:167], v[28:31], v[140:143]
  ds_read_b64_tr_b16 a[160:161], v245 offset:2112
  v_and_b32_e64 v255, 1, v232
  v_mul_u32_u24_e32 v255, 0x480, v255
  s_lshl2_add_u32 s37, s5, s3
  s_lshl4_add_u32 s37, s37, s4
  v_mfma_f32_16x16x32_bf16 v[208:211], a[168:171], a[32:35], v[208:211]
  ds_read_b64_tr_b16 a[162:163], v245 offset:2368
  s_mul_i32 s37, s37, 0x900
  buffer_load_dword v246, v255, s[28:31], s37 offen offset:1024
  buffer_load_dwordx2 v[246:247], v253, s[32:35], s71 offen sc1
  v_mfma_f32_16x16x32_bf16 v[212:215], a[168:171], v[32:35], v[212:215]
  ds_read_b64_tr_b16 a[164:165], v245 offset:2144
  v_mfma_f32_16x16x32_bf16 v[164:167], a[172:175], a[32:35], v[164:167]
  ds_read_b64_tr_b16 a[166:167], v245 offset:2400
  v_mfma_f32_16x16x32_bf16 v[172:175], a[172:175], v[32:35], v[172:175]
  ds_read_b64_tr_b16 a[168:169], v233 offset:8448
  v_mfma_f32_16x16x32_bf16 v[216:219], a[220:223], a[32:35], v[216:219]
  ds_read_b64_tr_b16 a[170:171], v233 offset:8704
  v_mfma_f32_16x16x32_bf16 v[220:223], a[220:223], v[32:35], v[220:223]
  ds_read_b64_tr_b16 a[172:173], v233 offset:8480
  v_mfma_f32_16x16x32_bf16 v[180:183], a[224:227], a[32:35], v[180:183]
  ds_read_b64_tr_b16 a[174:175], v233 offset:8736
  v_mfma_f32_16x16x32_bf16 v[188:191], a[224:227], v[32:35], v[188:191]
  ds_read_b64_tr_b16 a[220:221], v233 offset:8512
  s_add_u32 m0, s76, 0x3180
  v_mfma_f32_16x16x32_bf16 v[224:227], a[228:231], a[32:35], v[224:227]
  buffer_load_dwordx4 v242, s[20:23], s60 offen lds
  ds_read_b64_tr_b16 a[222:223], v233 offset:8768
  v_mfma_f32_16x16x32_bf16 v[228:231], a[228:231], v[32:35], v[228:231]
  ds_read_b64_tr_b16 a[224:225], v233 offset:8544
  s_waitcnt lgkmcnt(7)
  s_nop 0
  v_mfma_f32_16x16x32_bf16 v[132:135], a[232:235], a[32:35], v[132:135]
  ds_read_b64_tr_b16 a[226:227], v233 offset:8800
  v_mfma_f32_16x16x32_bf16 v[140:143], a[232:235], v[32:35], v[140:143]
  ds_read_b64_tr_b16 a[228:229], v245 offset:4224
  v_mfma_f32_16x16x32_bf16 v[208:211], a[144:147], a[36:39], v[208:211]
  ds_read_b64_tr_b16 a[230:231], v245 offset:4480
  v_mfma_f32_16x16x32_bf16 v[212:215], a[144:147], v[36:39], v[212:215]
  ds_read_b64_tr_b16 a[232:233], v245 offset:4256
  v_mfma_f32_16x16x32_bf16 v[164:167], a[148:151], a[36:39], v[164:167]
  ds_read_b64_tr_b16 a[234:235], v245 offset:4512
  v_mfma_f32_16x16x32_bf16 v[172:175], a[148:151], v[36:39], v[172:175]
  ds_read_b64_tr_b16 a[144:145], v233 offset:12672
  s_add_u32 m0, s76, 0x4200
  v_mfma_f32_16x16x32_bf16 v[216:219], a[152:155], a[36:39], v[216:219]
  buffer_load_dwordx4 v242, s[20:23], s61 offen lds
  ds_read_b64_tr_b16 a[146:147], v233 offset:12928
  v_mfma_f32_16x16x32_bf16 v[220:223], a[152:155], v[36:39], v[220:223]
  ds_read_b64_tr_b16 a[148:149], v233 offset:12704
  v_mfma_f32_16x16x32_bf16 v[180:183], a[156:159], a[36:39], v[180:183]
  ds_read_b64_tr_b16 a[150:151], v233 offset:12960
  v_mfma_f32_16x16x32_bf16 v[188:191], a[156:159], v[36:39], v[188:191]
  ds_read_b64_tr_b16 a[152:153], v233 offset:12736
  v_mfma_f32_16x16x32_bf16 v[224:227], a[160:163], a[36:39], v[224:227]
  ds_read_b64_tr_b16 a[154:155], v233 offset:12992
  v_mfma_f32_16x16x32_bf16 v[228:231], a[160:163], v[36:39], v[228:231]
  ds_read_b64_tr_b16 a[156:157], v233 offset:12768
  v_mfma_f32_16x16x32_bf16 v[132:135], a[164:167], a[36:39], v[132:135]
  ds_read_b64_tr_b16 a[158:159], v233 offset:13024
  v_mfma_f32_16x16x32_bf16 v[140:143], a[164:167], v[36:39], v[140:143]
  ds_read_b64_tr_b16 a[160:161], v245 offset:6336
  s_waitcnt lgkmcnt(7)
  s_nop 0
  v_mfma_f32_16x16x32_bf16 v[208:211], a[168:171], a[40:43], v[208:211]
  ds_read_b64_tr_b16 a[162:163], v245 offset:6592
  v_mfma_f32_16x16x32_bf16 v[212:215], a[168:171], v[40:43], v[212:215]
  ds_read_b64_tr_b16 a[164:165], v245 offset:6368
  v_mfma_f32_16x16x32_bf16 v[164:167], a[172:175], a[40:43], v[164:167]
  ds_read_b64_tr_b16 a[166:167], v245 offset:6624
  v_mfma_f32_16x16x32_bf16 v[172:175], a[172:175], v[40:43], v[172:175]
  s_barrier
  s_nop 0
  v_add_u32_e32 v233, 0x6300, v233
  v_add_u32_e32 v245, 0x6300, v245
  ds_read_b64_tr_b16 a[168:169], v233 offset:0
  v_mfma_f32_16x16x32_bf16 v[216:219], a[220:223], a[40:43], v[216:219]
  ds_read_b64_tr_b16 a[170:171], v233 offset:256
  v_mfma_f32_16x16x32_bf16 v[220:223], a[220:223], v[40:43], v[220:223]
  ds_read_b64_tr_b16 a[172:173], v233 offset:32
  s_add_u32 m0, s76, 0x6300
  v_mfma_f32_16x16x32_bf16 v[180:183], a[224:227], a[40:43], v[180:183]
  buffer_load_dwordx4 v242, s[20:23], s62 offen lds
  ds_read_b64_tr_b16 a[174:175], v233 offset:288
  v_mfma_f32_16x16x32_bf16 v[188:191], a[224:227], v[40:43], v[188:191]
  ds_read_b64_tr_b16 a[220:221], v233 offset:64
  v_mfma_f32_16x16x32_bf16 v[224:227], a[228:231], a[40:43], v[224:227]
  ds_read_b64_tr_b16 a[222:223], v233 offset:320
  v_mfma_f32_16x16x32_bf16 v[228:231], a[228:231], v[40:43], v[228:231]
  ds_read_b64_tr_b16 a[224:225], v233 offset:96
  v_mfma_f32_16x16x32_bf16 v[132:135], a[232:235], a[40:43], v[132:135]
  ds_read_b64_tr_b16 a[226:227], v233 offset:352
  v_mfma_f32_16x16x32_bf16 v[140:143], a[232:235], v[40:43], v[140:143]
  ds_read_b64_tr_b16 a[228:229], v245 offset:0
  v_mfma_f32_16x16x32_bf16 v[208:211], a[144:147], a[44:47], v[208:211]
  ds_read_b64_tr_b16 a[230:231], v245 offset:256
  v_mfma_f32_16x16x32_bf16 v[212:215], a[144:147], v[44:47], v[212:215]
  ds_read_b64_tr_b16 a[232:233], v245 offset:32
  s_add_u32 m0, s76, 0x7380
  s_waitcnt lgkmcnt(7)
  v_mfma_f32_16x16x32_bf16 v[164:167], a[148:151], a[44:47], v[164:167]
  buffer_load_dwordx4 v242, s[20:23], s63 offen lds
  ds_read_b64_tr_b16 a[234:235], v245 offset:288
  s_waitcnt vmcnt(10)
  v_max3_u32 v108, v124, v125, v126
  v_mfma_f32_16x16x32_bf16 v[172:175], a[148:151], v[44:47], v[172:175]
  ds_read_b64_tr_b16 a[144:145], v233 offset:4224
  v_max_u32_e64 v108, v108, v127
  v_cmp_eq_u32_e64 s[94:95], -1, v108
  v_mfma_f32_16x16x32_bf16 v[216:219], a[152:155], a[44:47], v[216:219]
  ds_read_b64_tr_b16 a[146:147], v233 offset:4480
s_cmp_lg_u64 s[94:95], 0
  s_cbranch_scc1 Lslow2
Lret2:
  ds_write_b64 v239, v[124:125] offset:0
  ds_write_b64 v240, v[126:127] offset:0
  v_mfma_f32_16x16x32_bf16 v[220:223], a[152:155], v[44:47], v[220:223]
  ds_read_b64_tr_b16 a[148:149], v233 offset:4256
  v_accvgpr_read_b32 v239, a206
  v_accvgpr_read_b32 v240, a207
  v_accvgpr_read_b32 v241, a208
  v_mfma_f32_16x16x32_bf16 v[180:183], a[156:159], a[44:47], v[180:183]
  ds_read_b64_tr_b16 a[150:151], v233 offset:4512
  v_mfma_f32_16x16x32_bf16 v[188:191], a[156:159], v[44:47], v[188:191]
  ds_read_b64_tr_b16 a[152:153], v233 offset:4288
  v_mfma_f32_16x16x32_bf16 v[224:227], a[160:163], a[44:47], v[224:227]
  ds_read_b64_tr_b16 a[154:155], v233 offset:4544
  v_mfma_f32_16x16x32_bf16 v[228:231], a[160:163], v[44:47], v[228:231]
  ds_read_b64_tr_b16 a[156:157], v233 offset:4320
  s_add_u32 m0, s76, 0x8400
  v_mfma_f32_16x16x32_bf16 v[132:135], a[164:167], a[44:47], v[132:135]
  buffer_load_dwordx4 v242, s[20:23], s64 offen lds
  ds_read_b64_tr_b16 a[158:159], v233 offset:4576
  v_mfma_f32_16x16x32_bf16 v[140:143], a[164:167], v[44:47], v[140:143]
  ds_read_b64_tr_b16 a[160:161], v245 offset:2112
  v_mfma_f32_16x16x32_bf16 v[208:211], a[168:171], a[48:51], v[208:211]
  ds_read_b64_tr_b16 a[162:163], v245 offset:2368
  v_mfma_f32_16x16x32_bf16 v[212:215], a[168:171], v[48:51], v[212:215]
  ds_read_b64_tr_b16 a[164:165], v245 offset:2144
  v_mfma_f32_16x16x32_bf16 v[164:167], a[172:175], a[48:51], v[164:167]
  ds_read_b64_tr_b16 a[166:167], v245 offset:2400
  v_mfma_f32_16x16x32_bf16 v[172:175], a[172:175], v[48:51], v[172:175]
  ds_read_b64_tr_b16 a[168:169], v233 offset:8448
  s_waitcnt lgkmcnt(7)
  s_nop 0
  v_mfma_f32_16x16x32_bf16 v[216:219], a[220:223], a[48:51], v[216:219]
  ds_read_b64_tr_b16 a[170:171], v233 offset:8704
  v_mfma_f32_16x16x32_bf16 v[220:223], a[220:223], v[48:51], v[220:223]
  ds_read_b64_tr_b16 a[172:173], v233 offset:8480
  v_mfma_f32_16x16x32_bf16 v[180:183], a[224:227], a[48:51], v[180:183]
  ds_read_b64_tr_b16 a[174:175], v233 offset:8736
  v_mfma_f32_16x16x32_bf16 v[188:191], a[224:227], v[48:51], v[188:191]
  ds_read_b64_tr_b16 a[220:221], v233 offset:8512
  s_add_u32 m0, s76, 0x9480
  v_mfma_f32_16x16x32_bf16 v[224:227], a[228:231], a[48:51], v[224:227]
  buffer_load_dwordx4 v242, s[20:23], s65 offen lds
  ds_read_b64_tr_b16 a[222:223], v233 offset:8768
  v_mfma_f32_16x16x32_bf16 v[228:231], a[228:231], v[48:51], v[228:231]
  ds_read_b64_tr_b16 a[224:225], v233 offset:8544
  v_mfma_f32_16x16x32_bf16 v[132:135], a[232:235], a[48:51], v[132:135]
  ds_read_b64_tr_b16 a[226:227], v233 offset:8800
  v_mfma_f32_16x16x32_bf16 v[140:143], a[232:235], v[48:51], v[140:143]
  ds_read_b64_tr_b16 a[228:229], v245 offset:4224
  v_mfma_f32_16x16x32_bf16 v[208:211], a[144:147], a[52:55], v[208:211]
  ds_read_b64_tr_b16 a[230:231], v245 offset:4480
  v_mfma_f32_16x16x32_bf16 v[212:215], a[144:147], v[52:55], v[212:215]
  ds_read_b64_tr_b16 a[232:233], v245 offset:4256
  v_mfma_f32_16x16x32_bf16 v[164:167], a[148:151], a[52:55], v[164:167]
  ds_read_b64_tr_b16 a[234:235], v245 offset:4512
  v_mfma_f32_16x16x32_bf16 v[172:175], a[148:151], v[52:55], v[172:175]
  ds_read_b64_tr_b16 a[144:145], v233 offset:12672
  s_add_u32 m0, s76, 0xa500
  v_mfma_f32_16x16x32_bf16 v[216:219], a[152:155], a[52:55], v[216:219]
  buffer_load_dwordx4 v243, s[24:27], 0 offen lds
  ds_read_b64_tr_b16 a[146:147], v233 offset:12928
  v_mfma_f32_16x16x32_bf16 v[220:223], a[152:155], v[52:55], v[220:223]
  ds_read_b64_tr_b16 a[148:149], v233 offset:12704
  s_waitcnt lgkmcnt(7)
  s_nop 0
  v_mfma_f32_16x16x32_bf16 v[180:183], a[156:159], a[52:55], v[180:183]
  ds_read_b64_tr_b16 a[150:151], v233 offset:12960
  v_mfma_f32_16x16x32_bf16 v[188:191], a[156:159], v[52:55], v[188:191]
  ds_read_b64_tr_b16 a[152:153], v233 offset:12736
  v_mfma_f32_16x16x32_bf16 v[224:227], a[160:163], a[52:55], v[224:227]
  ds_read_b64_tr_b16 a[154:155], v233 offset:12992
  v_mfma_f32_16x16x32_bf16 v[228:231], a[160:163], v[52:55], v[228:231]
  ds_read_b64_tr_b16 a[156:157], v233 offset:12768
  v_mfma_f32_16x16x32_bf16 v[132:135], a[164:167], a[52:55], v[132:135]
  ds_read_b64_tr_b16 a[158:159], v233 offset:13024
  v_mfma_f32_16x16x32_bf16 v[140:143], a[164:167], v[52:55], v[140:143]
  ds_read_b64_tr_b16 a[160:161], v245 offset:6336
  v_mfma_f32_16x16x32_bf16 v[208:211], a[168:171], a[56:59], v[208:211]
  ds_read_b64_tr_b16 a[162:163], v245 offset:6592
  v_mfma_f32_16x16x32_bf16 v[212:215], a[168:171], v[56:59], v[212:215]
  ds_read_b64_tr_b16 a[164:165], v245 offset:6368
  v_mfma_f32_16x16x32_bf16 v[164:167], a[172:175], a[56:59], v[164:167]
  ds_read_b64_tr_b16 a[166:167], v245 offset:6624
  v_mfma_f32_16x16x32_bf16 v[172:175], a[172:175], v[56:59], v[172:175]
  s_barrier
  s_nop 0
  v_add_u32_e32 v233, 0x6300, v233
  v_add_u32_e32 v245, 0x6300, v245
  ds_read_b64_tr_b16 a[168:169], v233 offset:0
  v_mfma_f32_16x16x32_bf16 v[216:219], a[220:223], a[56:59], v[216:219]
  ds_read_b64_tr_b16 a[170:171], v233 offset:256
  ds_read_b128 a[72:75], v239 offset:0
  ds_read_b128 a[76:79], v239 offset:16
  ds_read_b64 a[80:81], v239 offset:32
  v_mfma_f32_16x16x32_bf16 v[220:223], a[220:223], v[56:59], v[220:223]
  ds_read_b64_tr_b16 a[172:173], v233 offset:32
  s_add_u32 m0, s76, 0xc600
  s_xor_b32 s66, s84, 7
  s_lshl_b32 s66, s66, 7
  v_add_u32_e32 v242, s66, v234
  v_add_u32_e32 v243, s66, v235
  v_mfma_f32_16x16x32_bf16 v[180:183], a[224:227], a[56:59], v[180:183]
  buffer_load_dwordx4 v242, s[20:23], s57 offen lds
  ds_read_b64_tr_b16 a[174:175], v233 offset:288
  ds_read_b128 a[82:85], v239 offset:384
  ds_read_b128 a[86:89], v239 offset:400
  v_mfma_f32_16x16x32_bf16 v[188:191], a[224:227], v[56:59], v[188:191]
  ds_read_b64_tr_b16 a[220:221], v233 offset:64
  ds_read_b64 a[90:91], v239 offset:416
  ds_read_b128 a[92:95], v240 offset:0
  s_waitcnt lgkmcnt(12)
  s_nop 0
  v_mfma_f32_16x16x32_bf16 v[224:227], a[228:231], a[56:59], v[224:227]
  ds_read_b64_tr_b16 a[222:223], v233 offset:320
  ds_read_b128 a[96:99], v240 offset:16
  ds_read_b64 a[100:101], v240 offset:32
  ds_read_b128 a[102:105], v241 offset:0
  v_mfma_f32_16x16x32_bf16 v[228:231], a[228:231], v[56:59], v[228:231]
  ds_read_b64_tr_b16 a[224:225], v233 offset:96
  s_add_u32 m0, s76, 0xd680
  ds_read_b128 a[106:109], v241 offset:16
  ds_read_b64 a[110:111], v241 offset:32
  s_waitcnt lgkmcnt(13)
  s_nop 0
  v_mfma_f32_16x16x32_bf16 v[120:123], a[72:75], v[88:91], 0
  v_mfma_f32_16x16x32_bf16 v[132:135], a[232:235], a[56:59], v[132:135]
  buffer_load_dwordx4 v242, s[20:23], s58 offen lds
  ds_read_b64_tr_b16 a[226:227], v233 offset:352
  s_waitcnt lgkmcnt(11)
  v_mfma_f32_16x16x32_bf16 v[124:127], a[82:85], v[88:91], 0
  v_mfma_f32_16x16x32_bf16 v[140:143], a[232:235], v[56:59], v[140:143]
  ds_read_b64_tr_b16 a[228:229], v245 offset:0
  s_waitcnt lgkmcnt(9)
  v_mfma_f32_16x16x32_bf16 v[148:151], a[92:95], v[88:91], 0
  v_mfma_f32_16x16x32_bf16 v[208:211], a[144:147], a[60:63], v[208:211]
  ds_read_b64_tr_b16 a[230:231], v245 offset:256
  s_waitcnt lgkmcnt(5)
  s_nop 0
  v_mfma_f32_16x16x32_bf16 v[156:159], a[102:105], v[88:91], 0
  v_mfma_f32_16x16x32_bf16 v[212:215], a[144:147], v[60:63], v[212:215]
  ds_read_b64_tr_b16 a[232:233], v245 offset:32
  s_add_u32 m0, s76, 0xe700
  v_mfma_f32_16x16x32_bf16 v[120:123], a[76:79], v[92:95], v[120:123]
  v_mfma_f32_16x16x32_bf16 v[164:167], a[148:151], a[60:63], v[164:167]
  buffer_load_dwordx4 v242, s[20:23], s59 offen lds
  ds_read_b64_tr_b16 a[234:235], v245 offset:288
  v_mfma_f32_16x16x32_bf16 v[124:127], a[86:89], v[92:95], v[124:127]
  v_mfma_f32_16x16x32_bf16 v[172:175], a[148:151], v[60:63], v[172:175]
  ds_read_b64_tr_b16 a[144:145], v233 offset:4224
  v_mfma_f32_16x16x32_bf16 v[148:151], a[96:99], v[92:95], v[148:151]
  v_mfma_f32_16x16x32_bf16 v[216:219], a[152:155], a[60:63], v[216:219]
  ds_read_b64_tr_b16 a[146:147], v233 offset:4480
  s_waitcnt lgkmcnt(4)
  s_nop 0
  v_mfma_f32_16x16x32_bf16 v[156:159], a[106:109], v[92:95], v[156:159]
  v_mfma_f32_16x16x32_bf16 v[220:223], a[152:155], v[60:63], v[220:223]
  ds_read_b64_tr_b16 a[148:149], v233 offset:4256
  s_add_u32 m0, s76, 0xf780
  v_mfma_f32_16x16x16_bf16 v[120:123], a[80:81], v[112:113], v[120:123]
  v_mfma_f32_16x16x32_bf16 v[180:183], a[156:159], a[60:63], v[180:183]
  buffer_load_dwordx4 v242, s[20:23], s60 offen lds
  ds_read_b64_tr_b16 a[150:151], v233 offset:4512
  v_mfma_f32_16x16x16_bf16 v[124:127], a[90:91], v[112:113], v[124:127]
  v_mfma_f32_16x16x32_bf16 v[188:191], a[156:159], v[60:63], v[188:191]
  ds_read_b64_tr_b16 a[152:153], v233 offset:4288
  v_mfma_f32_16x16x16_bf16 v[148:151], a[100:101], v[112:113], v[148:151]
  v_mfma_f32_16x16x32_bf16 v[224:227], a[160:163], a[60:63], v[224:227]
  ds_read_b64_tr_b16 a[154:155], v233 offset:4544
  v_mfma_f32_16x16x16_bf16 v[156:159], a[110:111], v[112:113], v[156:159]
  s_waitcnt vmcnt(15)
  buffer_store_dwordx2 v[248:249], v252, s[32:35], s39 offen sc1
  v_accvgpr_read_b32 v255, a190
  s_xor_b32 s39, s4, 1
  s_lshl_b32 s39, s39, 9
  s_add_u32 s39, s39, s97
  buffer_store_dwordx2 v[248:249], v255, s[32:35], s39 offen sc1
  v_mfma_f32_16x16x32_bf16 v[100:103], a[72:75], v[80:83], 0
  v_accvgpr_read_b32 v255, a215
  v_mfma_f32_16x16x32_bf16 v[104:107], a[82:85], v[80:83], 0
  v_mfma_f32_16x16x32_bf16 v[228:231], a[160:163], v[60:63], v[228:231]
  ds_read_b64_tr_b16 a[156:157], v233 offset:4320
  s_add_u32 m0, s76, 0x10800
  v_mfma_f32_16x16x32_bf16 v[108:111], a[92:95], v[80:83], 0
  v_mfma_f32_16x16x32_bf16 v[132:135], a[164:167], a[60:63], v[132:135]
  buffer_load_dwordx4 v242, s[20:23], s61 offen lds
  ds_read_b64_tr_b16 a[158:159], v233 offset:4576
  v_mfma_f32_16x16x32_bf16 v[116:119], a[102:105], v[80:83], 0
  v_mfma_f32_16x16x32_bf16 v[140:143], a[164:167], v[60:63], v[140:143]
  ds_read_b64_tr_b16 a[160:161], v245 offset:2112
  v_mfma_f32_16x16x32_bf16 v[100:103], a[76:79], v[84:87], v[100:103]
  v_mfma_f32_16x16x32_bf16 v[208:211], a[168:171], a[64:67], v[208:211]
  ds_read_b64_tr_b16 a[162:163], v245 offset:2368
  v_mfma_f32_16x16x32_bf16 v[104:107], a[86:89], v[84:87], v[104:107]
  v_mfma_f32_16x16x32_bf16 v[212:215], a[168:171], v[64:67], v[212:215]
  ds_read_b64_tr_b16 a[164:165], v245 offset:2144
  v_mfma_f32_16x16x32_bf16 v[108:111], a[96:99], v[84:87], v[108:111]
  v_mfma_f32_16x16x32_bf16 v[164:167], a[172:175], a[64:67], v[164:167]
  ds_read_b64_tr_b16 a[166:167], v245 offset:2400
  v_mfma_f32_16x16x32_bf16 v[116:119], a[106:109], v[84:87], v[116:119]
  v_mfma_f32_16x16x32_bf16 v[172:175], a[172:175], v[64:67], v[172:175]
  s_waitcnt vmcnt(12)
  s_barrier
  v_add_u32_e32 v233, 0xfffe7400, v233
  ds_read_b64_tr_b16 a[168:169], v233 offset:0
  v_mfma_f32_16x16x16_bf16 v[100:103], a[80:81], v[114:115], v[100:103]
  v_mfma_f32_16x16x32_bf16 v[216:219], a[220:223], a[64:67], v[216:219]
  ds_read_b64_tr_b16 a[170:171], v233 offset:256
  v_mfma_f32_16x16x16_bf16 v[104:107], a[90:91], v[114:115], v[104:107]
  v_mfma_f32_16x16x32_bf16 v[220:223], a[220:223], v[64:67], v[220:223]
  ds_read_b64_tr_b16 a[172:173], v233 offset:32
  s_add_u32 m0, s76, 0x12900
  v_mfma_f32_16x16x16_bf16 v[108:111], a[100:101], v[114:115], v[108:111]
  v_mfma_f32_16x16x32_bf16 v[180:183], a[224:227], a[64:67], v[180:183]
  buffer_load_dwordx4 v242, s[20:23], s62 offen lds
  ds_read_b64_tr_b16 a[174:175], v233 offset:288
  v_mfma_f32_16x16x16_bf16 v[116:119], a[110:111], v[114:115], v[116:119]
  v_accvgpr_read_b32 v158, a186
  v_add_f32_e32 v156, 0x358637bd, v156
  v_add_f32_e32 v157, 0x358637bd, v157
  v_mul_f32_e64 v156, v158, v156
  v_mfma_f32_16x16x32_bf16 v[188:191], a[224:227], v[64:67], v[188:191]
  ds_read_b64_tr_b16 a[220:221], v233 offset:64
  v_mul_f32_e32 v157, v158, v157
  v_rcp_f32_e32 v156, v156
  v_mfma_f32_16x16x32_bf16 v[224:227], a[228:231], a[64:67], v[224:227]
  ds_read_b64_tr_b16 a[222:223], v233 offset:320
  v_rcp_f32_e64 v157, v157
  v_accvgpr_read_b32 v118, a187
  v_mfma_f32_16x16x32_bf16 v[228:231], a[228:231], v[64:67], v[228:231]
  ds_read_b64_tr_b16 a[224:225], v233 offset:96
  v_cndmask_b32_e64 v158, v156, v157, s[92:93]
  v_mul_f32_e32 v120, v158, v120
  s_waitcnt lgkmcnt(4)
  v_mfma_f32_16x16x32_bf16 v[132:135], a[232:235], a[64:67], v[132:135]
  ds_read_b64_tr_b16 a[226:227], v233 offset:352
  v_mul_f32_e32 v121, v158, v121
  v_mul_f32_e32 v122, v158, v122
  v_mul_f32_e64 v123, v158, v123
  v_mfma_f32_16x16x32_bf16 v[140:143], a[232:235], v[64:67], v[140:143]
  ds_read_b64_tr_b16 a[228:229], v233 offset:4224
  s_add_u32 m0, s76, 0x13980
  v_mul_f32_e32 v124, v158, v124
  v_mul_f32_e32 v125, v158, v125
  v_mfma_f32_16x16x32_bf16 v[208:211], a[144:147], a[68:71], v[208:211]
  buffer_load_dwordx4 v242, s[20:23], s63 offen lds
  ds_read_b64_tr_b16 a[230:231], v233 offset:4480
  v_mul_f32_e32 v126, v158, v126
  v_mul_f32_e32 v127, v158, v127
  v_mfma_f32_16x16x32_bf16 v[212:215], a[144:147], v[68:71], v[212:215]
  ds_read_b64_tr_b16 a[232:233], v233 offset:4256
  v_mul_f32_e32 v148, v156, v148
  v_mul_f32_e32 v149, v156, v149
  v_mul_f32_e64 v150, v157, v150
  v_mfma_f32_16x16x32_bf16 v[164:167], a[148:151], a[68:71], v[164:167]
  ds_read_b64_tr_b16 a[234:235], v233 offset:4512
  v_mul_f32_e64 v151, v157, v151
  v_cvt_pk_bf16_f32 v72, v120, v121
  v_cvt_pk_bf16_f32 v73, v122, v123
  v_mfma_f32_16x16x32_bf16 v[172:175], a[148:151], v[68:71], v[172:175]
  ds_read_b64_tr_b16 a[144:145], v233 offset:4288
  v_cvt_pk_bf16_f32 v74, v124, v125
  v_cvt_pk_bf16_f32 v75, v126, v127
  v_cvt_pk_bf16_f32 v96, v148, v149
  v_mfma_f32_16x16x32_bf16 v[216:219], a[152:155], a[68:71], v[216:219]
  ds_read_b64_tr_b16 a[146:147], v233 offset:4544
  v_cvt_pk_bf16_f32 v97, v150, v151
  v_cvt_pk_bf16_f32 v208, v208, v209
  v_cvt_pk_bf16_f32 v209, v210, v211
  v_mfma_f32_16x16x32_bf16 v[220:223], a[152:155], v[68:71], v[220:223]
  ds_read_b64_tr_b16 a[148:149], v233 offset:4320
  v_cvt_pk_bf16_f32 v210, v164, v165
  v_cvt_pk_bf16_f32 v211, v166, v167
  v_pk_max_i16 v208, v208, 0
  v_mfma_f32_16x16x32_bf16 v[180:183], a[156:159], a[68:71], v[180:183]
  ds_read_b64_tr_b16 a[150:151], v233 offset:4576
  v_pk_max_i16 v209, v209, 0
  v_pk_max_i16 v210, v210, 0
  v_pk_max_i16 v211, v211, 0
  v_mfma_f32_16x16x32_bf16 v[188:191], a[156:159], v[68:71], v[188:191]
  ds_read_b64_tr_b16 a[152:153], v233 offset:8448
  s_add_u32 m0, s76, 0x14a00
  v_cvt_pk_bf16_f32 v212, v212, v213
  v_cvt_pk_bf16_f32 v213, v214, v215
  v_mfma_f32_16x16x32_bf16 v[224:227], a[160:163], a[68:71], v[224:227]
  buffer_load_dwordx4 v242, s[20:23], s64 offen lds
  ds_read_b64_tr_b16 a[154:155], v233 offset:8704
  v_cvt_pk_bf16_f32 v214, v172, v173
  v_cvt_pk_bf16_f32 v215, v174, v175
  v_mfma_f32_16x16x32_bf16 v[228:231], a[160:163], v[68:71], v[228:231]
  ds_read_b64_tr_b16 a[156:157], v233 offset:8480
  v_pk_max_i16 v212, v212, 0
  v_pk_max_i16 v213, v213, 0
  v_pk_max_i16 v214, v214, 0
  v_mfma_f32_16x16x32_bf16 v[132:135], a[164:167], a[68:71], v[132:135]
  ds_read_b64_tr_b16 a[158:159], v233 offset:8736
  v_pk_max_i16 v215, v215, 0
  v_cvt_pk_bf16_f32 v216, v216, v217
  v_cvt_pk_bf16_f32 v217, v218, v219
  v_mfma_f32_16x16x32_bf16 v[140:143], a[164:167], v[68:71], v[140:143]
  ds_read_b64_tr_b16 a[160:161], v233 offset:8512
  v_cvt_pk_bf16_f32 v218, v180, v181
  v_cvt_pk_bf16_f32 v219, v182, v183
  v_pk_max_i16 v216, v216, 0
  v_mfma_f32_16x16x32_bf16 v[52:55], a[168:171], v[128:131], 0
  ds_read_b64_tr_b16 a[162:163], v233 offset:8768
  v_pk_max_i16 v217, v217, 0
  v_pk_max_i16 v218, v218, 0
  v_pk_max_i16 v219, v219, 0
  v_mfma_f32_16x16x32_bf16 v[56:59], a[168:171], v[136:139], 0
  ds_read_b64_tr_b16 a[164:165], v233 offset:8544
  s_add_u32 m0, s76, 0x15a80
  v_cvt_pk_bf16_f32 v220, v220, v221
  s_waitcnt lgkmcnt(5)
  s_nop 0
  v_mfma_f32_16x16x32_bf16 v[60:63], a[172:175], v[128:131], 0
  buffer_load_dwordx4 v242, s[20:23], s65 offen lds
  ds_read_b64_tr_b16 a[166:167], v233 offset:8800
  v_cvt_pk_bf16_f32 v221, v222, v223
  v_cvt_pk_bf16_f32 v222, v188, v189
  v_mfma_f32_16x16x32_bf16 v[64:67], a[172:175], v[136:139], 0
  ds_read_b64_tr_b16 a[168:169], v233 offset:12672
  v_cvt_pk_bf16_f32 v223, v190, v191
  v_pk_max_i16 v220, v220, 0
  v_pk_max_i16 v221, v221, 0
  v_mfma_f32_16x16x32_bf16 v[164:167], a[220:223], v[128:131], 0
  ds_read_b64_tr_b16 a[170:171], v233 offset:12928
  v_pk_max_i16 v222, v222, 0
  v_pk_max_i16 v223, v223, 0
  v_cvt_pk_bf16_f32 v224, v224, v225
  v_mfma_f32_16x16x32_bf16 v[172:175], a[220:223], v[136:139], 0
  ds_read_b64_tr_b16 a[172:173], v233 offset:12704
  v_cvt_pk_bf16_f32 v225, v226, v227
  v_cvt_pk_bf16_f32 v226, v132, v133
  v_cvt_pk_bf16_f32 v227, v134, v135
  v_mfma_f32_16x16x32_bf16 v[68:71], a[224:227], v[128:131], 0
  ds_read_b64_tr_b16 a[174:175], v233 offset:12960
  v_pk_max_i16 v224, v224, 0
  v_pk_max_i16 v225, v225, 0
  v_pk_max_i16 v226, v226, 0
  v_mfma_f32_16x16x32_bf16 v[180:183], a[224:227], v[136:139], 0
  ds_read_b64_tr_b16 a[220:221], v233 offset:12736
  v_pk_max_i16 v227, v227, 0
  v_cvt_pk_bf16_f32 v228, v228, v229
  v_cvt_pk_bf16_f32 v229, v230, v231
  v_mfma_f32_16x16x32_bf16 v[52:55], a[228:231], v[144:147], v[52:55]
  ds_read_b64_tr_b16 a[222:223], v233 offset:12992
  v_cvt_pk_bf16_f32 v230, v140, v141
  v_cvt_pk_bf16_f32 v231, v142, v143
  v_pk_max_i16 v228, v228, 0
  v_mfma_f32_16x16x32_bf16 v[56:59], a[228:231], v[152:155], v[56:59]
  ds_read_b64_tr_b16 a[224:225], v233 offset:12768
  s_add_u32 m0, s76, 0x16b00
  v_pk_max_i16 v229, v229, 0
  v_pk_max_i16 v230, v230, 0
  v_mfma_f32_16x16x32_bf16 v[60:63], a[232:235], v[144:147], v[60:63]
  buffer_load_dwordx4 v243, s[24:27], 0 offen lds
  ds_read_b64_tr_b16 a[226:227], v233 offset:13024
  v_pk_max_i16 v231, v231, 0
  v_add_f32_e32 v116, 0x358637bd, v116
  v_mfma_f32_16x16x32_bf16 v[64:67], a[232:235], v[152:155], v[64:67]
  ds_read_b64_tr_b16 a[228:229], v233 offset:16896
  v_add_f32_e32 v117, 0x358637bd, v117
  v_mul_f32_e32 v116, v118, v116
  v_mul_f32_e32 v117, v118, v117
  v_mfma_f32_16x16x32_bf16 v[164:167], a[144:147], v[144:147], v[164:167]
  ds_read_b64_tr_b16 a[230:231], v233 offset:17152
  v_rcp_f32_e64 v116, v116
  v_mfma_f32_16x16x32_bf16 v[172:175], a[144:147], v[152:155], v[172:175]
  ds_read_b64_tr_b16 a[232:233], v233 offset:16928
  v_rcp_f32_e64 v117, v117
  v_mfma_f32_16x16x32_bf16 v[68:71], a[148:151], v[144:147], v[68:71]
  ds_read_b64_tr_b16 a[234:235], v233 offset:17184
  v_cndmask_b32_e64 v118, v116, v117, s[92:93]
  v_mul_f32_e32 v100, v118, v100
  v_mul_f32_e32 v101, v118, v101
  v_mfma_f32_16x16x32_bf16 v[180:183], a[148:151], v[152:155], v[180:183]
  ds_read_b64_tr_b16 a[144:145], v233 offset:16960
  v_mul_f32_e32 v102, v118, v102
  v_mul_f32_e32 v103, v118, v103
  v_mul_f32_e64 v104, v118, v104
  v_mfma_f32_16x16x32_bf16 v[52:55], a[152:155], v[160:163], v[52:55]
  ds_read_b64_tr_b16 a[146:147], v233 offset:17216
  v_mul_f32_e32 v105, v118, v105
  v_mul_f32_e32 v106, v118, v106
  v_mul_f32_e64 v107, v118, v107
  v_mfma_f32_16x16x32_bf16 v[56:59], a[152:155], v[168:171], v[56:59]
  ds_read_b64_tr_b16 a[148:149], v233 offset:16992
  v_mul_f32_e32 v108, v116, v108
  v_mul_f32_e32 v109, v116, v109
  s_waitcnt lgkmcnt(5)
  v_mfma_f32_16x16x32_bf16 v[60:63], a[156:159], v[160:163], v[60:63]
  ds_read_b64_tr_b16 a[150:151], v233 offset:17248
  v_mul_f32_e32 v110, v117, v110
  v_mul_f32_e64 v111, v117, v111
  v_cvt_pk_bf16_f32 v76, v100, v101
  v_mfma_f32_16x16x32_bf16 v[64:67], a[156:159], v[168:171], v[64:67]
  v_cvt_pk_bf16_f32 v77, v102, v103
  v_cvt_pk_bf16_f32 v78, v104, v105
  v_cvt_pk_bf16_f32 v79, v106, v107
  v_cvt_pk_bf16_f32 v98, v108, v109
  s_waitcnt vmcnt(12)
  s_barrier
  v_add_u32_e32 v233, 0x6300, v233
  ds_read_b64_tr_b16 a[152:153], v233 offset:0
  v_mfma_f32_16x16x32_bf16 v[164:167], a[160:163], v[160:163], v[164:167]
  ds_read_b64_tr_b16 a[154:155], v233 offset:256
  v_cvt_pk_bf16_f32 v99, v110, v111
  v_mfma_f32_16x16x32_bf16 v[172:175], a[160:163], v[168:171], v[172:175]
  ds_read_b64_tr_b16 a[156:157], v233 offset:32
  s_add_u32 m0, s76, 0x18c00
  s_xor_b32 s66, s84, 6
  s_lshl_b32 s66, s66, 7
  v_add_u32_e32 v242, s66, v234
  v_add_u32_e32 v243, s66, v235
  v_mfma_f32_16x16x32_bf16 v[68:71], a[164:167], v[160:163], v[68:71]
  buffer_load_dwordx4 v242, s[20:23], s57 offen lds
  ds_read_b64_tr_b16 a[158:159], v233 offset:288
  v_mfma_f32_16x16x32_bf16 v[180:183], a[164:167], v[168:171], v[180:183]
  ds_read_b64_tr_b16 a[160:161], v233 offset:64
  v_mfma_f32_16x16x32_bf16 v[52:55], a[168:171], v[176:179], v[52:55]
  ds_read_b64_tr_b16 a[162:163], v233 offset:320
  v_mfma_f32_16x16x32_bf16 v[56:59], a[168:171], v[184:187], v[56:59]
  ds_read_b64_tr_b16 a[164:165], v233 offset:96
  v_mfma_f32_16x16x32_bf16 v[60:63], a[172:175], v[176:179], v[60:63]
  ds_read_b64_tr_b16 a[166:167], v233 offset:352
  v_mfma_f32_16x16x32_bf16 v[64:67], a[172:175], v[184:187], v[64:67]
  ds_read_b64_tr_b16 a[168:169], v233 offset:4224
  v_mfma_f32_16x16x32_bf16 v[164:167], a[220:223], v[176:179], v[164:167]
  ds_read_b64_tr_b16 a[170:171], v233 offset:4480
  v_mfma_f32_16x16x32_bf16 v[172:175], a[220:223], v[184:187], v[172:175]
  ds_read_b64_tr_b16 a[172:173], v233 offset:4256
  s_add_u32 m0, s76, 0x19c80
  v_mfma_f32_16x16x32_bf16 v[68:71], a[224:227], v[176:179], v[68:71]
  buffer_load_dwordx4 v242, s[20:23], s58 offen lds
  ds_read_b64_tr_b16 a[174:175], v233 offset:4512
  v_mfma_f32_16x16x32_bf16 v[180:183], a[224:227], v[184:187], v[180:183]
  ds_read_b64_tr_b16 a[220:221], v233 offset:4288
  v_mfma_f32_16x16x32_bf16 v[52:55], a[228:231], v[192:195], v[52:55]
  ds_read_b64_tr_b16 a[222:223], v233 offset:4544
  v_mfma_f32_16x16x32_bf16 v[56:59], a[228:231], v[196:199], v[56:59]
  ds_read_b64_tr_b16 a[224:225], v233 offset:4320
  s_waitcnt lgkmcnt(7)
  s_nop 0
  v_mfma_f32_16x16x32_bf16 v[60:63], a[232:235], v[192:195], v[60:63]
  ds_read_b64_tr_b16 a[226:227], v233 offset:4576
  v_mfma_f32_16x16x32_bf16 v[64:67], a[232:235], v[196:199], v[64:67]
  ds_read_b64_tr_b16 a[228:229], v233 offset:8448
  v_mfma_f32_16x16x32_bf16 v[164:167], a[144:147], v[192:195], v[164:167]
  ds_read_b64_tr_b16 a[230:231], v233 offset:8704
  v_mfma_f32_16x16x32_bf16 v[172:175], a[144:147], v[196:199], v[172:175]
  ds_read_b64_tr_b16 a[232:233], v233 offset:8480
  s_add_u32 m0, s76, 0x1ad00
  v_mfma_f32_16x16x32_bf16 v[68:71], a[148:151], v[192:195], v[68:71]
  buffer_load_dwordx4 v242, s[20:23], s59 offen lds
  ds_read_b64_tr_b16 a[234:235], v233 offset:8736
  v_mfma_f32_16x16x32_bf16 v[180:183], a[148:151], v[196:199], v[180:183]
  ds_read_b64_tr_b16 a[144:145], v233 offset:8512
  v_mfma_f32_16x16x32_bf16 v[52:55], a[152:155], v[200:203], v[52:55]
  ds_read_b64_tr_b16 a[146:147], v233 offset:8768
  v_mfma_f32_16x16x32_bf16 v[56:59], a[152:155], v[204:207], v[56:59]
  ds_read_b64_tr_b16 a[148:149], v233 offset:8544
  v_mfma_f32_16x16x32_bf16 v[60:63], a[156:159], v[200:203], v[60:63]
  ds_read_b64_tr_b16 a[150:151], v233 offset:8800
  v_mfma_f32_16x16x32_bf16 v[64:67], a[156:159], v[204:207], v[64:67]
  ds_read_b64_tr_b16 a[152:153], v233 offset:12672
  v_mfma_f32_16x16x32_bf16 v[164:167], a[160:163], v[200:203], v[164:167]
  ds_read_b64_tr_b16 a[154:155], v233 offset:12928
  v_mfma_f32_16x16x32_bf16 v[172:175], a[160:163], v[204:207], v[172:175]
  ds_read_b64_tr_b16 a[156:157], v233 offset:12704
  v_mfma_f32_16x16x32_bf16 v[68:71], a[164:167], v[200:203], v[68:71]
  ds_read_b64_tr_b16 a[158:159], v233 offset:12960
  v_mfma_f32_16x16x32_bf16 v[180:183], a[164:167], v[204:207], v[180:183]
  ds_read_b64_tr_b16 a[160:161], v233 offset:12736
  s_add_u32 m0, s76, 0x1bd80
  s_waitcnt lgkmcnt(7)
  s_nop 0
  v_mfma_f32_16x16x32_bf16 v[52:55], a[168:171], v[208:211], v[52:55]
  buffer_load_dwordx4 v242, s[20:23], s60 offen lds
  ds_read_b64_tr_b16 a[162:163], v233 offset:12992
  v_mfma_f32_16x16x32_bf16 v[56:59], a[168:171], v[212:215], v[56:59]
  ds_read_b64_tr_b16 a[164:165], v233 offset:12768
  v_mfma_f32_16x16x32_bf16 v[60:63], a[172:175], v[208:211], v[60:63]
  ds_read_b64_tr_b16 a[166:167], v233 offset:13024
  v_mfma_f32_16x16x32_bf16 v[64:67], a[172:175], v[212:215], v[64:67]
  s_mov_b32 s67, 0x400
  v_add_u32_e64 v250, s67, v236
  ds_read_b64_tr_b16 a[168:169], v233 offset:16896
  v_mfma_f32_16x16x32_bf16 v[164:167], a[220:223], v[208:211], v[164:167]
  ds_read_b64_tr_b16 a[170:171], v233 offset:17152
  v_mfma_f32_16x16x32_bf16 v[172:175], a[220:223], v[212:215], v[172:175]
  ds_read_b64_tr_b16 a[172:173], v233 offset:16928
  v_mfma_f32_16x16x32_bf16 v[68:71], a[224:227], v[208:211], v[68:71]
  ds_read_b64_tr_b16 a[174:175], v233 offset:17184
  v_mfma_f32_16x16x32_bf16 v[180:183], a[224:227], v[212:215], v[180:183]
  ds_read_b64_tr_b16 a[220:221], v233 offset:16960
  s_add_u32 m0, s76, 0x1ce00
  v_mfma_f32_16x16x32_bf16 v[52:55], a[228:231], v[216:219], v[52:55]
  buffer_load_dwordx4 v242, s[20:23], s61 offen lds
  ds_read_b64_tr_b16 a[222:223], v233 offset:17216
  v_mfma_f32_16x16x32_bf16 v[56:59], a[228:231], v[220:223], v[56:59]
  ds_read_b64_tr_b16 a[224:225], v233 offset:16992
  v_mfma_f32_16x16x32_bf16 v[60:63], a[232:235], v[216:219], v[60:63]
  ds_read_b64_tr_b16 a[226:227], v233 offset:17248
  v_mfma_f32_16x16x32_bf16 v[64:67], a[232:235], v[220:223], v[64:67]
  ds_read_b64_tr_b16 a[228:229], v250 offset:0
  v_mfma_f32_16x16x32_bf16 v[164:167], a[144:147], v[216:219], v[164:167]
  v_mfma_f32_16x16x32_bf16 v[172:175], a[144:147], v[220:223], v[172:175]
  ds_read_b64_tr_b16 a[232:233], v250 offset:32
  s_waitcnt lgkmcnt(6)
  s_nop 0
  v_mfma_f32_16x16x32_bf16 v[68:71], a[148:151], v[216:219], v[68:71]
  v_mfma_f32_16x16x32_bf16 v[180:183], a[148:151], v[220:223], v[180:183]
  ds_read_b64_tr_b16 a[144:145], v250 offset:64
  v_mfma_f32_16x16x32_bf16 v[52:55], a[152:155], v[224:227], v[52:55]
  v_mfma_f32_16x16x32_bf16 v[56:59], a[152:155], v[228:231], v[56:59]
  ds_read_b64_tr_b16 a[148:149], v250 offset:96
  v_mfma_f32_16x16x32_bf16 v[60:63], a[156:159], v[224:227], v[60:63]
  v_mfma_f32_16x16x32_bf16 v[64:67], a[156:159], v[228:231], v[64:67]
  s_waitcnt vmcnt(10)
  s_barrier
  v_add_u32_e32 v233, 0x6300, v233
  ds_read_b64_tr_b16 a[152:153], v233 offset:0
  v_mfma_f32_16x16x32_bf16 v[164:167], a[160:163], v[224:227], v[164:167]
  ds_read_b64_tr_b16 a[154:155], v233 offset:256
  v_mfma_f32_16x16x32_bf16 v[172:175], a[160:163], v[228:231], v[172:175]
  ds_read_b64_tr_b16 a[156:157], v233 offset:32
  s_add_u32 m0, s76, 0
  s_nop 0
  v_mfma_f32_16x16x32_bf16 v[68:71], a[164:167], v[224:227], v[68:71]
  buffer_load_dwordx4 v242, s[20:23], s62 offen lds
  ds_read_b64_tr_b16 a[158:159], v233 offset:288
  v_mfma_f32_16x16x32_bf16 v[180:183], a[164:167], v[228:231], v[180:183]
  ds_read_b64_tr_b16 a[160:161], v233 offset:64
  v_mfma_f32_16x16x32_bf16 v[52:55], a[168:171], v[72:75], v[52:55]
  ds_read_b64_tr_b16 a[162:163], v233 offset:320
  v_mfma_f32_16x16x32_bf16 v[56:59], a[168:171], v[76:79], v[56:59]
  ds_read_b64_tr_b16 a[164:165], v233 offset:96
  v_mfma_f32_16x16x32_bf16 v[60:63], a[172:175], v[72:75], v[60:63]
  ds_read_b64_tr_b16 a[166:167], v233 offset:352
  v_mfma_f32_16x16x32_bf16 v[64:67], a[172:175], v[76:79], v[64:67]
  ds_read_b64_tr_b16 a[168:169], v233 offset:4224
  s_add_u32 m0, s76, 0x1080
  s_waitcnt lgkmcnt(7)
  s_nop 0
  v_mfma_f32_16x16x32_bf16 v[164:167], a[220:223], v[72:75], v[164:167]
  buffer_load_dwordx4 v242, s[20:23], s63 offen lds
  ds_read_b64_tr_b16 a[170:171], v233 offset:4480
  v_mfma_f32_16x16x32_bf16 v[172:175], a[220:223], v[76:79], v[172:175]
  ds_read_b64_tr_b16 a[172:173], v233 offset:4256
  v_mfma_f32_16x16x32_bf16 v[68:71], a[224:227], v[72:75], v[68:71]
  ds_read_b64_tr_b16 a[174:175], v233 offset:4512
  v_mfma_f32_16x16x32_bf16 v[180:183], a[224:227], v[76:79], v[180:183]
  ds_read_b64_tr_b16 a[220:221], v233 offset:4288
  v_mfma_f32_4x4x4_16b_bf16 v[52:55], a[228:229], v[96:97], v[52:55]
  ds_read_b64_tr_b16 a[222:223], v233 offset:4544
  v_mfma_f32_4x4x4_16b_bf16 v[56:59], a[228:229], v[98:99], v[56:59]
  ds_read_b64_tr_b16 a[224:225], v233 offset:4320
  v_mfma_f32_4x4x4_16b_bf16 v[60:63], a[232:233], v[96:97], v[60:63]
  ds_read_b64_tr_b16 a[226:227], v233 offset:4576
  v_cvt_pk_bf16_f32 v52, v52, v53
  v_cvt_pk_bf16_f32 v53, v54, v55
  v_cvt_pk_bf16_f32 v54, v56, v57
  v_cvt_pk_bf16_f32 v55, v58, v59
  v_mfma_f32_4x4x4_16b_bf16 v[64:67], a[232:233], v[98:99], v[64:67]
  ds_read_b64_tr_b16 a[228:229], v233 offset:8448
  s_add_u32 m0, s76, 0x2100
  s_xor_b32 s37, s69, 0
  s_nop 0
  buffer_store_dwordx4 v[52:55], v255, s[32:35], s37 offen sc1
  v_cvt_pk_bf16_f32 v60, v60, v61
  v_mfma_f32_4x4x4_16b_bf16 v[164:167], a[144:145], v[96:97], v[164:167]
  buffer_load_dwordx4 v242, s[20:23], s64 offen lds
  ds_read_b64_tr_b16 a[230:231], v233 offset:8704
  v_cvt_pk_bf16_f32 v61, v62, v63
  v_cvt_pk_bf16_f32 v62, v64, v65
  v_cvt_pk_bf16_f32 v63, v66, v67
  v_mfma_f32_4x4x4_16b_bf16 v[172:175], a[144:145], v[98:99], v[172:175]
  ds_read_b64_tr_b16 a[232:233], v233 offset:8480
  s_xor_b32 s37, s69, 0x100000
  buffer_store_dwordx4 v[60:63], v255, s[32:35], s37 offen sc1
  v_cvt_pk_bf16_f32 v164, v164, v165
  v_cvt_pk_bf16_f32 v165, v166, v167
  v_mfma_f32_4x4x4_16b_bf16 v[68:71], a[148:149], v[96:97], v[68:71]
  ds_read_b64_tr_b16 a[234:235], v233 offset:8736
  v_cvt_pk_bf16_f32 v166, v172, v173
  v_cvt_pk_bf16_f32 v167, v174, v175
  s_xor_b32 s37, s69, 0x200000
  buffer_store_dwordx4 v[164:167], v255, s[32:35], s37 offen sc1
  v_mfma_f32_4x4x4_16b_bf16 v[180:183], a[148:149], v[98:99], v[180:183]
  ds_read_b64_tr_b16 a[144:145], v233 offset:8512
  v_cvt_pk_bf16_f32 v68, v68, v69
  v_cvt_pk_bf16_f32 v69, v70, v71
  v_mfma_f32_16x16x32_bf16 v[20:23], a[152:155], v[128:131], 0
  ds_read_b64_tr_b16 a[146:147], v233 offset:8768
  v_cvt_pk_bf16_f32 v70, v180, v181
  v_cvt_pk_bf16_f32 v71, v182, v183
  v_mfma_f32_16x16x32_bf16 v[24:27], a[152:155], v[136:139], 0
  ds_read_b64_tr_b16 a[148:149], v233 offset:8544
  s_add_u32 m0, s76, 0x3180
  s_waitcnt lgkmcnt(5)
  s_nop 0
  v_mfma_f32_16x16x32_bf16 v[28:31], a[156:159], v[128:131], 0
  buffer_load_dwordx4 v242, s[20:23], s65 offen lds
  ds_read_b64_tr_b16 a[150:151], v233 offset:8800
  s_xor_b32 s37, s69, 0x300000
  v_mfma_f32_16x16x32_bf16 v[32:35], a[156:159], v[136:139], 0
  ds_read_b64_tr_b16 a[152:153], v233 offset:12672
  buffer_store_dwordx4 v[68:71], v255, s[32:35], s37 offen sc1
  v_accvgpr_read_b32 v255, a190
  v_mfma_f32_16x16x32_bf16 v[36:39], a[160:163], v[128:131], 0
  ds_read_b64_tr_b16 a[154:155], v233 offset:12928
  s_xor_b32 s37, s96, 0x708000
  v_mfma_f32_16x16x32_bf16 v[40:43], a[160:163], v[136:139], 0
  ds_read_b64_tr_b16 a[156:157], v233 offset:12704
  v_mfma_f32_16x16x32_bf16 v[44:47], a[164:167], v[128:131], 0
  ds_read_b64_tr_b16 a[158:159], v233 offset:12960
  v_mfma_f32_16x16x32_bf16 v[48:51], a[164:167], v[136:139], 0
  ds_read_b64_tr_b16 a[160:161], v233 offset:12736
  v_mfma_f32_16x16x32_bf16 v[20:23], a[168:171], v[144:147], v[20:23]
  ds_read_b64_tr_b16 a[162:163], v233 offset:12992
  v_mfma_f32_16x16x32_bf16 v[24:27], a[168:171], v[152:155], v[24:27]
  ds_read_b64_tr_b16 a[164:165], v233 offset:12768
  s_add_u32 m0, s76, 0x4200
  v_mfma_f32_16x16x32_bf16 v[28:31], a[172:175], v[144:147], v[28:31]
  buffer_load_dwordx4 v243, s[24:27], 0 offen lds
  ds_read_b64_tr_b16 a[166:167], v233 offset:13024
  v_mfma_f32_16x16x32_bf16 v[32:35], a[172:175], v[152:155], v[32:35]
  ds_read_b64_tr_b16 a[168:169], v233 offset:16896
  v_mfma_f32_16x16x32_bf16 v[36:39], a[220:223], v[144:147], v[36:39]
  ds_read_b64_tr_b16 a[170:171], v233 offset:17152
  v_mfma_f32_16x16x32_bf16 v[40:43], a[220:223], v[152:155], v[40:43]
  ds_read_b64_tr_b16 a[172:173], v233 offset:16928
  v_mfma_f32_16x16x32_bf16 v[44:47], a[224:227], v[144:147], v[44:47]
  ds_read_b64_tr_b16 a[174:175], v233 offset:17184
  v_mfma_f32_16x16x32_bf16 v[48:51], a[224:227], v[152:155], v[48:51]
  ds_read_b64_tr_b16 a[220:221], v233 offset:16960
  v_mfma_f32_16x16x32_bf16 v[20:23], a[228:231], v[160:163], v[20:23]
  ds_read_b64_tr_b16 a[222:223], v233 offset:17216
  v_mfma_f32_16x16x32_bf16 v[24:27], a[228:231], v[168:171], v[24:27]
  ds_read_b64_tr_b16 a[224:225], v233 offset:16992
  s_waitcnt lgkmcnt(7)
  v_mfma_f32_16x16x32_bf16 v[28:31], a[232:235], v[160:163], v[28:31]
  ds_read_b64_tr_b16 a[226:227], v233 offset:17248
  v_mfma_f32_16x16x32_bf16 v[32:35], a[232:235], v[168:171], v[32:35]
  s_waitcnt vmcnt(14)
  s_barrier
  s_nop 0
  v_add_u32_e32 v233, 0x6300, v233
  ds_read_b64_tr_b16 a[228:229], v233 offset:0
  v_mfma_f32_16x16x32_bf16 v[36:39], a[144:147], v[160:163], v[36:39]
  ds_read_b64_tr_b16 a[230:231], v233 offset:256
  v_mfma_f32_16x16x32_bf16 v[40:43], a[144:147], v[168:171], v[40:43]
  ds_read_b64_tr_b16 a[232:233], v233 offset:32
  s_add_u32 m0, s76, 0x6300
  s_xor_b32 s66, s84, 5
  s_lshl_b32 s66, s66, 7
  v_add_u32_e32 v242, s66, v234
  v_add_u32_e32 v243, s66, v235
  v_mfma_f32_16x16x32_bf16 v[44:47], a[148:151], v[160:163], v[44:47]
  buffer_load_dwordx4 v242, s[20:23], s57 offen lds
  ds_read_b64_tr_b16 a[234:235], v233 offset:288
  v_mfma_f32_16x16x32_bf16 v[48:51], a[148:151], v[168:171], v[48:51]
  ds_read_b64_tr_b16 a[144:145], v233 offset:64
  v_mfma_f32_16x16x32_bf16 v[20:23], a[152:155], v[176:179], v[20:23]
  ds_read_b64_tr_b16 a[146:147], v233 offset:320
  v_mfma_f32_16x16x32_bf16 v[24:27], a[152:155], v[184:187], v[24:27]
  ds_read_b64_tr_b16 a[148:149], v233 offset:96
  v_mfma_f32_16x16x32_bf16 v[28:31], a[156:159], v[176:179], v[28:31]
  ds_read_b64_tr_b16 a[150:151], v233 offset:352
  v_mfma_f32_16x16x32_bf16 v[32:35], a[156:159], v[184:187], v[32:35]
  ds_read_b64_tr_b16 a[152:153], v233 offset:4224
  v_mfma_f32_16x16x32_bf16 v[36:39], a[160:163], v[176:179], v[36:39]
  ds_read_b64_tr_b16 a[154:155], v233 offset:4480
  v_mfma_f32_16x16x32_bf16 v[40:43], a[160:163], v[184:187], v[40:43]
  ds_read_b64_tr_b16 a[156:157], v233 offset:4256
  s_add_u32 m0, s76, 0x7380
  v_mfma_f32_16x16x32_bf16 v[44:47], a[164:167], v[176:179], v[44:47]
  buffer_load_dwordx4 v242, s[20:23], s58 offen lds
  ds_read_b64_tr_b16 a[158:159], v233 offset:4512
  v_mfma_f32_16x16x32_bf16 v[48:51], a[164:167], v[184:187], v[48:51]
  ds_read_b64_tr_b16 a[160:161], v233 offset:4288
  s_waitcnt lgkmcnt(7)
  s_nop 0
  v_mfma_f32_16x16x32_bf16 v[20:23], a[168:171], v[192:195], v[20:23]
  ds_read_b64_tr_b16 a[162:163], v233 offset:4544
  v_mfma_f32_16x16x32_bf16 v[24:27], a[168:171], v[196:199], v[24:27]
  ds_read_b64_tr_b16 a[164:165], v233 offset:4320
  v_mfma_f32_16x16x32_bf16 v[28:31], a[172:175], v[192:195], v[28:31]
  ds_read_b64_tr_b16 a[166:167], v233 offset:4576
  v_mfma_f32_16x16x32_bf16 v[32:35], a[172:175], v[196:199], v[32:35]
  ds_read_b64_tr_b16 a[168:169], v233 offset:8448
  v_mfma_f32_16x16x32_bf16 v[36:39], a[220:223], v[192:195], v[36:39]
  ds_read_b64_tr_b16 a[170:171], v233 offset:8704
  v_mfma_f32_16x16x32_bf16 v[40:43], a[220:223], v[196:199], v[40:43]
  ds_read_b64_tr_b16 a[172:173], v233 offset:8480
  s_add_u32 m0, s76, 0x8400
  v_mfma_f32_16x16x32_bf16 v[44:47], a[224:227], v[192:195], v[44:47]
  buffer_load_dwordx4 v242, s[20:23], s59 offen lds
  ds_read_b64_tr_b16 a[174:175], v233 offset:8736
  v_mfma_f32_16x16x32_bf16 v[48:51], a[224:227], v[196:199], v[48:51]
  ds_read_b64_tr_b16 a[220:221], v233 offset:8512
  v_mfma_f32_16x16x32_bf16 v[20:23], a[228:231], v[200:203], v[20:23]
  ds_read_b64_tr_b16 a[222:223], v233 offset:8768
  v_mfma_f32_16x16x32_bf16 v[24:27], a[228:231], v[204:207], v[24:27]
  ds_read_b64_tr_b16 a[224:225], v233 offset:8544
  v_mfma_f32_16x16x32_bf16 v[28:31], a[232:235], v[200:203], v[28:31]
  ds_read_b64_tr_b16 a[226:227], v233 offset:8800
  v_mfma_f32_16x16x32_bf16 v[32:35], a[232:235], v[204:207], v[32:35]
  ds_read_b64_tr_b16 a[228:229], v233 offset:12672
  v_mfma_f32_16x16x32_bf16 v[36:39], a[144:147], v[200:203], v[36:39]
  ds_read_b64_tr_b16 a[230:231], v233 offset:12928
  v_mfma_f32_16x16x32_bf16 v[40:43], a[144:147], v[204:207], v[40:43]
  ds_read_b64_tr_b16 a[232:233], v233 offset:12704
  s_waitcnt lgkmcnt(7)
  s_nop 0
  v_mfma_f32_16x16x32_bf16 v[44:47], a[148:151], v[200:203], v[44:47]
  ds_read_b64_tr_b16 a[234:235], v233 offset:12960
  v_mfma_f32_16x16x32_bf16 v[48:51], a[148:151], v[204:207], v[48:51]
  ds_read_b64_tr_b16 a[144:145], v233 offset:12736
  s_add_u32 m0, s76, 0x9480
  v_mfma_f32_16x16x32_bf16 v[20:23], a[152:155], v[208:211], v[20:23]
  buffer_load_dwordx4 v242, s[20:23], s60 offen lds
  ds_read_b64_tr_b16 a[146:147], v233 offset:12992
  v_mfma_f32_16x16x32_bf16 v[24:27], a[152:155], v[212:215], v[24:27]
  ds_read_b64_tr_b16 a[148:149], v233 offset:12768
  v_mfma_f32_16x16x32_bf16 v[28:31], a[156:159], v[208:211], v[28:31]
  ds_read_b64_tr_b16 a[150:151], v233 offset:13024
  v_mfma_f32_16x16x32_bf16 v[32:35], a[156:159], v[212:215], v[32:35]
  s_xor_b32 s67, s84, 7
  s_lshl_b32 s67, s67, 7
  v_add_u32_e64 v250, s67, v236
  ds_read_b64_tr_b16 a[152:153], v233 offset:16896
  v_mfma_f32_16x16x32_bf16 v[36:39], a[160:163], v[208:211], v[36:39]
  ds_read_b64_tr_b16 a[154:155], v233 offset:17152
  v_mfma_f32_16x16x32_bf16 v[40:43], a[160:163], v[212:215], v[40:43]
  ds_read_b64_tr_b16 a[156:157], v233 offset:16928
  v_mfma_f32_16x16x32_bf16 v[44:47], a[164:167], v[208:211], v[44:47]
  ds_read_b64_tr_b16 a[158:159], v233 offset:17184
  v_mfma_f32_16x16x32_bf16 v[48:51], a[164:167], v[212:215], v[48:51]
  ds_read_b64_tr_b16 a[160:161], v233 offset:16960
  s_add_u32 m0, s76, 0xa500
  v_mfma_f32_16x16x32_bf16 v[20:23], a[168:171], v[216:219], v[20:23]
  buffer_load_dwordx4 v242, s[20:23], s61 offen lds
  ds_read_b64_tr_b16 a[162:163], v233 offset:17216
  v_mfma_f32_16x16x32_bf16 v[24:27], a[168:171], v[220:223], v[24:27]
  ds_read_b64_tr_b16 a[164:165], v233 offset:16992
  v_mfma_f32_16x16x32_bf16 v[28:31], a[172:175], v[216:219], v[28:31]
  ds_read_b64_tr_b16 a[166:167], v233 offset:17248
  v_mfma_f32_16x16x32_bf16 v[32:35], a[172:175], v[220:223], v[32:35]
  ds_read_b64_tr_b16 a[168:169], v250 offset:0
  s_waitcnt lgkmcnt(7)
  s_nop 0
  v_mfma_f32_16x16x32_bf16 v[36:39], a[220:223], v[216:219], v[36:39]
  v_mfma_f32_16x16x32_bf16 v[40:43], a[220:223], v[220:223], v[40:43]
  ds_read_b64_tr_b16 a[172:173], v250 offset:32
  v_mfma_f32_16x16x32_bf16 v[44:47], a[224:227], v[216:219], v[44:47]
  v_mfma_f32_16x16x32_bf16 v[48:51], a[224:227], v[220:223], v[48:51]
  ds_read_b64_tr_b16 a[220:221], v250 offset:64
  v_mfma_f32_16x16x32_bf16 v[20:23], a[228:231], v[224:227], v[20:23]
  v_mfma_f32_16x16x32_bf16 v[24:27], a[228:231], v[228:231], v[24:27]
  ds_read_b64_tr_b16 a[224:225], v250 offset:96
  v_mfma_f32_16x16x32_bf16 v[28:31], a[232:235], v[224:227], v[28:31]
  v_mfma_f32_16x16x32_bf16 v[32:35], a[232:235], v[228:231], v[32:35]
  s_waitcnt vmcnt(14)
  s_barrier
  v_add_u32_e32 v233, 0x6300, v233
  ds_read_b64_tr_b16 a[228:229], v233 offset:0
  v_mfma_f32_16x16x32_bf16 v[36:39], a[144:147], v[224:227], v[36:39]
  ds_read_b64_tr_b16 a[230:231], v233 offset:256
  v_mfma_f32_16x16x32_bf16 v[40:43], a[144:147], v[228:231], v[40:43]
  ds_read_b64_tr_b16 a[232:233], v233 offset:32
  s_add_u32 m0, s76, 0xc600
  s_waitcnt vmcnt(6)
  buffer_store_dwordx2 v[248:249], v255, s[32:35], s70 offen sc1
  s_xor_b32 s39, s84, 7
  v_mfma_f32_16x16x32_bf16 v[44:47], a[148:151], v[224:227], v[44:47]
  buffer_load_dwordx4 v242, s[20:23], s62 offen lds
  ds_read_b64_tr_b16 a[234:235], v233 offset:288
  s_lshl_b32 s39, s39, 10
  s_add_u32 s39, s39, s97
  v_accvgpr_read_b32 v255, a219
  v_mfma_f32_16x16x32_bf16 v[48:51], a[148:151], v[228:231], v[48:51]
  ds_read_b64_tr_b16 a[144:145], v233 offset:64
  s_mov_b32 s36, 0
  s_nop 0
  v_mfma_f32_16x16x32_bf16 v[20:23], a[152:155], v[72:75], v[20:23]
  ds_read_b64_tr_b16 a[146:147], v233 offset:320
  v_mfma_f32_16x16x32_bf16 v[24:27], a[152:155], v[76:79], v[24:27]
  ds_read_b64_tr_b16 a[148:149], v233 offset:96
  s_waitcnt lgkmcnt(6)
  s_nop 0
  v_mfma_f32_16x16x32_bf16 v[28:31], a[156:159], v[72:75], v[28:31]
  ds_read_b64_tr_b16 a[150:151], v233 offset:352
  v_mfma_f32_16x16x32_bf16 v[32:35], a[156:159], v[76:79], v[32:35]
  ds_read_b64_tr_b16 a[152:153], v233 offset:4224
  s_add_u32 m0, s76, 0xd680
  v_mfma_f32_16x16x32_bf16 v[36:39], a[160:163], v[72:75], v[36:39]
  buffer_load_dwordx4 v242, s[20:23], s63 offen lds
  ds_read_b64_tr_b16 a[154:155], v233 offset:4480
  v_mfma_f32_16x16x32_bf16 v[40:43], a[160:163], v[76:79], v[40:43]
  ds_read_b64_tr_b16 a[156:157], v233 offset:4256
  v_mfma_f32_16x16x32_bf16 v[44:47], a[164:167], v[72:75], v[44:47]
  ds_read_b64_tr_b16 a[158:159], v233 offset:4512
  v_mfma_f32_16x16x32_bf16 v[48:51], a[164:167], v[76:79], v[48:51]
  ds_read_b64_tr_b16 a[160:161], v233 offset:4288
  v_mfma_f32_4x4x4_16b_bf16 v[20:23], a[168:169], v[96:97], v[20:23]
  ds_read_b64_tr_b16 a[162:163], v233 offset:4544
  v_mfma_f32_4x4x4_16b_bf16 v[24:27], a[168:169], v[98:99], v[24:27]
  ds_read_b64_tr_b16 a[164:165], v233 offset:4320
  v_mfma_f32_4x4x4_16b_bf16 v[28:31], a[172:173], v[96:97], v[28:31]
  ds_read_b64_tr_b16 a[166:167], v233 offset:4576
  v_cvt_pk_bf16_f32 v20, v20, v21
  v_cvt_pk_bf16_f32 v21, v22, v23
  v_mfma_f32_4x4x4_16b_bf16 v[32:35], a[172:173], v[98:99], v[32:35]
  ds_read_b64_tr_b16 a[168:169], v233 offset:8448
  s_add_u32 m0, s76, 0xe700
  v_cvt_pk_bf16_f32 v22, v28, v29
  v_mfma_f32_4x4x4_16b_bf16 v[36:39], a[220:221], v[96:97], v[36:39]
  buffer_load_dwordx4 v242, s[20:23], s64 offen lds
  ds_read_b64_tr_b16 a[170:171], v233 offset:8704
  v_cvt_pk_bf16_f32 v23, v30, v31
  v_mfma_f32_4x4x4_16b_bf16 v[40:43], a[220:221], v[98:99], v[40:43]
  ds_read_b64_tr_b16 a[172:173], v233 offset:8480
  buffer_store_dwordx4 v[20:23], v251, s[32:35], s37 offen sc1
  v_cvt_pk_bf16_f32 v24, v24, v25
  v_mfma_f32_4x4x4_16b_bf16 v[44:47], a[224:225], v[96:97], v[44:47]
  ds_read_b64_tr_b16 a[174:175], v233 offset:8736
  v_cvt_pk_bf16_f32 v25, v26, v27
  v_cvt_pk_bf16_f32 v26, v32, v33
  v_mfma_f32_4x4x4_16b_bf16 v[48:51], a[224:225], v[98:99], v[48:51]
  ds_read_b64_tr_b16 a[220:221], v233 offset:8512
  v_cvt_pk_bf16_f32 v27, v34, v35
  s_waitcnt lgkmcnt(8)
  s_nop 0
  v_mfma_f32_16x16x32_bf16 v[0:3], a[228:231], v[128:131], 0
  ds_read_b64_tr_b16 a[222:223], v233 offset:8768
  buffer_store_dwordx4 v[24:27], v251, s[32:35], s37 offen offset:1024 sc1
  s_xor_b32 s37, s96, 0x70c000
  v_mfma_f32_16x16x32_bf16 v[4:7], a[228:231], v[136:139], 0
  ds_read_b64_tr_b16 a[224:225], v233 offset:8544
  s_add_u32 m0, s76, 0xf780
  v_cvt_pk_bf16_f32 v36, v36, v37
  v_mfma_f32_16x16x32_bf16 v[8:11], a[232:235], v[128:131], 0
  buffer_load_dwordx4 v242, s[20:23], s65 offen lds
  ds_read_b64_tr_b16 a[226:227], v233 offset:8800
  v_cvt_pk_bf16_f32 v37, v38, v39
  v_mfma_f32_16x16x32_bf16 v[12:15], a[232:235], v[136:139], 0
  ds_read_b64_tr_b16 a[228:229], v233 offset:12672
  v_cvt_pk_bf16_f32 v38, v44, v45
  v_cvt_pk_bf16_f32 v39, v46, v47
  v_mfma_f32_16x16x32_bf16 v[16:19], a[144:147], v[128:131], 0
  ds_read_b64_tr_b16 a[230:231], v233 offset:12928
  buffer_store_dwordx4 v[36:39], v251, s[32:35], s37 offen sc1
  v_cvt_pk_bf16_f32 v40, v40, v41
  v_mfma_f32_16x16x32_bf16 v[188:191], a[144:147], v[136:139], 0
  ds_read_b64_tr_b16 a[232:233], v233 offset:12704
  v_cvt_pk_bf16_f32 v41, v42, v43
  v_cvt_pk_bf16_f32 v42, v48, v49
  v_mfma_f32_16x16x32_bf16 v[132:135], a[148:151], v[128:131], 0
  ds_read_b64_tr_b16 a[234:235], v233 offset:12960
  v_cvt_pk_bf16_f32 v43, v50, v51
  buffer_store_dwordx4 v[40:43], v251, s[32:35], s37 offen offset:1024 sc1
  v_mfma_f32_16x16x32_bf16 v[140:143], a[148:151], v[136:139], 0
  ds_read_b64_tr_b16 a[144:145], v233 offset:12736
  s_xor_b32 s37, s96, 0xb00000
  v_mfma_f32_16x16x32_bf16 v[0:3], a[152:155], v[144:147], v[0:3]
  ds_read_b64_tr_b16 a[146:147], v233 offset:12992
  v_mfma_f32_16x16x32_bf16 v[4:7], a[152:155], v[152:155], v[4:7]
  ds_read_b64_tr_b16 a[148:149], v233 offset:12768
  s_add_u32 m0, s76, 0x10800
  v_mfma_f32_16x16x32_bf16 v[8:11], a[156:159], v[144:147], v[8:11]
  buffer_load_dwordx4 v243, s[24:27], 0 offen lds
  ds_read_b64_tr_b16 a[150:151], v233 offset:13024
  v_mfma_f32_16x16x32_bf16 v[12:15], a[156:159], v[152:155], v[12:15]
  ds_read_b64_tr_b16 a[152:153], v233 offset:16896
  s_waitcnt lgkmcnt(7)
  s_nop 0
  v_mfma_f32_16x16x32_bf16 v[16:19], a[160:163], v[144:147], v[16:19]
  ds_read_b64_tr_b16 a[154:155], v233 offset:17152
  v_mfma_f32_16x16x32_bf16 v[188:191], a[160:163], v[152:155], v[188:191]
  ds_read_b64_tr_b16 a[156:157], v233 offset:16928
  v_mfma_f32_16x16x32_bf16 v[132:135], a[164:167], v[144:147], v[132:135]
  ds_read_b64_tr_b16 a[158:159], v233 offset:17184
  v_mfma_f32_16x16x32_bf16 v[140:143], a[164:167], v[152:155], v[140:143]
  ds_read_b64_tr_b16 a[160:161], v233 offset:16960
  v_mfma_f32_16x16x32_bf16 v[0:3], a[168:171], v[160:163], v[0:3]
  ds_read_b64_tr_b16 a[162:163], v233 offset:17216
  v_mfma_f32_16x16x32_bf16 v[4:7], a[168:171], v[168:171], v[4:7]
  ds_read_b64_tr_b16 a[164:165], v233 offset:16992
  v_mfma_f32_16x16x32_bf16 v[8:11], a[172:175], v[160:163], v[8:11]
  ds_read_b64_tr_b16 a[166:167], v233 offset:17248
  v_mfma_f32_16x16x32_bf16 v[12:15], a[172:175], v[168:171], v[12:15]
  s_waitcnt vmcnt(15)
  s_barrier
  v_add_u32_e32 v233, 0xfffe7400, v233
  ds_read_b64_tr_b16 a[168:169], v233 offset:0
  v_mfma_f32_16x16x32_bf16 v[16:19], a[220:223], v[160:163], v[16:19]
  ds_read_b64_tr_b16 a[170:171], v233 offset:256
  v_mfma_f32_16x16x32_bf16 v[188:191], a[220:223], v[168:171], v[188:191]
  ds_read_b64_tr_b16 a[172:173], v233 offset:32
  s_add_u32 m0, s76, 0x12900
  s_xor_b32 s66, s84, 4
  s_lshl_b32 s66, s66, 7
  v_add_u32_e32 v242, s66, v234
  v_add_u32_e32 v243, s66, v235
  v_mfma_f32_16x16x32_bf16 v[132:135], a[224:227], v[160:163], v[132:135]
  buffer_load_dwordx4 v242, s[20:23], s57 offen lds
  ds_read_b64_tr_b16 a[174:175], v233 offset:288
  v_mfma_f32_16x16x32_bf16 v[140:143], a[224:227], v[168:171], v[140:143]
  ds_read_b64_tr_b16 a[220:221], v233 offset:64
  v_mfma_f32_16x16x32_bf16 v[0:3], a[228:231], v[176:179], v[0:3]
  ds_read_b64_tr_b16 a[222:223], v233 offset:320
  v_mfma_f32_16x16x32_bf16 v[4:7], a[228:231], v[184:187], v[4:7]
  ds_read_b64_tr_b16 a[224:225], v233 offset:96
  s_waitcnt lgkmcnt(6)
  s_nop 0
  v_mfma_f32_16x16x32_bf16 v[8:11], a[232:235], v[176:179], v[8:11]
  ds_read_b64_tr_b16 a[226:227], v233 offset:352
  v_mfma_f32_16x16x32_bf16 v[12:15], a[232:235], v[184:187], v[12:15]
  ds_read_b64_tr_b16 a[228:229], v233 offset:4224
  v_mfma_f32_16x16x32_bf16 v[16:19], a[144:147], v[176:179], v[16:19]
  ds_read_b64_tr_b16 a[230:231], v233 offset:4480
  v_mfma_f32_16x16x32_bf16 v[188:191], a[144:147], v[184:187], v[188:191]
  ds_read_b64_tr_b16 a[232:233], v233 offset:4256
  s_add_u32 m0, s76, 0x13980
  v_mfma_f32_16x16x32_bf16 v[132:135], a[148:151], v[176:179], v[132:135]
  buffer_load_dwordx4 v242, s[20:23], s58 offen lds
  ds_read_b64_tr_b16 a[234:235], v233 offset:4512
  v_mfma_f32_16x16x32_bf16 v[140:143], a[148:151], v[184:187], v[140:143]
  ds_read_b64_tr_b16 a[144:145], v233 offset:4288
  v_mfma_f32_16x16x32_bf16 v[0:3], a[152:155], v[192:195], v[0:3]
  ds_read_b64_tr_b16 a[146:147], v233 offset:4544
  v_mfma_f32_16x16x32_bf16 v[4:7], a[152:155], v[196:199], v[4:7]
  ds_read_b64_tr_b16 a[148:149], v233 offset:4320
  v_mfma_f32_16x16x32_bf16 v[8:11], a[156:159], v[192:195], v[8:11]
  ds_read_b64_tr_b16 a[150:151], v233 offset:4576
  v_mfma_f32_16x16x32_bf16 v[12:15], a[156:159], v[196:199], v[12:15]
  ds_read_b64_tr_b16 a[152:153], v233 offset:8448
  v_mfma_f32_16x16x32_bf16 v[16:19], a[160:163], v[192:195], v[16:19]
  ds_read_b64_tr_b16 a[154:155], v233 offset:8704
  v_mfma_f32_16x16x32_bf16 v[188:191], a[160:163], v[196:199], v[188:191]
  ds_read_b64_tr_b16 a[156:157], v233 offset:8480
  s_add_u32 m0, s76, 0x14a00
  v_mfma_f32_16x16x32_bf16 v[132:135], a[164:167], v[192:195], v[132:135]
  buffer_load_dwordx4 v242, s[20:23], s59 offen lds
  ds_read_b64_tr_b16 a[158:159], v233 offset:8736
  v_mfma_f32_16x16x32_bf16 v[140:143], a[164:167], v[196:199], v[140:143]
  ds_read_b64_tr_b16 a[160:161], v233 offset:8512
  s_waitcnt lgkmcnt(7)
  s_nop 0
  v_mfma_f32_16x16x32_bf16 v[0:3], a[168:171], v[200:203], v[0:3]
  ds_read_b64_tr_b16 a[162:163], v233 offset:8768
  v_mfma_f32_16x16x32_bf16 v[4:7], a[168:171], v[204:207], v[4:7]
  ds_read_b64_tr_b16 a[164:165], v233 offset:8544
  v_mfma_f32_16x16x32_bf16 v[8:11], a[172:175], v[200:203], v[8:11]
  ds_read_b64_tr_b16 a[166:167], v233 offset:8800
  v_mfma_f32_16x16x32_bf16 v[12:15], a[172:175], v[204:207], v[12:15]
  ds_read_b64_tr_b16 a[168:169], v233 offset:12672
  v_mfma_f32_16x16x32_bf16 v[16:19], a[220:223], v[200:203], v[16:19]
  ds_read_b64_tr_b16 a[170:171], v233 offset:12928
  v_mfma_f32_16x16x32_bf16 v[188:191], a[220:223], v[204:207], v[188:191]
  ds_read_b64_tr_b16 a[172:173], v233 offset:12704
  v_mfma_f32_16x16x32_bf16 v[132:135], a[224:227], v[200:203], v[132:135]
  ds_read_b64_tr_b16 a[174:175], v233 offset:12960
  v_mfma_f32_16x16x32_bf16 v[140:143], a[224:227], v[204:207], v[140:143]
  ds_read_b64_tr_b16 a[220:221], v233 offset:12736
  s_add_u32 m0, s76, 0x15a80
  v_mfma_f32_16x16x32_bf16 v[0:3], a[228:231], v[208:211], v[0:3]
  buffer_load_dwordx4 v242, s[20:23], s60 offen lds
  ds_read_b64_tr_b16 a[222:223], v233 offset:12992
  v_mfma_f32_16x16x32_bf16 v[4:7], a[228:231], v[212:215], v[4:7]
  ds_read_b64_tr_b16 a[224:225], v233 offset:12768
  v_mfma_f32_16x16x32_bf16 v[8:11], a[232:235], v[208:211], v[8:11]
  ds_read_b64_tr_b16 a[226:227], v233 offset:13024
  v_mfma_f32_16x16x32_bf16 v[12:15], a[232:235], v[212:215], v[12:15]
  s_xor_b32 s67, s84, 6
  s_lshl_b32 s67, s67, 7
  v_add_u32_e64 v250, s67, v236
  ds_read_b64_tr_b16 a[228:229], v233 offset:16896
  v_mfma_f32_16x16x32_bf16 v[16:19], a[144:147], v[208:211], v[16:19]
  ds_read_b64_tr_b16 a[230:231], v233 offset:17152
  v_mfma_f32_16x16x32_bf16 v[188:191], a[144:147], v[212:215], v[188:191]
  ds_read_b64_tr_b16 a[232:233], v233 offset:16928
  s_waitcnt lgkmcnt(7)
  s_nop 0
  v_mfma_f32_16x16x32_bf16 v[132:135], a[148:151], v[208:211], v[132:135]
  ds_read_b64_tr_b16 a[234:235], v233 offset:17184
  v_mfma_f32_16x16x32_bf16 v[140:143], a[148:151], v[212:215], v[140:143]
  ds_read_b64_tr_b16 a[144:145], v233 offset:16960
  s_add_u32 m0, s76, 0x16b00
  v_mfma_f32_16x16x32_bf16 v[0:3], a[152:155], v[216:219], v[0:3]
  buffer_load_dwordx4 v242, s[20:23], s61 offen lds
  ds_read_b64_tr_b16 a[146:147], v233 offset:17216
  v_mfma_f32_16x16x32_bf16 v[4:7], a[152:155], v[220:223], v[4:7]
  ds_read_b64_tr_b16 a[148:149], v233 offset:16992
  v_mfma_f32_16x16x32_bf16 v[8:11], a[156:159], v[216:219], v[8:11]
  ds_read_b64_tr_b16 a[150:151], v233 offset:17248
  v_mfma_f32_16x16x32_bf16 v[12:15], a[156:159], v[220:223], v[12:15]
  ds_read_b64_tr_b16 a[152:153], v250 offset:0
  v_mfma_f32_16x16x32_bf16 v[16:19], a[160:163], v[216:219], v[16:19]
  v_mfma_f32_16x16x32_bf16 v[188:191], a[160:163], v[220:223], v[188:191]
  ds_read_b64_tr_b16 a[156:157], v250 offset:32
  v_mfma_f32_16x16x32_bf16 v[132:135], a[164:167], v[216:219], v[132:135]
  v_mfma_f32_16x16x32_bf16 v[140:143], a[164:167], v[220:223], v[140:143]
  ds_read_b64_tr_b16 a[160:161], v250 offset:64
  v_mfma_f32_16x16x32_bf16 v[0:3], a[168:171], v[224:227], v[0:3]
  v_mfma_f32_16x16x32_bf16 v[4:7], a[168:171], v[228:231], v[4:7]
  ds_read_b64_tr_b16 a[164:165], v250 offset:96
  v_mfma_f32_16x16x32_bf16 v[8:11], a[172:175], v[224:227], v[8:11]
  v_mfma_f32_16x16x32_bf16 v[12:15], a[172:175], v[228:231], v[12:15]
  s_waitcnt vmcnt(15)
  s_barrier
  v_add_u32_e32 v233, 0x6300, v233
  ds_read_b64_tr_b16 a[168:169], v233 offset:0
  s_waitcnt lgkmcnt(3)
  s_nop 0
  v_mfma_f32_16x16x32_bf16 v[16:19], a[220:223], v[224:227], v[16:19]
  ds_read_b64_tr_b16 a[170:171], v233 offset:256
  v_mfma_f32_16x16x32_bf16 v[188:191], a[220:223], v[228:231], v[188:191]
  ds_read_b64_tr_b16 a[172:173], v233 offset:32
  s_add_u32 m0, s76, 0x18c00
  v_mfma_f32_16x16x32_bf16 v[132:135], a[224:227], v[224:227], v[132:135]
  buffer_load_dwordx4 v242, s[20:23], s62 offen lds
  ds_read_b64_tr_b16 a[174:175], v233 offset:288
  v_mfma_f32_16x16x32_bf16 v[140:143], a[224:227], v[228:231], v[140:143]
  ds_read_b64_tr_b16 a[220:221], v233 offset:64
  v_mfma_f32_16x16x32_bf16 v[0:3], a[228:231], v[72:75], v[0:3]
  ds_read_b64_tr_b16 a[222:223], v233 offset:320
  s_waitcnt vmcnt(7)
  buffer_store_dwordx2 v[248:249], v252, s[32:35], s39 offen sc1
  s_xor_b32 s39, s84, 6
  s_lshl_b32 s39, s39, 10
  v_mfma_f32_16x16x32_bf16 v[4:7], a[228:231], v[76:79], v[4:7]
  ds_read_b64_tr_b16 a[224:225], v233 offset:96
  s_add_u32 s39, s39, s97
  v_mfma_f32_16x16x32_bf16 v[8:11], a[232:235], v[72:75], v[8:11]
  ds_read_b64_tr_b16 a[226:227], v233 offset:352
  v_mfma_f32_16x16x32_bf16 v[12:15], a[232:235], v[76:79], v[12:15]
  ds_read_b64_tr_b16 a[228:229], v233 offset:4224
  s_add_u32 m0, s76, 0x19c80
  v_mfma_f32_16x16x32_bf16 v[16:19], a[144:147], v[72:75], v[16:19]
  buffer_load_dwordx4 v242, s[20:23], s63 offen lds
  ds_read_b64_tr_b16 a[230:231], v233 offset:4480
  v_mfma_f32_16x16x32_bf16 v[188:191], a[144:147], v[76:79], v[188:191]
  ds_read_b64_tr_b16 a[232:233], v233 offset:4256
  v_mfma_f32_16x16x32_bf16 v[132:135], a[148:151], v[72:75], v[132:135]
  ds_read_b64_tr_b16 a[234:235], v233 offset:4512
  v_mfma_f32_16x16x32_bf16 v[140:143], a[148:151], v[76:79], v[140:143]
  ds_read_b64_tr_b16 a[144:145], v233 offset:4288
  v_mfma_f32_4x4x4_16b_bf16 v[0:3], a[152:153], v[96:97], v[0:3]
  ds_read_b64_tr_b16 a[146:147], v233 offset:4544
  v_mfma_f32_4x4x4_16b_bf16 v[4:7], a[152:153], v[98:99], v[4:7]
  ds_read_b64_tr_b16 a[148:149], v233 offset:4320
  v_mfma_f32_4x4x4_16b_bf16 v[8:11], a[156:157], v[96:97], v[8:11]
  ds_read_b64_tr_b16 a[150:151], v233 offset:4576
  v_cvt_pk_bf16_f32 v0, v0, v1
  v_cvt_pk_bf16_f32 v1, v2, v3
  v_mfma_f32_4x4x4_16b_bf16 v[12:15], a[156:157], v[98:99], v[12:15]
  ds_read_b64_tr_b16 a[152:153], v233 offset:8448
  s_add_u32 m0, s76, 0x1ad00
  s_waitcnt lgkmcnt(8)
  s_nop 0
  v_mfma_f32_4x4x4_16b_bf16 v[16:19], a[160:161], v[96:97], v[16:19]
  buffer_load_dwordx4 v242, s[20:23], s64 offen lds
  ds_read_b64_tr_b16 a[154:155], v233 offset:8704
  v_cvt_pk_bf16_f32 v2, v8, v9
  v_mfma_f32_4x4x4_16b_bf16 v[188:191], a[160:161], v[98:99], v[188:191]
  ds_read_b64_tr_b16 a[156:157], v233 offset:8480
  v_cvt_pk_bf16_f32 v3, v10, v11
  buffer_store_dwordx4 v[0:3], v251, s[32:35], s37 offen sc1
  v_mfma_f32_4x4x4_16b_bf16 v[132:135], a[164:165], v[96:97], v[132:135]
  ds_read_b64_tr_b16 a[158:159], v233 offset:8736
  v_cvt_pk_bf16_f32 v4, v4, v5
  v_cvt_pk_bf16_f32 v5, v6, v7
  v_mfma_f32_4x4x4_16b_bf16 v[140:143], a[164:165], v[98:99], v[140:143]
  ds_read_b64_tr_b16 a[160:161], v233 offset:8512
  buffer_load_dwordx2 v[246:247], v253, s[32:35], s71 offen sc1
  v_cvt_pk_bf16_f32 v6, v12, v13
  v_mfma_f32_16x16x32_bf16 v[52:55], a[168:171], v[128:131], 0
  ds_read_b64_tr_b16 a[162:163], v233 offset:8768
  v_cvt_pk_bf16_f32 v7, v14, v15
  buffer_store_dwordx4 v[4:7], v251, s[32:35], s37 offen offset:1024 sc1
  v_mfma_f32_16x16x32_bf16 v[56:59], a[168:171], v[136:139], 0
  ds_read_b64_tr_b16 a[164:165], v233 offset:8544
  s_add_u32 m0, s76, 0x1bd80
  s_xor_b32 s37, s96, 0xb04000
  v_mfma_f32_16x16x32_bf16 v[60:63], a[172:175], v[128:131], 0
  buffer_load_dwordx4 v242, s[20:23], s65 offen lds
  ds_read_b64_tr_b16 a[166:167], v233 offset:8800
  v_cvt_pk_bf16_f32 v16, v16, v17
  v_mfma_f32_16x16x32_bf16 v[64:67], a[172:175], v[136:139], 0
  ds_read_b64_tr_b16 a[168:169], v233 offset:12672
  v_cvt_pk_bf16_f32 v17, v18, v19
  v_cvt_pk_bf16_f32 v18, v132, v133
  v_mfma_f32_16x16x32_bf16 v[164:167], a[220:223], v[128:131], 0
  ds_read_b64_tr_b16 a[170:171], v233 offset:12928
  v_cvt_pk_bf16_f32 v19, v134, v135
  buffer_store_dwordx4 v[16:19], v251, s[32:35], s37 offen sc1
  v_mfma_f32_16x16x32_bf16 v[172:175], a[220:223], v[136:139], 0
  ds_read_b64_tr_b16 a[172:173], v233 offset:12704
  v_cvt_pk_bf16_f32 v188, v188, v189
  v_cvt_pk_bf16_f32 v189, v190, v191
  v_mfma_f32_16x16x32_bf16 v[68:71], a[224:227], v[128:131], 0
  ds_read_b64_tr_b16 a[174:175], v233 offset:12960
  v_cvt_pk_bf16_f32 v190, v140, v141
  v_cvt_pk_bf16_f32 v191, v142, v143
  v_mfma_f32_16x16x32_bf16 v[180:183], a[224:227], v[136:139], 0
  ds_read_b64_tr_b16 a[220:221], v233 offset:12736
  buffer_store_dwordx4 v[188:191], v251, s[32:35], s37 offen offset:1024 sc1
  s_waitcnt lgkmcnt(6)
  s_nop 0
  v_mfma_f32_16x16x32_bf16 v[52:55], a[228:231], v[144:147], v[52:55]
  ds_read_b64_tr_b16 a[222:223], v233 offset:12992
  s_xor_b32 s37, s96, 0xe08000
  v_mfma_f32_16x16x32_bf16 v[56:59], a[228:231], v[152:155], v[56:59]
  ds_read_b64_tr_b16 a[224:225], v233 offset:12768
  s_add_u32 m0, s76, 0x1ce00
  v_mfma_f32_16x16x32_bf16 v[60:63], a[232:235], v[144:147], v[60:63]
  buffer_load_dwordx4 v243, s[24:27], 0 offen lds
  ds_read_b64_tr_b16 a[226:227], v233 offset:13024
  v_mfma_f32_16x16x32_bf16 v[64:67], a[232:235], v[152:155], v[64:67]
  ds_read_b64_tr_b16 a[228:229], v233 offset:16896
  v_mfma_f32_16x16x32_bf16 v[164:167], a[144:147], v[144:147], v[164:167]
  ds_read_b64_tr_b16 a[230:231], v233 offset:17152
  v_mfma_f32_16x16x32_bf16 v[172:175], a[144:147], v[152:155], v[172:175]
  ds_read_b64_tr_b16 a[232:233], v233 offset:16928
  v_mfma_f32_16x16x32_bf16 v[68:71], a[148:151], v[144:147], v[68:71]
  ds_read_b64_tr_b16 a[234:235], v233 offset:17184
  v_mfma_f32_16x16x32_bf16 v[180:183], a[148:151], v[152:155], v[180:183]
  ds_read_b64_tr_b16 a[144:145], v233 offset:16960
  v_mfma_f32_16x16x32_bf16 v[52:55], a[152:155], v[160:163], v[52:55]
  ds_read_b64_tr_b16 a[146:147], v233 offset:17216
  v_mfma_f32_16x16x32_bf16 v[56:59], a[152:155], v[168:171], v[56:59]
  ds_read_b64_tr_b16 a[148:149], v233 offset:16992
  v_mfma_f32_16x16x32_bf16 v[60:63], a[156:159], v[160:163], v[60:63]
  ds_read_b64_tr_b16 a[150:151], v233 offset:17248
  v_mfma_f32_16x16x32_bf16 v[64:67], a[156:159], v[168:171], v[64:67]
  s_waitcnt vmcnt(16)
  s_barrier
  v_add_u32_e32 v233, 0x6300, v233
  ds_read_b64_tr_b16 a[152:153], v233 offset:0
  v_mfma_f32_16x16x32_bf16 v[164:167], a[160:163], v[160:163], v[164:167]
  ds_read_b64_tr_b16 a[154:155], v233 offset:256
  v_mfma_f32_16x16x32_bf16 v[172:175], a[160:163], v[168:171], v[172:175]
  ds_read_b64_tr_b16 a[156:157], v233 offset:32
  s_add_u32 m0, s76, 0
  s_xor_b32 s66, s84, 3
  s_lshl_b32 s66, s66, 7
  v_add_u32_e32 v242, s66, v234
  v_add_u32_e32 v243, s66, v235
  s_waitcnt lgkmcnt(5)
  v_mfma_f32_16x16x32_bf16 v[68:71], a[164:167], v[160:163], v[68:71]
  buffer_load_dwordx4 v242, s[20:23], s57 offen lds
  ds_read_b64_tr_b16 a[158:159], v233 offset:288
  v_mfma_f32_16x16x32_bf16 v[180:183], a[164:167], v[168:171], v[180:183]
  ds_read_b64_tr_b16 a[160:161], v233 offset:64
  v_mfma_f32_16x16x32_bf16 v[52:55], a[168:171], v[176:179], v[52:55]
  ds_read_b64_tr_b16 a[162:163], v233 offset:320
  v_mfma_f32_16x16x32_bf16 v[56:59], a[168:171], v[184:187], v[56:59]
  ds_read_b64_tr_b16 a[164:165], v233 offset:96
  v_mfma_f32_16x16x32_bf16 v[60:63], a[172:175], v[176:179], v[60:63]
  ds_read_b64_tr_b16 a[166:167], v233 offset:352
  v_mfma_f32_16x16x32_bf16 v[64:67], a[172:175], v[184:187], v[64:67]
  ds_read_b64_tr_b16 a[168:169], v233 offset:4224
  v_mfma_f32_16x16x32_bf16 v[164:167], a[220:223], v[176:179], v[164:167]
  ds_read_b64_tr_b16 a[170:171], v233 offset:4480
  v_mfma_f32_16x16x32_bf16 v[172:175], a[220:223], v[184:187], v[172:175]
  ds_read_b64_tr_b16 a[172:173], v233 offset:4256
  s_add_u32 m0, s76, 0x1080
  v_mfma_f32_16x16x32_bf16 v[68:71], a[224:227], v[176:179], v[68:71]
  buffer_load_dwordx4 v242, s[20:23], s58 offen lds
  ds_read_b64_tr_b16 a[174:175], v233 offset:4512
  v_mfma_f32_16x16x32_bf16 v[180:183], a[224:227], v[184:187], v[180:183]
  ds_read_b64_tr_b16 a[220:221], v233 offset:4288
  v_mfma_f32_16x16x32_bf16 v[52:55], a[228:231], v[192:195], v[52:55]
  ds_read_b64_tr_b16 a[222:223], v233 offset:4544
  v_mfma_f32_16x16x32_bf16 v[56:59], a[228:231], v[196:199], v[56:59]
  ds_read_b64_tr_b16 a[224:225], v233 offset:4320
  v_mfma_f32_16x16x32_bf16 v[60:63], a[232:235], v[192:195], v[60:63]
  ds_read_b64_tr_b16 a[226:227], v233 offset:4576
  v_mfma_f32_16x16x32_bf16 v[64:67], a[232:235], v[196:199], v[64:67]
  ds_read_b64_tr_b16 a[228:229], v233 offset:8448
  v_mfma_f32_16x16x32_bf16 v[164:167], a[144:147], v[192:195], v[164:167]
  ds_read_b64_tr_b16 a[230:231], v233 offset:8704
  v_mfma_f32_16x16x32_bf16 v[172:175], a[144:147], v[196:199], v[172:175]
  ds_read_b64_tr_b16 a[232:233], v233 offset:8480
  s_add_u32 m0, s76, 0x2100
  s_waitcnt lgkmcnt(7)
  s_nop 0
  v_mfma_f32_16x16x32_bf16 v[68:71], a[148:151], v[192:195], v[68:71]
  buffer_load_dwordx4 v242, s[20:23], s59 offen lds
  ds_read_b64_tr_b16 a[234:235], v233 offset:8736
  v_mfma_f32_16x16x32_bf16 v[180:183], a[148:151], v[196:199], v[180:183]
  ds_read_b64_tr_b16 a[144:145], v233 offset:8512
  v_mfma_f32_16x16x32_bf16 v[52:55], a[152:155], v[200:203], v[52:55]
  ds_read_b64_tr_b16 a[146:147], v233 offset:8768
  v_mfma_f32_16x16x32_bf16 v[56:59], a[152:155], v[204:207], v[56:59]
  ds_read_b64_tr_b16 a[148:149], v233 offset:8544
  v_mfma_f32_16x16x32_bf16 v[60:63], a[156:159], v[200:203], v[60:63]
  ds_read_b64_tr_b16 a[150:151], v233 offset:8800
  v_mfma_f32_16x16x32_bf16 v[64:67], a[156:159], v[204:207], v[64:67]
  ds_read_b64_tr_b16 a[152:153], v233 offset:12672
  v_mfma_f32_16x16x32_bf16 v[164:167], a[160:163], v[200:203], v[164:167]
  ds_read_b64_tr_b16 a[154:155], v233 offset:12928
  v_mfma_f32_16x16x32_bf16 v[172:175], a[160:163], v[204:207], v[172:175]
  ds_read_b64_tr_b16 a[156:157], v233 offset:12704
  v_mfma_f32_16x16x32_bf16 v[68:71], a[164:167], v[200:203], v[68:71]
  ds_read_b64_tr_b16 a[158:159], v233 offset:12960
  v_mfma_f32_16x16x32_bf16 v[180:183], a[164:167], v[204:207], v[180:183]
  ds_read_b64_tr_b16 a[160:161], v233 offset:12736
  s_add_u32 m0, s76, 0x3180
  v_mfma_f32_16x16x32_bf16 v[52:55], a[168:171], v[208:211], v[52:55]
  buffer_load_dwordx4 v242, s[20:23], s60 offen lds
  ds_read_b64_tr_b16 a[162:163], v233 offset:12992
  v_mfma_f32_16x16x32_bf16 v[56:59], a[168:171], v[212:215], v[56:59]
  ds_read_b64_tr_b16 a[164:165], v233 offset:12768
  v_mfma_f32_16x16x32_bf16 v[60:63], a[172:175], v[208:211], v[60:63]
  ds_read_b64_tr_b16 a[166:167], v233 offset:13024
  v_mfma_f32_16x16x32_bf16 v[64:67], a[172:175], v[212:215], v[64:67]
  s_xor_b32 s67, s84, 5
  s_lshl_b32 s67, s67, 7
  v_add_u32_e64 v250, s67, v236
  ds_read_b64_tr_b16 a[168:169], v233 offset:16896
  s_waitcnt lgkmcnt(6)
  s_nop 0
  v_mfma_f32_16x16x32_bf16 v[164:167], a[220:223], v[208:211], v[164:167]
  ds_read_b64_tr_b16 a[170:171], v233 offset:17152
  v_mfma_f32_16x16x32_bf16 v[172:175], a[220:223], v[212:215], v[172:175]
  ds_read_b64_tr_b16 a[172:173], v233 offset:16928
  v_mfma_f32_16x16x32_bf16 v[68:71], a[224:227], v[208:211], v[68:71]
  ds_read_b64_tr_b16 a[174:175], v233 offset:17184
  v_mfma_f32_16x16x32_bf16 v[180:183], a[224:227], v[212:215], v[180:183]
  ds_read_b64_tr_b16 a[220:221], v233 offset:16960
  s_add_u32 m0, s76, 0x4200
  v_mfma_f32_16x16x32_bf16 v[52:55], a[228:231], v[216:219], v[52:55]
  buffer_load_dwordx4 v242, s[20:23], s61 offen lds
  ds_read_b64_tr_b16 a[222:223], v233 offset:17216
  v_mfma_f32_16x16x32_bf16 v[56:59], a[228:231], v[220:223], v[56:59]
  ds_read_b64_tr_b16 a[224:225], v233 offset:16992
  s_waitcnt vmcnt(10)
  v_cmp_eq_u64_e64 s[94:95], v[246:247], s[74:75]
  s_mov_b32 s83, 0xffff0000
  s_xor_b32 s82, s84, 1
  v_mfma_f32_16x16x32_bf16 v[60:63], a[232:235], v[216:219], v[60:63]
  ds_read_b64_tr_b16 a[226:227], v233 offset:17248
  s_lshl_b32 s82, s82, 1
  s_lshl_b32 s82, 3, s82
  s_or_b32 s83, s83, s82
  s_xor_b32 s82, s4, 1
  v_mfma_f32_16x16x32_bf16 v[64:67], a[232:235], v[220:223], v[64:67]
  ds_read_b64_tr_b16 a[228:229], v250 offset:0
  s_bitset1_b32 s83, s82
  s_andn2_b32 s83, s83, s94
  s_or_b32 s36, s36, s83
  s_cmp_lt_u32 s83, 0x10000
  s_cselect_b32 s82, s98, 0x7ffffff0
  s_nop 0
  v_mfma_f32_16x16x32_bf16 v[164:167], a[144:147], v[216:219], v[164:167]
  buffer_load_dwordx4 a[128:131], v251, s[32:35], s82 offen sc1
  buffer_load_dwordx4 a[132:135], v251, s[32:35], s82 offen offset:1024 sc1
  buffer_load_dwordx4 a[136:139], v251, s[32:35], s82 offen offset:2048 sc1
  buffer_load_dwordx4 a[140:143], v251, s[32:35], s82 offen offset:3072 sc1
  v_mfma_f32_16x16x32_bf16 v[172:175], a[144:147], v[220:223], v[172:175]
  ds_read_b64_tr_b16 a[232:233], v250 offset:32
  v_mfma_f32_16x16x32_bf16 v[68:71], a[148:151], v[216:219], v[68:71]
  v_mfma_f32_16x16x32_bf16 v[180:183], a[148:151], v[220:223], v[180:183]
  ds_read_b64_tr_b16 a[144:145], v250 offset:64
  v_mfma_f32_16x16x32_bf16 v[52:55], a[152:155], v[224:227], v[52:55]
  v_mfma_f32_16x16x32_bf16 v[56:59], a[152:155], v[228:231], v[56:59]
  ds_read_b64_tr_b16 a[148:149], v250 offset:96
  s_waitcnt lgkmcnt(3)
  v_mfma_f32_16x16x32_bf16 v[60:63], a[156:159], v[224:227], v[60:63]
  v_mfma_f32_16x16x32_bf16 v[64:67], a[156:159], v[228:231], v[64:67]
  s_barrier
  v_add_u32_e32 v233, 0x6300, v233
  ds_read_b64_tr_b16 a[152:153], v233 offset:0
  v_mfma_f32_16x16x32_bf16 v[164:167], a[160:163], v[224:227], v[164:167]
  ds_read_b64_tr_b16 a[154:155], v233 offset:256
  v_mfma_f32_16x16x32_bf16 v[172:175], a[160:163], v[228:231], v[172:175]
  ds_read_b64_tr_b16 a[156:157], v233 offset:32
  s_add_u32 m0, s76, 0x6300
  v_mfma_f32_16x16x32_bf16 v[68:71], a[164:167], v[224:227], v[68:71]
  buffer_load_dwordx4 v242, s[20:23], s62 offen lds
  ds_read_b64_tr_b16 a[158:159], v233 offset:288
  s_waitcnt vmcnt(11)
  buffer_store_dwordx2 v[248:249], v252, s[32:35], s39 offen sc1
  s_xor_b32 s39, s84, 5
  v_mfma_f32_16x16x32_bf16 v[180:183], a[164:167], v[228:231], v[180:183]
  ds_read_b64_tr_b16 a[160:161], v233 offset:64
  s_lshl_b32 s39, s39, 10
  s_add_u32 s39, s39, s97
  v_mfma_f32_16x16x32_bf16 v[52:55], a[168:171], v[72:75], v[52:55]
  ds_read_b64_tr_b16 a[162:163], v233 offset:320
  v_mfma_f32_16x16x32_bf16 v[56:59], a[168:171], v[76:79], v[56:59]
  ds_read_b64_tr_b16 a[164:165], v233 offset:96
  v_mfma_f32_16x16x32_bf16 v[60:63], a[172:175], v[72:75], v[60:63]
  ds_read_b64_tr_b16 a[166:167], v233 offset:352
  v_mfma_f32_16x16x32_bf16 v[64:67], a[172:175], v[76:79], v[64:67]
  ds_read_b64_tr_b16 a[168:169], v233 offset:4224
  s_add_u32 m0, s76, 0x7380
  v_mfma_f32_16x16x32_bf16 v[164:167], a[220:223], v[72:75], v[164:167]
  buffer_load_dwordx4 v242, s[20:23], s63 offen lds
  ds_read_b64_tr_b16 a[170:171], v233 offset:4480
  v_mfma_f32_16x16x32_bf16 v[172:175], a[220:223], v[76:79], v[172:175]
  ds_read_b64_tr_b16 a[172:173], v233 offset:4256
  v_mfma_f32_16x16x32_bf16 v[68:71], a[224:227], v[72:75], v[68:71]
  ds_read_b64_tr_b16 a[174:175], v233 offset:4512
  v_mfma_f32_16x16x32_bf16 v[180:183], a[224:227], v[76:79], v[180:183]
  ds_read_b64_tr_b16 a[220:221], v233 offset:4288
  v_mfma_f32_4x4x4_16b_bf16 v[52:55], a[228:229], v[96:97], v[52:55]
  ds_read_b64_tr_b16 a[222:223], v233 offset:4544
  v_mfma_f32_4x4x4_16b_bf16 v[56:59], a[228:229], v[98:99], v[56:59]
  ds_read_b64_tr_b16 a[224:225], v233 offset:4320
  s_waitcnt lgkmcnt(8)
  s_nop 0
  v_mfma_f32_4x4x4_16b_bf16 v[60:63], a[232:233], v[96:97], v[60:63]
  ds_read_b64_tr_b16 a[226:227], v233 offset:4576
  v_cvt_pk_bf16_f32 v52, v52, v53
  v_cvt_pk_bf16_f32 v53, v54, v55
  v_mfma_f32_4x4x4_16b_bf16 v[64:67], a[232:233], v[98:99], v[64:67]
  ds_read_b64_tr_b16 a[228:229], v233 offset:8448
  s_add_u32 m0, s76, 0x8400
  v_cvt_pk_bf16_f32 v54, v60, v61
  v_mfma_f32_4x4x4_16b_bf16 v[164:167], a[144:145], v[96:97], v[164:167]
  buffer_load_dwordx4 v242, s[20:23], s64 offen lds
  ds_read_b64_tr_b16 a[230:231], v233 offset:8704
  v_cvt_pk_bf16_f32 v55, v62, v63
  v_mfma_f32_4x4x4_16b_bf16 v[172:175], a[144:145], v[98:99], v[172:175]
  ds_read_b64_tr_b16 a[232:233], v233 offset:8480
  buffer_store_dwordx4 v[52:55], v251, s[32:35], s37 offen sc1
  v_cvt_pk_bf16_f32 v56, v56, v57
  v_mfma_f32_4x4x4_16b_bf16 v[68:71], a[148:149], v[96:97], v[68:71]
  ds_read_b64_tr_b16 a[234:235], v233 offset:8736
  v_cvt_pk_bf16_f32 v57, v58, v59
  v_cvt_pk_bf16_f32 v58, v64, v65
  v_mfma_f32_4x4x4_16b_bf16 v[180:183], a[148:149], v[98:99], v[180:183]
  ds_read_b64_tr_b16 a[144:145], v233 offset:8512
  buffer_load_dwordx2 v[246:247], v253, s[32:35], s71 offen sc1
  v_cvt_pk_bf16_f32 v59, v66, v67
  v_mfma_f32_16x16x32_bf16 v[20:23], a[152:155], v[128:131], 0
  ds_read_b64_tr_b16 a[146:147], v233 offset:8768
  buffer_store_dwordx4 v[56:59], v251, s[32:35], s37 offen offset:1024 sc1
  s_xor_b32 s37, s96, 0xe0c000
  v_mfma_f32_16x16x32_bf16 v[24:27], a[152:155], v[136:139], 0
  ds_read_b64_tr_b16 a[148:149], v233 offset:8544
  s_add_u32 m0, s76, 0x9480
  v_cvt_pk_bf16_f32 v164, v164, v165
  v_mfma_f32_16x16x32_bf16 v[28:31], a[156:159], v[128:131], 0
  buffer_load_dwordx4 v242, s[20:23], s65 offen lds
  ds_read_b64_tr_b16 a[150:151], v233 offset:8800
  v_cvt_pk_bf16_f32 v165, v166, v167
  v_mfma_f32_16x16x32_bf16 v[32:35], a[156:159], v[136:139], 0
  ds_read_b64_tr_b16 a[152:153], v233 offset:12672
  v_cvt_pk_bf16_f32 v166, v68, v69
  v_cvt_pk_bf16_f32 v167, v70, v71
  v_mfma_f32_16x16x32_bf16 v[36:39], a[160:163], v[128:131], 0
  ds_read_b64_tr_b16 a[154:155], v233 offset:12928
  buffer_store_dwordx4 v[164:167], v251, s[32:35], s37 offen sc1
  v_cvt_pk_bf16_f32 v172, v172, v173
  v_mfma_f32_16x16x32_bf16 v[40:43], a[160:163], v[136:139], 0
  ds_read_b64_tr_b16 a[156:157], v233 offset:12704
  v_cvt_pk_bf16_f32 v173, v174, v175
  s_waitcnt lgkmcnt(6)
  s_nop 0
  v_mfma_f32_16x16x32_bf16 v[44:47], a[164:167], v[128:131], 0
  ds_read_b64_tr_b16 a[158:159], v233 offset:12960
  v_cvt_pk_bf16_f32 v174, v180, v181
  v_cvt_pk_bf16_f32 v175, v182, v183
  v_mfma_f32_16x16x32_bf16 v[48:51], a[164:167], v[136:139], 0
  ds_read_b64_tr_b16 a[160:161], v233 offset:12736
  buffer_store_dwordx4 v[172:175], v251, s[32:35], s37 offen offset:1024 sc1
  s_xor_b32 s37, s96, 0x1200000
  v_mfma_f32_16x16x32_bf16 v[20:23], a[168:171], v[144:147], v[20:23]
  ds_read_b64_tr_b16 a[162:163], v233 offset:12992
  v_mfma_f32_16x16x32_bf16 v[24:27], a[168:171], v[152:155], v[24:27]
  ds_read_b64_tr_b16 a[164:165], v233 offset:12768
  s_add_u32 m0, s76, 0xa500
  v_mfma_f32_16x16x32_bf16 v[28:31], a[172:175], v[144:147], v[28:31]
  buffer_load_dwordx4 v243, s[24:27], 0 offen lds
  ds_read_b64_tr_b16 a[166:167], v233 offset:13024
  v_mfma_f32_16x16x32_bf16 v[32:35], a[172:175], v[152:155], v[32:35]
  ds_read_b64_tr_b16 a[168:169], v233 offset:16896
  v_mfma_f32_16x16x32_bf16 v[36:39], a[220:223], v[144:147], v[36:39]
  ds_read_b64_tr_b16 a[170:171], v233 offset:17152
  v_mfma_f32_16x16x32_bf16 v[40:43], a[220:223], v[152:155], v[40:43]
  ds_read_b64_tr_b16 a[172:173], v233 offset:16928
  v_mfma_f32_16x16x32_bf16 v[44:47], a[224:227], v[144:147], v[44:47]
  ds_read_b64_tr_b16 a[174:175], v233 offset:17184
  v_mfma_f32_16x16x32_bf16 v[48:51], a[224:227], v[152:155], v[48:51]
  ds_read_b64_tr_b16 a[220:221], v233 offset:16960
  v_mfma_f32_16x16x32_bf16 v[20:23], a[228:231], v[160:163], v[20:23]
  ds_read_b64_tr_b16 a[222:223], v233 offset:17216
  v_mfma_f32_16x16x32_bf16 v[24:27], a[228:231], v[168:171], v[24:27]
  ds_read_b64_tr_b16 a[224:225], v233 offset:16992
  v_mfma_f32_16x16x32_bf16 v[28:31], a[232:235], v[160:163], v[28:31]
  ds_read_b64_tr_b16 a[226:227], v233 offset:17248
  v_mfma_f32_16x16x32_bf16 v[32:35], a[232:235], v[168:171], v[32:35]
  s_waitcnt vmcnt(20)
  s_barrier
  v_add_u32_e32 v233, 0x6300, v233
  ds_read_b64_tr_b16 a[228:229], v233 offset:0
  s_waitcnt lgkmcnt(6)
  s_nop 0
  v_mfma_f32_16x16x32_bf16 v[36:39], a[144:147], v[160:163], v[36:39]
  ds_read_b64_tr_b16 a[230:231], v233 offset:256
  v_mfma_f32_16x16x32_bf16 v[40:43], a[144:147], v[168:171], v[40:43]
  ds_read_b64_tr_b16 a[232:233], v233 offset:32
  s_add_u32 m0, s76, 0xc600
  s_xor_b32 s66, s84, 2
  s_lshl_b32 s66, s66, 7
  v_add_u32_e32 v242, s66, v234
  v_add_u32_e32 v243, s66, v235
  v_mfma_f32_16x16x32_bf16 v[44:47], a[148:151], v[160:163], v[44:47]
  buffer_load_dwordx4 v242, s[20:23], s57 offen lds
  ds_read_b64_tr_b16 a[234:235], v233 offset:288
  v_mfma_f32_16x16x32_bf16 v[48:51], a[148:151], v[168:171], v[48:51]
  ds_read_b64_tr_b16 a[144:145], v233 offset:64
  v_mfma_f32_16x16x32_bf16 v[20:23], a[152:155], v[176:179], v[20:23]
  ds_read_b64_tr_b16 a[146:147], v233 offset:320
  v_mfma_f32_16x16x32_bf16 v[24:27], a[152:155], v[184:187], v[24:27]
  ds_read_b64_tr_b16 a[148:149], v233 offset:96
  v_mfma_f32_16x16x32_bf16 v[28:31], a[156:159], v[176:179], v[28:31]
  ds_read_b64_tr_b16 a[150:151], v233 offset:352
  v_mfma_f32_16x16x32_bf16 v[32:35], a[156:159], v[184:187], v[32:35]
  ds_read_b64_tr_b16 a[152:153], v233 offset:4224
  v_mfma_f32_16x16x32_bf16 v[36:39], a[160:163], v[176:179], v[36:39]
  ds_read_b64_tr_b16 a[154:155], v233 offset:4480
  v_mfma_f32_16x16x32_bf16 v[40:43], a[160:163], v[184:187], v[40:43]
  ds_read_b64_tr_b16 a[156:157], v233 offset:4256
  s_add_u32 m0, s76, 0xd680
  v_mfma_f32_16x16x32_bf16 v[44:47], a[164:167], v[176:179], v[44:47]
  buffer_load_dwordx4 v242, s[20:23], s58 offen lds
  ds_read_b64_tr_b16 a[158:159], v233 offset:4512
  v_mfma_f32_16x16x32_bf16 v[48:51], a[164:167], v[184:187], v[48:51]
  ds_read_b64_tr_b16 a[160:161], v233 offset:4288
  v_mfma_f32_16x16x32_bf16 v[20:23], a[168:171], v[192:195], v[20:23]
  ds_read_b64_tr_b16 a[162:163], v233 offset:4544
  v_mfma_f32_16x16x32_bf16 v[24:27], a[168:171], v[196:199], v[24:27]
  ds_read_b64_tr_b16 a[164:165], v233 offset:4320
  s_waitcnt lgkmcnt(7)
  s_nop 0
  v_mfma_f32_16x16x32_bf16 v[28:31], a[172:175], v[192:195], v[28:31]
  ds_read_b64_tr_b16 a[166:167], v233 offset:4576
  v_mfma_f32_16x16x32_bf16 v[32:35], a[172:175], v[196:199], v[32:35]
  ds_read_b64_tr_b16 a[168:169], v233 offset:8448
  v_mfma_f32_16x16x32_bf16 v[36:39], a[220:223], v[192:195], v[36:39]
  ds_read_b64_tr_b16 a[170:171], v233 offset:8704
  v_mfma_f32_16x16x32_bf16 v[40:43], a[220:223], v[196:199], v[40:43]
  ds_read_b64_tr_b16 a[172:173], v233 offset:8480
  s_add_u32 m0, s76, 0xe700
  v_mfma_f32_16x16x32_bf16 v[44:47], a[224:227], v[192:195], v[44:47]
  buffer_load_dwordx4 v242, s[20:23], s59 offen lds
  ds_read_b64_tr_b16 a[174:175], v233 offset:8736
  v_mfma_f32_16x16x32_bf16 v[48:51], a[224:227], v[196:199], v[48:51]
  ds_read_b64_tr_b16 a[220:221], v233 offset:8512
  v_mfma_f32_16x16x32_bf16 v[20:23], a[228:231], v[200:203], v[20:23]
  ds_read_b64_tr_b16 a[222:223], v233 offset:8768
  v_mfma_f32_16x16x32_bf16 v[24:27], a[228:231], v[204:207], v[24:27]
  ds_read_b64_tr_b16 a[224:225], v233 offset:8544
  v_mfma_f32_16x16x32_bf16 v[28:31], a[232:235], v[200:203], v[28:31]
  ds_read_b64_tr_b16 a[226:227], v233 offset:8800
  v_mfma_f32_16x16x32_bf16 v[32:35], a[232:235], v[204:207], v[32:35]
  ds_read_b64_tr_b16 a[228:229], v233 offset:12672
  v_mfma_f32_16x16x32_bf16 v[36:39], a[144:147], v[200:203], v[36:39]
  ds_read_b64_tr_b16 a[230:231], v233 offset:12928
  v_mfma_f32_16x16x32_bf16 v[40:43], a[144:147], v[204:207], v[40:43]
  ds_read_b64_tr_b16 a[232:233], v233 offset:12704
  v_mfma_f32_16x16x32_bf16 v[44:47], a[148:151], v[200:203], v[44:47]
  ds_read_b64_tr_b16 a[234:235], v233 offset:12960
  v_mfma_f32_16x16x32_bf16 v[48:51], a[148:151], v[204:207], v[48:51]
  ds_read_b64_tr_b16 a[144:145], v233 offset:12736
  s_add_u32 m0, s76, 0xf780
  s_waitcnt lgkmcnt(7)
  s_nop 0
  v_mfma_f32_16x16x32_bf16 v[20:23], a[152:155], v[208:211], v[20:23]
  buffer_load_dwordx4 v242, s[20:23], s60 offen lds
  ds_read_b64_tr_b16 a[146:147], v233 offset:12992
  v_mfma_f32_16x16x32_bf16 v[24:27], a[152:155], v[212:215], v[24:27]
  ds_read_b64_tr_b16 a[148:149], v233 offset:12768
  v_mfma_f32_16x16x32_bf16 v[28:31], a[156:159], v[208:211], v[28:31]
  ds_read_b64_tr_b16 a[150:151], v233 offset:13024
  v_mfma_f32_16x16x32_bf16 v[32:35], a[156:159], v[212:215], v[32:35]
  s_xor_b32 s67, s84, 4
  s_lshl_b32 s67, s67, 7
  v_add_u32_e64 v250, s67, v236
  ds_read_b64_tr_b16 a[152:153], v233 offset:16896
  v_mfma_f32_16x16x32_bf16 v[36:39], a[160:163], v[208:211], v[36:39]
  ds_read_b64_tr_b16 a[154:155], v233 offset:17152
  v_mfma_f32_16x16x32_bf16 v[40:43], a[160:163], v[212:215], v[40:43]
  ds_read_b64_tr_b16 a[156:157], v233 offset:16928
  v_mfma_f32_16x16x32_bf16 v[44:47], a[164:167], v[208:211], v[44:47]
  ds_read_b64_tr_b16 a[158:159], v233 offset:17184
  v_mfma_f32_16x16x32_bf16 v[48:51], a[164:167], v[212:215], v[48:51]
  ds_read_b64_tr_b16 a[160:161], v233 offset:16960
  s_add_u32 m0, s76, 0x10800
  v_mfma_f32_16x16x32_bf16 v[20:23], a[168:171], v[216:219], v[20:23]
  buffer_load_dwordx4 v242, s[20:23], s61 offen lds
  ds_read_b64_tr_b16 a[162:163], v233 offset:17216
  v_mfma_f32_16x16x32_bf16 v[24:27], a[168:171], v[220:223], v[24:27]
  ds_read_b64_tr_b16 a[164:165], v233 offset:16992
  s_waitcnt vmcnt(10)
  s_nop 0
  v_cmp_eq_u64_e64 s[94:95], v[246:247], s[74:75]
  v_mfma_f32_16x16x32_bf16 v[28:31], a[172:175], v[216:219], v[28:31]
  ds_read_b64_tr_b16 a[166:167], v233 offset:17248
s_and_b32 s82, s36, s94
  s_cbranch_scc1 Lslow3
Lret3:
  s_mov_b32 s83, 0
  s_xor_b32 s82, s84, 7
  s_lshl_b32 s82, s82, 1
  v_mfma_f32_16x16x32_bf16 v[32:35], a[172:175], v[220:223], v[32:35]
  ds_read_b64_tr_b16 a[168:169], v250 offset:0
  s_lshl_b32 s82, 3, s82
  s_or_b32 s83, s83, s82
  s_andn2_b32 s83, s83, s94
  s_or_b32 s36, s36, s83
  v_mfma_f32_16x16x32_bf16 v[36:39], a[220:223], v[216:219], v[36:39]
  s_xor_b32 s82, s98, 0x400000
  s_cmp_eq_u32 s83, 0
  s_cselect_b32 s82, s82, 0x7ffffff0
  buffer_load_dwordx4 a[0:3], v251, s[32:35], s82 offen sc1
  buffer_load_dwordx4 a[4:7], v251, s[32:35], s82 offen offset:1024 sc1
  buffer_load_dwordx4 a[8:11], v251, s[32:35], s82 offen offset:2048 sc1
  v_mfma_f32_16x16x32_bf16 v[40:43], a[220:223], v[220:223], v[40:43]
  ds_read_b64_tr_b16 a[172:173], v250 offset:32
  buffer_load_dwordx4 a[12:15], v251, s[32:35], s82 offen offset:3072 sc1
  s_waitcnt lgkmcnt(3)
  s_nop 0
  v_mfma_f32_16x16x32_bf16 v[44:47], a[224:227], v[216:219], v[44:47]
  v_mfma_f32_16x16x32_bf16 v[48:51], a[224:227], v[220:223], v[48:51]
  ds_read_b64_tr_b16 a[220:221], v250 offset:64
  v_mfma_f32_16x16x32_bf16 v[20:23], a[228:231], v[224:227], v[20:23]
  v_mfma_f32_16x16x32_bf16 v[24:27], a[228:231], v[228:231], v[24:27]
  ds_read_b64_tr_b16 a[224:225], v250 offset:96
  v_mfma_f32_16x16x32_bf16 v[28:31], a[232:235], v[224:227], v[28:31]
  v_mfma_f32_16x16x32_bf16 v[32:35], a[232:235], v[228:231], v[32:35]
  s_barrier
  s_nop 0
  v_add_u32_e32 v233, 0xfffe7400, v233
  ds_read_b64_tr_b16 a[228:229], v233 offset:0
  v_mfma_f32_16x16x32_bf16 v[36:39], a[144:147], v[224:227], v[36:39]
  ds_read_b64_tr_b16 a[230:231], v233 offset:256
  v_mfma_f32_16x16x32_bf16 v[40:43], a[144:147], v[228:231], v[40:43]
  ds_read_b64_tr_b16 a[232:233], v233 offset:32
  s_add_u32 m0, s76, 0x12900
  v_mfma_f32_16x16x32_bf16 v[44:47], a[148:151], v[224:227], v[44:47]
  buffer_load_dwordx4 v242, s[20:23], s62 offen lds
  ds_read_b64_tr_b16 a[234:235], v233 offset:288
  s_waitcnt vmcnt(11)
  buffer_store_dwordx2 v[248:249], v252, s[32:35], s39 offen sc1
  s_xor_b32 s39, s84, 4
  v_mfma_f32_16x16x32_bf16 v[48:51], a[148:151], v[228:231], v[48:51]
  ds_read_b64_tr_b16 a[144:145], v233 offset:64
  s_lshl_b32 s39, s39, 10
  s_add_u32 s39, s39, s97
  v_mfma_f32_16x16x32_bf16 v[20:23], a[152:155], v[72:75], v[20:23]
  ds_read_b64_tr_b16 a[146:147], v233 offset:320
  v_mfma_f32_16x16x32_bf16 v[24:27], a[152:155], v[76:79], v[24:27]
  ds_read_b64_tr_b16 a[148:149], v233 offset:96
  v_mfma_f32_16x16x32_bf16 v[28:31], a[156:159], v[72:75], v[28:31]
  ds_read_b64_tr_b16 a[150:151], v233 offset:352
  v_mfma_f32_16x16x32_bf16 v[32:35], a[156:159], v[76:79], v[32:35]
  ds_read_b64_tr_b16 a[152:153], v233 offset:4224
  s_add_u32 m0, s76, 0x13980
  v_mfma_f32_16x16x32_bf16 v[36:39], a[160:163], v[72:75], v[36:39]
  buffer_load_dwordx4 v242, s[20:23], s63 offen lds
  ds_read_b64_tr_b16 a[154:155], v233 offset:4480
  v_mfma_f32_16x16x32_bf16 v[40:43], a[160:163], v[76:79], v[40:43]
  ds_read_b64_tr_b16 a[156:157], v233 offset:4256
  s_waitcnt lgkmcnt(7)
  s_nop 0
  v_mfma_f32_16x16x32_bf16 v[44:47], a[164:167], v[72:75], v[44:47]
  ds_read_b64_tr_b16 a[158:159], v233 offset:4512
  v_mfma_f32_16x16x32_bf16 v[48:51], a[164:167], v[76:79], v[48:51]
  ds_read_b64_tr_b16 a[160:161], v233 offset:4288
  v_mfma_f32_4x4x4_16b_bf16 v[20:23], a[168:169], v[96:97], v[20:23]
  ds_read_b64_tr_b16 a[162:163], v233 offset:4544
  v_mfma_f32_4x4x4_16b_bf16 v[24:27], a[168:169], v[98:99], v[24:27]
  ds_read_b64_tr_b16 a[164:165], v233 offset:4320
  v_mfma_f32_4x4x4_16b_bf16 v[28:31], a[172:173], v[96:97], v[28:31]
  ds_read_b64_tr_b16 a[166:167], v233 offset:4576
  v_cvt_pk_bf16_f32 v20, v20, v21
  v_cvt_pk_bf16_f32 v21, v22, v23
  v_mfma_f32_4x4x4_16b_bf16 v[32:35], a[172:173], v[98:99], v[32:35]
  ds_read_b64_tr_b16 a[168:169], v233 offset:8448
  s_add_u32 m0, s76, 0x14a00
  v_cvt_pk_bf16_f32 v22, v28, v29
  v_mfma_f32_4x4x4_16b_bf16 v[36:39], a[220:221], v[96:97], v[36:39]
  buffer_load_dwordx4 v242, s[20:23], s64 offen lds
  ds_read_b64_tr_b16 a[170:171], v233 offset:8704
  v_cvt_pk_bf16_f32 v23, v30, v31
  v_mfma_f32_4x4x4_16b_bf16 v[40:43], a[220:221], v[98:99], v[40:43]
  ds_read_b64_tr_b16 a[172:173], v233 offset:8480
  buffer_store_dwordx4 v[20:23], v251, s[32:35], s37 offen sc1
  v_cvt_pk_bf16_f32 v24, v24, v25
  v_mfma_f32_4x4x4_16b_bf16 v[44:47], a[224:225], v[96:97], v[44:47]
  ds_read_b64_tr_b16 a[174:175], v233 offset:8736
  v_cvt_pk_bf16_f32 v25, v26, v27
  v_cvt_pk_bf16_f32 v26, v32, v33
  v_mfma_f32_4x4x4_16b_bf16 v[48:51], a[224:225], v[98:99], v[48:51]
  ds_read_b64_tr_b16 a[220:221], v233 offset:8512
  buffer_load_dwordx2 v[246:247], v253, s[32:35], s71 offen sc1
  v_cvt_pk_bf16_f32 v27, v34, v35
  v_mfma_f32_16x16x32_bf16 v[0:3], a[228:231], v[128:131], 0
  ds_read_b64_tr_b16 a[222:223], v233 offset:8768
  buffer_store_dwordx4 v[24:27], v251, s[32:35], s37 offen offset:1024 sc1
  s_xor_b32 s37, s96, 0x1204000
  v_mfma_f32_16x16x32_bf16 v[4:7], a[228:231], v[136:139], 0
  ds_read_b64_tr_b16 a[224:225], v233 offset:8544
  s_add_u32 m0, s76, 0x15a80
  v_cvt_pk_bf16_f32 v36, v36, v37
  v_mfma_f32_16x16x32_bf16 v[8:11], a[232:235], v[128:131], 0
  buffer_load_dwordx4 v242, s[20:23], s65 offen lds
  ds_read_b64_tr_b16 a[226:227], v233 offset:8800
  v_cvt_pk_bf16_f32 v37, v38, v39
  v_mfma_f32_16x16x32_bf16 v[12:15], a[232:235], v[136:139], 0
  ds_read_b64_tr_b16 a[228:229], v233 offset:12672
  v_cvt_pk_bf16_f32 v38, v44, v45
  s_waitcnt lgkmcnt(6)
  s_nop 0
  v_mfma_f32_16x16x32_bf16 v[16:19], a[144:147], v[128:131], 0
  ds_read_b64_tr_b16 a[230:231], v233 offset:12928
  v_cvt_pk_bf16_f32 v39, v46, v47
  buffer_store_dwordx4 v[36:39], v251, s[32:35], s37 offen sc1
  v_mfma_f32_16x16x32_bf16 v[188:191], a[144:147], v[136:139], 0
  ds_read_b64_tr_b16 a[232:233], v233 offset:12704
  v_cvt_pk_bf16_f32 v40, v40, v41
  v_cvt_pk_bf16_f32 v41, v42, v43
  v_mfma_f32_16x16x32_bf16 v[132:135], a[148:151], v[128:131], 0
  ds_read_b64_tr_b16 a[234:235], v233 offset:12960
  v_cvt_pk_bf16_f32 v42, v48, v49
  v_cvt_pk_bf16_f32 v43, v50, v51
  v_mfma_f32_16x16x32_bf16 v[140:143], a[148:151], v[136:139], 0
  ds_read_b64_tr_b16 a[144:145], v233 offset:12736
  buffer_store_dwordx4 v[40:43], v251, s[32:35], s37 offen offset:1024 sc1
  s_xor_b32 s37, s96, 0x1508000
  v_mfma_f32_16x16x32_bf16 v[0:3], a[152:155], v[144:147], v[0:3]
  ds_read_b64_tr_b16 a[146:147], v233 offset:12992
  v_mfma_f32_16x16x32_bf16 v[4:7], a[152:155], v[152:155], v[4:7]
  ds_read_b64_tr_b16 a[148:149], v233 offset:12768
  s_add_u32 m0, s76, 0x16b00
  v_mfma_f32_16x16x32_bf16 v[8:11], a[156:159], v[144:147], v[8:11]
  buffer_load_dwordx4 v243, s[24:27], 0 offen lds
  ds_read_b64_tr_b16 a[150:151], v233 offset:13024
  v_mfma_f32_16x16x32_bf16 v[12:15], a[156:159], v[152:155], v[12:15]
  ds_read_b64_tr_b16 a[152:153], v233 offset:16896
  v_mfma_f32_16x16x32_bf16 v[16:19], a[160:163], v[144:147], v[16:19]
  ds_read_b64_tr_b16 a[154:155], v233 offset:17152
  v_mfma_f32_16x16x32_bf16 v[188:191], a[160:163], v[152:155], v[188:191]
  ds_read_b64_tr_b16 a[156:157], v233 offset:16928
  v_mfma_f32_16x16x32_bf16 v[132:135], a[164:167], v[144:147], v[132:135]
  ds_read_b64_tr_b16 a[158:159], v233 offset:17184
  v_mfma_f32_16x16x32_bf16 v[140:143], a[164:167], v[152:155], v[140:143]
  ds_read_b64_tr_b16 a[160:161], v233 offset:16960
  v_mfma_f32_16x16x32_bf16 v[0:3], a[168:171], v[160:163], v[0:3]
  ds_read_b64_tr_b16 a[162:163], v233 offset:17216
  v_mfma_f32_16x16x32_bf16 v[4:7], a[168:171], v[168:171], v[4:7]
  ds_read_b64_tr_b16 a[164:165], v233 offset:16992
  s_waitcnt lgkmcnt(7)
  v_mfma_f32_16x16x32_bf16 v[8:11], a[172:175], v[160:163], v[8:11]
  ds_read_b64_tr_b16 a[166:167], v233 offset:17248
  v_mfma_f32_16x16x32_bf16 v[12:15], a[172:175], v[168:171], v[12:15]
  s_waitcnt vmcnt(20)
  s_barrier
  s_nop 0
  v_add_u32_e32 v233, 0x6300, v233
  ds_read_b64_tr_b16 a[168:169], v233 offset:0
  v_mfma_f32_16x16x32_bf16 v[16:19], a[220:223], v[160:163], v[16:19]
  ds_read_b64_tr_b16 a[170:171], v233 offset:256
  v_mfma_f32_16x16x32_bf16 v[188:191], a[220:223], v[168:171], v[188:191]
  ds_read_b64_tr_b16 a[172:173], v233 offset:32
  s_add_u32 m0, s76, 0x18c00
  s_lshl_b32 s66, s84, 7
  v_add_u32_e32 v242, s66, v234
  v_add_u32_e64 v243, s66, v235
  v_mfma_f32_16x16x32_bf16 v[132:135], a[224:227], v[160:163], v[132:135]
  buffer_load_dwordx4 v242, s[20:23], s57 offen lds
  ds_read_b64_tr_b16 a[174:175], v233 offset:288
  v_mfma_f32_16x16x32_bf16 v[140:143], a[224:227], v[168:171], v[140:143]
  ds_read_b64_tr_b16 a[220:221], v233 offset:64
  v_mfma_f32_16x16x32_bf16 v[0:3], a[228:231], v[176:179], v[0:3]
  ds_read_b64_tr_b16 a[222:223], v233 offset:320
  v_mfma_f32_16x16x32_bf16 v[4:7], a[228:231], v[184:187], v[4:7]
  ds_read_b64_tr_b16 a[224:225], v233 offset:96
  v_mfma_f32_16x16x32_bf16 v[8:11], a[232:235], v[176:179], v[8:11]
  ds_read_b64_tr_b16 a[226:227], v233 offset:352
  v_mfma_f32_16x16x32_bf16 v[12:15], a[232:235], v[184:187], v[12:15]
  ds_read_b64_tr_b16 a[228:229], v233 offset:4224
  v_mfma_f32_16x16x32_bf16 v[16:19], a[144:147], v[176:179], v[16:19]
  ds_read_b64_tr_b16 a[230:231], v233 offset:4480
  v_mfma_f32_16x16x32_bf16 v[188:191], a[144:147], v[184:187], v[188:191]
  ds_read_b64_tr_b16 a[232:233], v233 offset:4256
  s_add_u32 m0, s76, 0x19c80
  v_mfma_f32_16x16x32_bf16 v[132:135], a[148:151], v[176:179], v[132:135]
  buffer_load_dwordx4 v242, s[20:23], s58 offen lds
  ds_read_b64_tr_b16 a[234:235], v233 offset:4512
  v_mfma_f32_16x16x32_bf16 v[140:143], a[148:151], v[184:187], v[140:143]
  ds_read_b64_tr_b16 a[144:145], v233 offset:4288
  s_waitcnt lgkmcnt(7)
  s_nop 0
  v_mfma_f32_16x16x32_bf16 v[0:3], a[152:155], v[192:195], v[0:3]
  ds_read_b64_tr_b16 a[146:147], v233 offset:4544
  v_mfma_f32_16x16x32_bf16 v[4:7], a[152:155], v[196:199], v[4:7]
  ds_read_b64_tr_b16 a[148:149], v233 offset:4320
  v_mfma_f32_16x16x32_bf16 v[8:11], a[156:159], v[192:195], v[8:11]
  ds_read_b64_tr_b16 a[150:151], v233 offset:4576
  v_mfma_f32_16x16x32_bf16 v[12:15], a[156:159], v[196:199], v[12:15]
  ds_read_b64_tr_b16 a[152:153], v233 offset:8448
  v_mfma_f32_16x16x32_bf16 v[16:19], a[160:163], v[192:195], v[16:19]
  ds_read_b64_tr_b16 a[154:155], v233 offset:8704
  v_mfma_f32_16x16x32_bf16 v[188:191], a[160:163], v[196:199], v[188:191]
  ds_read_b64_tr_b16 a[156:157], v233 offset:8480
  s_add_u32 m0, s76, 0x1ad00
  v_mfma_f32_16x16x32_bf16 v[132:135], a[164:167], v[192:195], v[132:135]
  buffer_load_dwordx4 v242, s[20:23], s59 offen lds
  ds_read_b64_tr_b16 a[158:159], v233 offset:8736
  v_mfma_f32_16x16x32_bf16 v[140:143], a[164:167], v[196:199], v[140:143]
  ds_read_b64_tr_b16 a[160:161], v233 offset:8512
  v_mfma_f32_16x16x32_bf16 v[0:3], a[168:171], v[200:203], v[0:3]
  ds_read_b64_tr_b16 a[162:163], v233 offset:8768
  v_mfma_f32_16x16x32_bf16 v[4:7], a[168:171], v[204:207], v[4:7]
  ds_read_b64_tr_b16 a[164:165], v233 offset:8544
  v_mfma_f32_16x16x32_bf16 v[8:11], a[172:175], v[200:203], v[8:11]
  ds_read_b64_tr_b16 a[166:167], v233 offset:8800
  v_mfma_f32_16x16x32_bf16 v[12:15], a[172:175], v[204:207], v[12:15]
  ds_read_b64_tr_b16 a[168:169], v233 offset:12672
  v_mfma_f32_16x16x32_bf16 v[16:19], a[220:223], v[200:203], v[16:19]
  ds_read_b64_tr_b16 a[170:171], v233 offset:12928
  v_mfma_f32_16x16x32_bf16 v[188:191], a[220:223], v[204:207], v[188:191]
  ds_read_b64_tr_b16 a[172:173], v233 offset:12704
  s_waitcnt lgkmcnt(7)
  s_nop 0
  v_mfma_f32_16x16x32_bf16 v[132:135], a[224:227], v[200:203], v[132:135]
  ds_read_b64_tr_b16 a[174:175], v233 offset:12960
  v_mfma_f32_16x16x32_bf16 v[140:143], a[224:227], v[204:207], v[140:143]
  ds_read_b64_tr_b16 a[220:221], v233 offset:12736
  s_add_u32 m0, s76, 0x1bd80
  v_mfma_f32_16x16x32_bf16 v[0:3], a[228:231], v[208:211], v[0:3]
  buffer_load_dwordx4 v242, s[20:23], s60 offen lds
  ds_read_b64_tr_b16 a[222:223], v233 offset:12992
  v_mfma_f32_16x16x32_bf16 v[4:7], a[228:231], v[212:215], v[4:7]
  ds_read_b64_tr_b16 a[224:225], v233 offset:12768
  v_mfma_f32_16x16x32_bf16 v[8:11], a[232:235], v[208:211], v[8:11]
  ds_read_b64_tr_b16 a[226:227], v233 offset:13024
  v_mfma_f32_16x16x32_bf16 v[12:15], a[232:235], v[212:215], v[12:15]
  s_xor_b32 s67, s84, 3
  s_lshl_b32 s67, s67, 7
  v_add_u32_e64 v250, s67, v236
  ds_read_b64_tr_b16 a[228:229], v233 offset:16896
  v_mfma_f32_16x16x32_bf16 v[16:19], a[144:147], v[208:211], v[16:19]
  ds_read_b64_tr_b16 a[230:231], v233 offset:17152
  v_mfma_f32_16x16x32_bf16 v[188:191], a[144:147], v[212:215], v[188:191]
  ds_read_b64_tr_b16 a[232:233], v233 offset:16928
  v_mfma_f32_16x16x32_bf16 v[132:135], a[148:151], v[208:211], v[132:135]
  ds_read_b64_tr_b16 a[234:235], v233 offset:17184
  v_mfma_f32_16x16x32_bf16 v[140:143], a[148:151], v[212:215], v[140:143]
  ds_read_b64_tr_b16 a[144:145], v233 offset:16960
  s_add_u32 m0, s76, 0x1ce00
  v_mfma_f32_16x16x32_bf16 v[0:3], a[152:155], v[216:219], v[0:3]
  buffer_load_dwordx4 v242, s[20:23], s61 offen lds
  ds_read_b64_tr_b16 a[146:147], v233 offset:17216
  v_mfma_f32_16x16x32_bf16 v[4:7], a[152:155], v[220:223], v[4:7]
  ds_read_b64_tr_b16 a[148:149], v233 offset:16992
  v_mfma_f32_16x16x32_bf16 v[8:11], a[156:159], v[216:219], v[8:11]
  ds_read_b64_tr_b16 a[150:151], v233 offset:17248
  s_waitcnt vmcnt(10)
  s_nop 0
  v_cmp_eq_u64_e64 s[94:95], v[246:247], s[74:75]
  v_mfma_f32_16x16x32_bf16 v[12:15], a[156:159], v[220:223], v[12:15]
  ds_read_b64_tr_b16 a[152:153], v250 offset:0
s_and_b32 s82, s36, s94
  s_cbranch_scc1 Lslow4
Lret4:
  s_mov_b32 s83, 0
  s_xor_b32 s82, s84, 6
  s_waitcnt lgkmcnt(6)
  v_mfma_f32_16x16x32_bf16 v[16:19], a[160:163], v[216:219], v[16:19]
  s_lshl_b32 s82, s82, 1
  s_lshl_b32 s82, 3, s82
  s_or_b32 s83, s83, s82
  s_andn2_b32 s83, s83, s94
  s_or_b32 s36, s36, s83
  v_mfma_f32_16x16x32_bf16 v[188:191], a[160:163], v[220:223], v[188:191]
  ds_read_b64_tr_b16 a[156:157], v250 offset:32
  s_xor_b32 s82, s98, 0x800000
  s_cmp_eq_u32 s83, 0
  s_cselect_b32 s82, s82, 0x7ffffff0
  s_nop 0
  buffer_load_dwordx4 a[16:19], v251, s[32:35], s82 offen sc1
  buffer_load_dwordx4 a[20:23], v251, s[32:35], s82 offen offset:1024 sc1
  v_mfma_f32_16x16x32_bf16 v[132:135], a[164:167], v[216:219], v[132:135]
  buffer_load_dwordx4 a[24:27], v251, s[32:35], s82 offen offset:2048 sc1
  buffer_load_dwordx4 a[28:31], v251, s[32:35], s82 offen offset:3072 sc1
  v_mfma_f32_16x16x32_bf16 v[140:143], a[164:167], v[220:223], v[140:143]
  ds_read_b64_tr_b16 a[160:161], v250 offset:64
  v_mfma_f32_16x16x32_bf16 v[0:3], a[168:171], v[224:227], v[0:3]
  v_mfma_f32_16x16x32_bf16 v[4:7], a[168:171], v[228:231], v[4:7]
  ds_read_b64_tr_b16 a[164:165], v250 offset:96
  v_mfma_f32_16x16x32_bf16 v[8:11], a[172:175], v[224:227], v[8:11]
  v_mfma_f32_16x16x32_bf16 v[12:15], a[172:175], v[228:231], v[12:15]
  s_barrier
  s_nop 0
  v_add_u32_e32 v233, 0x6300, v233
  ds_read_b64_tr_b16 a[168:169], v233 offset:0
  v_mfma_f32_16x16x32_bf16 v[16:19], a[220:223], v[224:227], v[16:19]
  ds_read_b64_tr_b16 a[170:171], v233 offset:256
  v_mfma_f32_16x16x32_bf16 v[188:191], a[220:223], v[228:231], v[188:191]
  ds_read_b64_tr_b16 a[172:173], v233 offset:32
  s_add_u32 m0, s76, 0
  s_nop 0
  v_mfma_f32_16x16x32_bf16 v[132:135], a[224:227], v[224:227], v[132:135]
  buffer_load_dwordx4 v242, s[20:23], s62 offen lds
  ds_read_b64_tr_b16 a[174:175], v233 offset:288
  v_mfma_f32_16x16x32_bf16 v[140:143], a[224:227], v[228:231], v[140:143]
  ds_read_b64_tr_b16 a[220:221], v233 offset:64
  s_waitcnt vmcnt(11)
  buffer_store_dwordx2 v[248:249], v252, s[32:35], s39 offen sc1
  s_xor_b32 s39, s84, 3
  s_lshl_b32 s39, s39, 10
  v_mfma_f32_16x16x32_bf16 v[0:3], a[228:231], v[72:75], v[0:3]
  ds_read_b64_tr_b16 a[222:223], v233 offset:320
  s_add_u32 s39, s39, s97
  v_mfma_f32_16x16x32_bf16 v[4:7], a[228:231], v[76:79], v[4:7]
  ds_read_b64_tr_b16 a[224:225], v233 offset:96
  s_waitcnt lgkmcnt(7)
  s_nop 0
  v_mfma_f32_16x16x32_bf16 v[8:11], a[232:235], v[72:75], v[8:11]
  ds_read_b64_tr_b16 a[226:227], v233 offset:352
  v_mfma_f32_16x16x32_bf16 v[12:15], a[232:235], v[76:79], v[12:15]
  ds_read_b64_tr_b16 a[228:229], v233 offset:4224
  s_add_u32 m0, s76, 0x1080
  v_mfma_f32_16x16x32_bf16 v[16:19], a[144:147], v[72:75], v[16:19]
  buffer_load_dwordx4 v242, s[20:23], s63 offen lds
  ds_read_b64_tr_b16 a[230:231], v233 offset:4480
  v_mfma_f32_16x16x32_bf16 v[188:191], a[144:147], v[76:79], v[188:191]
  ds_read_b64_tr_b16 a[232:233], v233 offset:4256
  v_mfma_f32_16x16x32_bf16 v[132:135], a[148:151], v[72:75], v[132:135]
  ds_read_b64_tr_b16 a[234:235], v233 offset:4512
  v_mfma_f32_16x16x32_bf16 v[140:143], a[148:151], v[76:79], v[140:143]
  ds_read_b64_tr_b16 a[144:145], v233 offset:4288
  v_mfma_f32_4x4x4_16b_bf16 v[0:3], a[152:153], v[96:97], v[0:3]
  ds_read_b64_tr_b16 a[146:147], v233 offset:4544
  v_mfma_f32_4x4x4_16b_bf16 v[4:7], a[152:153], v[98:99], v[4:7]
  ds_read_b64_tr_b16 a[148:149], v233 offset:4320
  v_mfma_f32_4x4x4_16b_bf16 v[8:11], a[156:157], v[96:97], v[8:11]
  ds_read_b64_tr_b16 a[150:151], v233 offset:4576
  v_cvt_pk_bf16_f32 v0, v0, v1
  v_cvt_pk_bf16_f32 v1, v2, v3
  v_mfma_f32_4x4x4_16b_bf16 v[12:15], a[156:157], v[98:99], v[12:15]
  ds_read_b64_tr_b16 a[152:153], v233 offset:8448
  s_add_u32 m0, s76, 0x2100
  v_cvt_pk_bf16_f32 v2, v8, v9
  v_mfma_f32_4x4x4_16b_bf16 v[16:19], a[160:161], v[96:97], v[16:19]
  buffer_load_dwordx4 v242, s[20:23], s64 offen lds
  ds_read_b64_tr_b16 a[154:155], v233 offset:8704
  v_cvt_pk_bf16_f32 v3, v10, v11
  v_mfma_f32_4x4x4_16b_bf16 v[188:191], a[160:161], v[98:99], v[188:191]
  ds_read_b64_tr_b16 a[156:157], v233 offset:8480
  buffer_store_dwordx4 v[0:3], v251, s[32:35], s37 offen sc1
  v_cvt_pk_bf16_f32 v4, v4, v5
  v_mfma_f32_4x4x4_16b_bf16 v[132:135], a[164:165], v[96:97], v[132:135]
  ds_read_b64_tr_b16 a[158:159], v233 offset:8736
  v_cvt_pk_bf16_f32 v5, v6, v7
  v_cvt_pk_bf16_f32 v6, v12, v13
  v_mfma_f32_4x4x4_16b_bf16 v[140:143], a[164:165], v[98:99], v[140:143]
  ds_read_b64_tr_b16 a[160:161], v233 offset:8512
  buffer_load_dwordx2 v[246:247], v253, s[32:35], s71 offen sc1
  s_waitcnt lgkmcnt(8)
  s_nop 0
  v_mfma_f32_16x16x32_bf16 v[52:55], a[168:171], v[128:131], 0
  ds_read_b64_tr_b16 a[162:163], v233 offset:8768
  v_cvt_pk_bf16_f32 v7, v14, v15
  buffer_store_dwordx4 v[4:7], v251, s[32:35], s37 offen offset:1024 sc1
  v_mfma_f32_16x16x32_bf16 v[56:59], a[168:171], v[136:139], 0
  ds_read_b64_tr_b16 a[164:165], v233 offset:8544
  s_add_u32 m0, s76, 0x3180
  s_xor_b32 s37, s96, 0x150c000
  v_mfma_f32_16x16x32_bf16 v[60:63], a[172:175], v[128:131], 0
  buffer_load_dwordx4 v242, s[20:23], s65 offen lds
  ds_read_b64_tr_b16 a[166:167], v233 offset:8800
  v_cvt_pk_bf16_f32 v16, v16, v17
  v_mfma_f32_16x16x32_bf16 v[64:67], a[172:175], v[136:139], 0
  ds_read_b64_tr_b16 a[168:169], v233 offset:12672
  v_cvt_pk_bf16_f32 v17, v18, v19
  v_cvt_pk_bf16_f32 v18, v132, v133
  v_mfma_f32_16x16x32_bf16 v[164:167], a[220:223], v[128:131], 0
  ds_read_b64_tr_b16 a[170:171], v233 offset:12928
  v_cvt_pk_bf16_f32 v19, v134, v135
  buffer_store_dwordx4 v[16:19], v251, s[32:35], s37 offen sc1
  v_mfma_f32_16x16x32_bf16 v[172:175], a[220:223], v[136:139], 0
  ds_read_b64_tr_b16 a[172:173], v233 offset:12704
  v_cvt_pk_bf16_f32 v188, v188, v189
  v_cvt_pk_bf16_f32 v189, v190, v191
  v_mfma_f32_16x16x32_bf16 v[68:71], a[224:227], v[128:131], 0
  ds_read_b64_tr_b16 a[174:175], v233 offset:12960
  v_cvt_pk_bf16_f32 v190, v140, v141
  v_cvt_pk_bf16_f32 v191, v142, v143
  v_mfma_f32_16x16x32_bf16 v[180:183], a[224:227], v[136:139], 0
  ds_read_b64_tr_b16 a[220:221], v233 offset:12736
  buffer_store_dwordx4 v[188:191], v251, s[32:35], s37 offen offset:1024 sc1
  s_xor_b32 s37, s96, 0x1900000
  v_mfma_f32_16x16x32_bf16 v[52:55], a[228:231], v[144:147], v[52:55]
  ds_read_b64_tr_b16 a[222:223], v233 offset:12992
  v_mfma_f32_16x16x32_bf16 v[56:59], a[228:231], v[152:155], v[56:59]
  ds_read_b64_tr_b16 a[224:225], v233 offset:12768
  s_add_u32 m0, s76, 0x4200
  v_mfma_f32_16x16x32_bf16 v[60:63], a[232:235], v[144:147], v[60:63]
  buffer_load_dwordx4 v243, s[24:27], 0 offen lds
  ds_read_b64_tr_b16 a[226:227], v233 offset:13024
  v_mfma_f32_16x16x32_bf16 v[64:67], a[232:235], v[152:155], v[64:67]
  ds_read_b64_tr_b16 a[228:229], v233 offset:16896
  s_waitcnt lgkmcnt(6)
  s_nop 0
  v_mfma_f32_16x16x32_bf16 v[164:167], a[144:147], v[144:147], v[164:167]
  ds_read_b64_tr_b16 a[230:231], v233 offset:17152
  v_mfma_f32_16x16x32_bf16 v[172:175], a[144:147], v[152:155], v[172:175]
  ds_read_b64_tr_b16 a[232:233], v233 offset:16928
  v_mfma_f32_16x16x32_bf16 v[68:71], a[148:151], v[144:147], v[68:71]
  ds_read_b64_tr_b16 a[234:235], v233 offset:17184
  v_mfma_f32_16x16x32_bf16 v[180:183], a[148:151], v[152:155], v[180:183]
  ds_read_b64_tr_b16 a[144:145], v233 offset:16960
  v_mfma_f32_16x16x32_bf16 v[52:55], a[152:155], v[160:163], v[52:55]
  ds_read_b64_tr_b16 a[146:147], v233 offset:17216
  v_mfma_f32_16x16x32_bf16 v[56:59], a[152:155], v[168:171], v[56:59]
  ds_read_b64_tr_b16 a[148:149], v233 offset:16992
  v_mfma_f32_16x16x32_bf16 v[60:63], a[156:159], v[160:163], v[60:63]
  ds_read_b64_tr_b16 a[150:151], v233 offset:17248
  v_mfma_f32_16x16x32_bf16 v[64:67], a[156:159], v[168:171], v[64:67]
  s_waitcnt vmcnt(20)
  s_barrier
  v_add_u32_e32 v233, 0x6300, v233
  ds_read_b64_tr_b16 a[152:153], v233 offset:0
  v_mfma_f32_16x16x32_bf16 v[164:167], a[160:163], v[160:163], v[164:167]
  ds_read_b64_tr_b16 a[154:155], v233 offset:256
  v_mfma_f32_16x16x32_bf16 v[172:175], a[160:163], v[168:171], v[172:175]
  ds_read_b64_tr_b16 a[156:157], v233 offset:32
  s_add_u32 m0, s76, 0x6300
  s_xor_b32 s66, s84, 1
  s_lshl_b32 s66, s66, 7
  v_add_u32_e32 v242, s66, v234
  v_add_u32_e32 v243, s66, v235
  v_mfma_f32_16x16x32_bf16 v[68:71], a[164:167], v[160:163], v[68:71]
  buffer_load_dwordx4 v242, s[20:23], s57 offen lds
  ds_read_b64_tr_b16 a[158:159], v233 offset:288
  v_mfma_f32_16x16x32_bf16 v[180:183], a[164:167], v[168:171], v[180:183]
  ds_read_b64_tr_b16 a[160:161], v233 offset:64
  v_mfma_f32_16x16x32_bf16 v[52:55], a[168:171], v[176:179], v[52:55]
  ds_read_b64_tr_b16 a[162:163], v233 offset:320
  v_mfma_f32_16x16x32_bf16 v[56:59], a[168:171], v[184:187], v[56:59]
  ds_read_b64_tr_b16 a[164:165], v233 offset:96
  s_waitcnt lgkmcnt(6)
  s_nop 0
  v_mfma_f32_16x16x32_bf16 v[60:63], a[172:175], v[176:179], v[60:63]
  ds_read_b64_tr_b16 a[166:167], v233 offset:352
  v_mfma_f32_16x16x32_bf16 v[64:67], a[172:175], v[184:187], v[64:67]
  ds_read_b64_tr_b16 a[168:169], v233 offset:4224
  v_mfma_f32_16x16x32_bf16 v[164:167], a[220:223], v[176:179], v[164:167]
  ds_read_b64_tr_b16 a[170:171], v233 offset:4480
  v_mfma_f32_16x16x32_bf16 v[172:175], a[220:223], v[184:187], v[172:175]
  ds_read_b64_tr_b16 a[172:173], v233 offset:4256
  s_add_u32 m0, s76, 0x7380
  v_mfma_f32_16x16x32_bf16 v[68:71], a[224:227], v[176:179], v[68:71]
  buffer_load_dwordx4 v242, s[20:23], s58 offen lds
  ds_read_b64_tr_b16 a[174:175], v233 offset:4512
  v_mfma_f32_16x16x32_bf16 v[180:183], a[224:227], v[184:187], v[180:183]
  ds_read_b64_tr_b16 a[220:221], v233 offset:4288
  v_mfma_f32_16x16x32_bf16 v[52:55], a[228:231], v[192:195], v[52:55]
  ds_read_b64_tr_b16 a[222:223], v233 offset:4544
  v_mfma_f32_16x16x32_bf16 v[56:59], a[228:231], v[196:199], v[56:59]
  ds_read_b64_tr_b16 a[224:225], v233 offset:4320
  v_mfma_f32_16x16x32_bf16 v[60:63], a[232:235], v[192:195], v[60:63]
  ds_read_b64_tr_b16 a[226:227], v233 offset:4576
  v_mfma_f32_16x16x32_bf16 v[64:67], a[232:235], v[196:199], v[64:67]
  ds_read_b64_tr_b16 a[228:229], v233 offset:8448
  v_mfma_f32_16x16x32_bf16 v[164:167], a[144:147], v[192:195], v[164:167]
  ds_read_b64_tr_b16 a[230:231], v233 offset:8704
  v_mfma_f32_16x16x32_bf16 v[172:175], a[144:147], v[196:199], v[172:175]
  ds_read_b64_tr_b16 a[232:233], v233 offset:8480
  s_add_u32 m0, s76, 0x8400
  v_mfma_f32_16x16x32_bf16 v[68:71], a[148:151], v[192:195], v[68:71]
  buffer_load_dwordx4 v242, s[20:23], s59 offen lds
  ds_read_b64_tr_b16 a[234:235], v233 offset:8736
  v_mfma_f32_16x16x32_bf16 v[180:183], a[148:151], v[196:199], v[180:183]
  ds_read_b64_tr_b16 a[144:145], v233 offset:8512
  s_waitcnt lgkmcnt(7)
  s_nop 0
  v_mfma_f32_16x16x32_bf16 v[52:55], a[152:155], v[200:203], v[52:55]
  ds_read_b64_tr_b16 a[146:147], v233 offset:8768
  v_mfma_f32_16x16x32_bf16 v[56:59], a[152:155], v[204:207], v[56:59]
  ds_read_b64_tr_b16 a[148:149], v233 offset:8544
  v_mfma_f32_16x16x32_bf16 v[60:63], a[156:159], v[200:203], v[60:63]
  ds_read_b64_tr_b16 a[150:151], v233 offset:8800
  v_mfma_f32_16x16x32_bf16 v[64:67], a[156:159], v[204:207], v[64:67]
  ds_read_b64_tr_b16 a[152:153], v233 offset:12672
  v_mfma_f32_16x16x32_bf16 v[164:167], a[160:163], v[200:203], v[164:167]
  ds_read_b64_tr_b16 a[154:155], v233 offset:12928
  v_mfma_f32_16x16x32_bf16 v[172:175], a[160:163], v[204:207], v[172:175]
  ds_read_b64_tr_b16 a[156:157], v233 offset:12704
  v_mfma_f32_16x16x32_bf16 v[68:71], a[164:167], v[200:203], v[68:71]
  ds_read_b64_tr_b16 a[158:159], v233 offset:12960
  v_mfma_f32_16x16x32_bf16 v[180:183], a[164:167], v[204:207], v[180:183]
  ds_read_b64_tr_b16 a[160:161], v233 offset:12736
  s_add_u32 m0, s76, 0x9480
  v_mfma_f32_16x16x32_bf16 v[52:55], a[168:171], v[208:211], v[52:55]
  buffer_load_dwordx4 v242, s[20:23], s60 offen lds
  ds_read_b64_tr_b16 a[162:163], v233 offset:12992
  v_mfma_f32_16x16x32_bf16 v[56:59], a[168:171], v[212:215], v[56:59]
  ds_read_b64_tr_b16 a[164:165], v233 offset:12768
  v_mfma_f32_16x16x32_bf16 v[60:63], a[172:175], v[208:211], v[60:63]
  ds_read_b64_tr_b16 a[166:167], v233 offset:13024
  v_mfma_f32_16x16x32_bf16 v[64:67], a[172:175], v[212:215], v[64:67]
  s_xor_b32 s67, s84, 2
  s_lshl_b32 s67, s67, 7
  v_add_u32_e64 v250, s67, v236
  ds_read_b64_tr_b16 a[168:169], v233 offset:16896
  v_mfma_f32_16x16x32_bf16 v[164:167], a[220:223], v[208:211], v[164:167]
  ds_read_b64_tr_b16 a[170:171], v233 offset:17152
  v_mfma_f32_16x16x32_bf16 v[172:175], a[220:223], v[212:215], v[172:175]
  ds_read_b64_tr_b16 a[172:173], v233 offset:16928
  s_waitcnt lgkmcnt(7)
  s_nop 0
  v_mfma_f32_16x16x32_bf16 v[68:71], a[224:227], v[208:211], v[68:71]
  ds_read_b64_tr_b16 a[174:175], v233 offset:17184
  v_mfma_f32_16x16x32_bf16 v[180:183], a[224:227], v[212:215], v[180:183]
  ds_read_b64_tr_b16 a[220:221], v233 offset:16960
  s_add_u32 m0, s76, 0xa500
  v_mfma_f32_16x16x32_bf16 v[52:55], a[228:231], v[216:219], v[52:55]
  buffer_load_dwordx4 v242, s[20:23], s61 offen lds
  ds_read_b64_tr_b16 a[222:223], v233 offset:17216
  v_mfma_f32_16x16x32_bf16 v[56:59], a[228:231], v[220:223], v[56:59]
  ds_read_b64_tr_b16 a[224:225], v233 offset:16992
  v_mfma_f32_16x16x32_bf16 v[60:63], a[232:235], v[216:219], v[60:63]
  ds_read_b64_tr_b16 a[226:227], v233 offset:17248
  s_waitcnt vmcnt(10)
  s_nop 0
  v_cmp_eq_u64_e64 s[94:95], v[246:247], s[74:75]
  v_mfma_f32_16x16x32_bf16 v[64:67], a[232:235], v[220:223], v[64:67]
  ds_read_b64_tr_b16 a[228:229], v250 offset:0
s_and_b32 s82, s36, s94
  s_cbranch_scc1 Lslow5
Lret5:
  s_mov_b32 s83, 0
  s_xor_b32 s82, s84, 5
  s_lshl_b32 s82, s82, 1
  v_mfma_f32_16x16x32_bf16 v[164:167], a[144:147], v[216:219], v[164:167]
  s_lshl_b32 s82, 3, s82
  s_or_b32 s83, s83, s82
  s_andn2_b32 s83, s83, s94
  s_or_b32 s36, s36, s83
  s_xor_b32 s82, s98, 0xc00000
  v_mfma_f32_16x16x32_bf16 v[172:175], a[144:147], v[220:223], v[172:175]
  ds_read_b64_tr_b16 a[232:233], v250 offset:32
  s_cmp_eq_u32 s83, 0
  s_cselect_b32 s82, s82, 0x7ffffff0
  buffer_load_dwordx4 a[32:35], v251, s[32:35], s82 offen sc1
  buffer_load_dwordx4 a[36:39], v251, s[32:35], s82 offen offset:1024 sc1
  buffer_load_dwordx4 a[40:43], v251, s[32:35], s82 offen offset:2048 sc1
  v_mfma_f32_16x16x32_bf16 v[68:71], a[148:151], v[216:219], v[68:71]
  buffer_load_dwordx4 a[44:47], v251, s[32:35], s82 offen offset:3072 sc1
  v_mfma_f32_16x16x32_bf16 v[180:183], a[148:151], v[220:223], v[180:183]
  ds_read_b64_tr_b16 a[144:145], v250 offset:64
  v_mfma_f32_16x16x32_bf16 v[52:55], a[152:155], v[224:227], v[52:55]
  v_mfma_f32_16x16x32_bf16 v[56:59], a[152:155], v[228:231], v[56:59]
  ds_read_b64_tr_b16 a[148:149], v250 offset:96
  v_mfma_f32_16x16x32_bf16 v[60:63], a[156:159], v[224:227], v[60:63]
  v_mfma_f32_16x16x32_bf16 v[64:67], a[156:159], v[228:231], v[64:67]
  s_barrier
  v_add_u32_e32 v233, 0x6300, v233
  ds_read_b64_tr_b16 a[152:153], v233 offset:0
  s_waitcnt lgkmcnt(3)
  v_mfma_f32_16x16x32_bf16 v[164:167], a[160:163], v[224:227], v[164:167]
  ds_read_b64_tr_b16 a[154:155], v233 offset:256
  v_mfma_f32_16x16x32_bf16 v[172:175], a[160:163], v[228:231], v[172:175]
  ds_read_b64_tr_b16 a[156:157], v233 offset:32
  s_add_u32 m0, s76, 0xc600
  v_mfma_f32_16x16x32_bf16 v[68:71], a[164:167], v[224:227], v[68:71]
  buffer_load_dwordx4 v242, s[20:23], s62 offen lds
  ds_read_b64_tr_b16 a[158:159], v233 offset:288
  v_mfma_f32_16x16x32_bf16 v[180:183], a[164:167], v[228:231], v[180:183]
  ds_read_b64_tr_b16 a[160:161], v233 offset:4224
  s_add_u32 m0, s76, 0xd680
  s_waitcnt vmcnt(11)
  buffer_store_dwordx2 v[248:249], v252, s[32:35], s39 offen sc1
  s_xor_b32 s39, s84, 2
  v_mfma_f32_16x16x32_bf16 v[52:55], a[168:171], v[72:75], v[52:55]
  buffer_load_dwordx4 v242, s[20:23], s63 offen lds
  ds_read_b64_tr_b16 a[162:163], v233 offset:4480
  s_lshl_b32 s39, s39, 10
  s_add_u32 s39, s39, s97
  v_mfma_f32_16x16x32_bf16 v[56:59], a[168:171], v[76:79], v[56:59]
  ds_read_b64_tr_b16 a[164:165], v233 offset:4256
  v_mfma_f32_16x16x32_bf16 v[60:63], a[172:175], v[72:75], v[60:63]
  ds_read_b64_tr_b16 a[166:167], v233 offset:4512
  v_mfma_f32_16x16x32_bf16 v[64:67], a[172:175], v[76:79], v[64:67]
  ds_read_b64_tr_b16 a[168:169], v233 offset:8448
  s_add_u32 m0, s76, 0xe700
  v_mfma_f32_16x16x32_bf16 v[164:167], a[220:223], v[72:75], v[164:167]
  buffer_load_dwordx4 v242, s[20:23], s64 offen lds
  ds_read_b64_tr_b16 a[170:171], v233 offset:8704
  v_mfma_f32_16x16x32_bf16 v[172:175], a[220:223], v[76:79], v[172:175]
  ds_read_b64_tr_b16 a[172:173], v233 offset:8480
  s_add_u32 m0, s76, 0xf780
  v_mfma_f32_16x16x32_bf16 v[68:71], a[224:227], v[72:75], v[68:71]
  buffer_load_dwordx4 v242, s[20:23], s65 offen lds
  ds_read_b64_tr_b16 a[174:175], v233 offset:8736
  v_mfma_f32_16x16x32_bf16 v[180:183], a[224:227], v[76:79], v[180:183]
  ds_read_b64_tr_b16 a[220:221], v233 offset:12672
  buffer_load_dwordx2 v[246:247], v253, s[32:35], s71 offen sc1
  v_mfma_f32_4x4x4_16b_bf16 v[52:55], a[228:229], v[96:97], v[52:55]
  ds_read_b64_tr_b16 a[222:223], v233 offset:12928
  v_mfma_f32_4x4x4_16b_bf16 v[56:59], a[228:229], v[98:99], v[56:59]
  ds_read_b64_tr_b16 a[224:225], v233 offset:12704
  s_add_u32 m0, s76, 0x10800
  v_mfma_f32_4x4x4_16b_bf16 v[60:63], a[232:233], v[96:97], v[60:63]
  buffer_load_dwordx4 v243, s[24:27], 0 offen lds
  ds_read_b64_tr_b16 a[226:227], v233 offset:12960
  v_cvt_pk_bf16_f32 v52, v52, v53
  v_mfma_f32_4x4x4_16b_bf16 v[64:67], a[232:233], v[98:99], v[64:67]
  ds_read_b64_tr_b16 a[228:229], v233 offset:16896
  v_cvt_pk_bf16_f32 v53, v54, v55
  s_waitcnt lgkmcnt(8)
  s_nop 0
  v_mfma_f32_4x4x4_16b_bf16 v[164:167], a[144:145], v[96:97], v[164:167]
  ds_read_b64_tr_b16 a[230:231], v233 offset:17152
  v_cvt_pk_bf16_f32 v54, v60, v61
  v_cvt_pk_bf16_f32 v55, v62, v63
  v_mfma_f32_4x4x4_16b_bf16 v[172:175], a[144:145], v[98:99], v[172:175]
  ds_read_b64_tr_b16 a[232:233], v233 offset:16928
  buffer_store_dwordx4 v[52:55], v251, s[32:35], s37 offen sc1
  v_cvt_pk_bf16_f32 v56, v56, v57
  v_mfma_f32_4x4x4_16b_bf16 v[68:71], a[148:149], v[96:97], v[68:71]
  ds_read_b64_tr_b16 a[234:235], v233 offset:17184
  v_cvt_pk_bf16_f32 v57, v58, v59
  v_cvt_pk_bf16_f32 v58, v64, v65
  v_mfma_f32_4x4x4_16b_bf16 v[180:183], a[148:149], v[98:99], v[180:183]
  v_cvt_pk_bf16_f32 v59, v66, v67
  buffer_store_dwordx4 v[56:59], v251, s[32:35], s37 offen offset:1024 sc1
  s_xor_b32 s37, s96, 0x1904000
  s_waitcnt vmcnt(18)
  s_barrier
  v_add_u32_e32 v233, 0xfffe7400, v233
  ds_read_b64_tr_b16 a[144:145], v233 offset:0
  v_mfma_f32_16x16x32_bf16 v[0:3], a[152:155], v[128:131], 0
  ds_read_b64_tr_b16 a[146:147], v233 offset:256
  v_cvt_pk_bf16_f32 v164, v164, v165
  v_cvt_pk_bf16_f32 v165, v166, v167
  v_mfma_f32_16x16x32_bf16 v[4:7], a[152:155], v[136:139], 0
  ds_read_b64_tr_b16 a[148:149], v233 offset:32
  v_cvt_pk_bf16_f32 v166, v68, v69
  v_cvt_pk_bf16_f32 v167, v70, v71
  v_mfma_f32_16x16x32_bf16 v[8:11], a[156:159], v[128:131], 0
  ds_read_b64_tr_b16 a[150:151], v233 offset:288
  buffer_store_dwordx4 v[164:167], v251, s[32:35], s37 offen sc1
  v_cvt_pk_bf16_f32 v172, v172, v173
  v_mfma_f32_16x16x32_bf16 v[12:15], a[156:159], v[136:139], 0
  ds_read_b64_tr_b16 a[152:153], v233 offset:4224
  v_cvt_pk_bf16_f32 v173, v174, v175
  v_cvt_pk_bf16_f32 v174, v180, v181
  v_mfma_f32_16x16x32_bf16 v[0:3], a[160:163], v[144:147], v[0:3]
  ds_read_b64_tr_b16 a[154:155], v233 offset:4480
  v_cvt_pk_bf16_f32 v175, v182, v183
  buffer_store_dwordx4 v[172:175], v251, s[32:35], s37 offen offset:1024 sc1
  v_mfma_f32_16x16x32_bf16 v[4:7], a[160:163], v[152:155], v[4:7]
  ds_read_b64_tr_b16 a[156:157], v233 offset:4256
  s_xor_b32 s37, s96, 0x2000000
  v_mfma_f32_16x16x32_bf16 v[8:11], a[164:167], v[144:147], v[8:11]
  ds_read_b64_tr_b16 a[158:159], v233 offset:4512
  v_mfma_f32_16x16x32_bf16 v[12:15], a[164:167], v[152:155], v[12:15]
  ds_read_b64_tr_b16 a[160:161], v233 offset:8448
  s_waitcnt lgkmcnt(6)
  s_nop 0
  v_mfma_f32_16x16x32_bf16 v[0:3], a[168:171], v[160:163], v[0:3]
  ds_read_b64_tr_b16 a[162:163], v233 offset:8704
  v_mfma_f32_16x16x32_bf16 v[4:7], a[168:171], v[168:171], v[4:7]
  ds_read_b64_tr_b16 a[164:165], v233 offset:8480
  v_mfma_f32_16x16x32_bf16 v[8:11], a[172:175], v[160:163], v[8:11]
  ds_read_b64_tr_b16 a[166:167], v233 offset:8736
  v_mfma_f32_16x16x32_bf16 v[12:15], a[172:175], v[168:171], v[12:15]
  ds_read_b64_tr_b16 a[168:169], v233 offset:12672
  v_mfma_f32_16x16x32_bf16 v[0:3], a[220:223], v[176:179], v[0:3]
  ds_read_b64_tr_b16 a[170:171], v233 offset:12928
  v_mfma_f32_16x16x32_bf16 v[4:7], a[220:223], v[184:187], v[4:7]
  ds_read_b64_tr_b16 a[172:173], v233 offset:12704
  v_mfma_f32_16x16x32_bf16 v[8:11], a[224:227], v[176:179], v[8:11]
  ds_read_b64_tr_b16 a[174:175], v233 offset:12960
  v_mfma_f32_16x16x32_bf16 v[12:15], a[224:227], v[184:187], v[12:15]
  s_lshl_b32 s67, s84, 7
  v_add_u32_e32 v250, s67, v236
  ds_read_b64_tr_b16 a[220:221], v233 offset:16896
  v_mfma_f32_16x16x32_bf16 v[0:3], a[228:231], v[192:195], v[0:3]
  ds_read_b64_tr_b16 a[222:223], v233 offset:17152
  v_mfma_f32_16x16x32_bf16 v[4:7], a[228:231], v[196:199], v[4:7]
  ds_read_b64_tr_b16 a[224:225], v233 offset:16928
  v_mfma_f32_16x16x32_bf16 v[8:11], a[232:235], v[192:195], v[8:11]
  ds_read_b64_tr_b16 a[226:227], v233 offset:17184
  v_mfma_f32_16x16x32_bf16 v[12:15], a[232:235], v[196:199], v[12:15]
  ds_read_b64_tr_b16 a[228:229], v250 offset:0
  v_mfma_f32_16x16x32_bf16 v[0:3], a[144:147], v[200:203], v[0:3]
  v_mfma_f32_16x16x32_bf16 v[4:7], a[144:147], v[204:207], v[4:7]
  ds_read_b64_tr_b16 a[232:233], v250 offset:32
  s_waitcnt lgkmcnt(6)
  v_mfma_f32_16x16x32_bf16 v[8:11], a[148:151], v[200:203], v[8:11]
  v_mfma_f32_16x16x32_bf16 v[12:15], a[148:151], v[204:207], v[12:15]
  s_waitcnt vmcnt(15)
  s_barrier
  s_nop 0
  v_add_u32_e32 v233, 0x6300, v233
  ds_read_b64_tr_b16 a[144:145], v233 offset:0
  v_mfma_f32_16x16x32_bf16 v[0:3], a[152:155], v[208:211], v[0:3]
  ds_read_b64_tr_b16 a[146:147], v233 offset:256
  v_mfma_f32_16x16x32_bf16 v[4:7], a[152:155], v[212:215], v[4:7]
  ds_read_b64_tr_b16 a[148:149], v233 offset:32
  v_mfma_f32_16x16x32_bf16 v[8:11], a[156:159], v[208:211], v[8:11]
  ds_read_b64_tr_b16 a[150:151], v233 offset:288
  v_mfma_f32_16x16x32_bf16 v[12:15], a[156:159], v[212:215], v[12:15]
  ds_read_b64_tr_b16 a[152:153], v233 offset:4224
  v_mfma_f32_16x16x32_bf16 v[0:3], a[160:163], v[216:219], v[0:3]
  ds_read_b64_tr_b16 a[154:155], v233 offset:4480
  v_mfma_f32_16x16x32_bf16 v[4:7], a[160:163], v[220:223], v[4:7]
  ds_read_b64_tr_b16 a[156:157], v233 offset:4256
  v_mfma_f32_16x16x32_bf16 v[8:11], a[164:167], v[216:219], v[8:11]
  ds_read_b64_tr_b16 a[158:159], v233 offset:4512
  v_mfma_f32_16x16x32_bf16 v[12:15], a[164:167], v[220:223], v[12:15]
  ds_read_b64_tr_b16 a[160:161], v233 offset:8448
  v_mfma_f32_16x16x32_bf16 v[0:3], a[168:171], v[224:227], v[0:3]
  ds_read_b64_tr_b16 a[162:163], v233 offset:8704
  v_mfma_f32_16x16x32_bf16 v[4:7], a[168:171], v[228:231], v[4:7]
  ds_read_b64_tr_b16 a[164:165], v233 offset:8480
  v_mfma_f32_16x16x32_bf16 v[8:11], a[172:175], v[224:227], v[8:11]
  ds_read_b64_tr_b16 a[166:167], v233 offset:8736
  v_mfma_f32_16x16x32_bf16 v[12:15], a[172:175], v[228:231], v[12:15]
  ds_read_b64_tr_b16 a[168:169], v233 offset:12672
  s_waitcnt lgkmcnt(7)
  s_nop 0
  v_mfma_f32_16x16x32_bf16 v[0:3], a[220:223], v[72:75], v[0:3]
  ds_read_b64_tr_b16 a[170:171], v233 offset:12928
  v_mfma_f32_16x16x32_bf16 v[4:7], a[220:223], v[76:79], v[4:7]
  ds_read_b64_tr_b16 a[172:173], v233 offset:12704
  v_mfma_f32_16x16x32_bf16 v[8:11], a[224:227], v[72:75], v[8:11]
  ds_read_b64_tr_b16 a[174:175], v233 offset:12960
  v_mfma_f32_16x16x32_bf16 v[12:15], a[224:227], v[76:79], v[12:15]
  ds_read_b64_tr_b16 a[220:221], v233 offset:16896
  v_mfma_f32_4x4x4_16b_bf16 v[0:3], a[228:229], v[96:97], v[0:3]
  ds_read_b64_tr_b16 a[222:223], v233 offset:17152
  v_mfma_f32_4x4x4_16b_bf16 v[4:7], a[228:229], v[98:99], v[4:7]
  ds_read_b64_tr_b16 a[224:225], v233 offset:16928
  v_mfma_f32_4x4x4_16b_bf16 v[8:11], a[232:233], v[96:97], v[8:11]
  ds_read_b64_tr_b16 a[226:227], v233 offset:17184
  v_cvt_pk_bf16_f32 v0, v0, v1
  v_cvt_pk_bf16_f32 v1, v2, v3
  v_mfma_f32_4x4x4_16b_bf16 v[12:15], a[232:233], v[98:99], v[12:15]
  s_waitcnt vmcnt(4)
  s_barrier
  v_add_u32_e32 v233, 0x6300, v233
  ds_read_b64_tr_b16 a[228:229], v233 offset:0
  v_cmp_eq_u64_e64 s[94:95], v[246:247], s[74:75]
  v_mfma_f32_16x16x32_bf16 v[20:23], a[144:147], v[128:131], 0
  ds_read_b64_tr_b16 a[230:231], v233 offset:256
s_and_b32 s82, s36, s94
  s_cbranch_scc1 Lslow6
Lret6:
  s_mov_b32 s83, 0
  s_xor_b32 s82, s84, 4
  s_lshl_b32 s82, s82, 1
  v_mfma_f32_16x16x32_bf16 v[24:27], a[144:147], v[136:139], 0
  ds_read_b64_tr_b16 a[232:233], v233 offset:32
  s_lshl_b32 s82, 3, s82
  s_or_b32 s83, s83, s82
  s_andn2_b32 s83, s83, s94
  s_or_b32 s36, s36, s83
  v_mfma_f32_16x16x32_bf16 v[28:31], a[148:151], v[128:131], 0
  ds_read_b64_tr_b16 a[234:235], v233 offset:288
  s_xor_b32 s82, s98, 0x1000000
  s_cmp_eq_u32 s83, 0
  s_cselect_b32 s82, s82, 0x7ffffff0
  buffer_load_dwordx4 a[48:51], v251, s[32:35], s82 offen sc1
  buffer_load_dwordx4 a[52:55], v251, s[32:35], s82 offen offset:1024 sc1
  v_mfma_f32_16x16x32_bf16 v[32:35], a[148:151], v[136:139], 0
  ds_read_b64_tr_b16 a[144:145], v233 offset:4224
  buffer_load_dwordx4 a[56:59], v251, s[32:35], s82 offen offset:2048 sc1
  buffer_load_dwordx4 a[60:63], v251, s[32:35], s82 offen offset:3072 sc1
  v_mfma_f32_16x16x32_bf16 v[20:23], a[152:155], v[144:147], v[20:23]
  ds_read_b64_tr_b16 a[146:147], v233 offset:4480
  v_cvt_pk_bf16_f32 v2, v8, v9
  v_cvt_pk_bf16_f32 v3, v10, v11
  v_mfma_f32_16x16x32_bf16 v[24:27], a[152:155], v[152:155], v[24:27]
  ds_read_b64_tr_b16 a[148:149], v233 offset:4256
  buffer_store_dwordx4 v[0:3], v251, s[32:35], s37 offen sc1
  s_waitcnt lgkmcnt(5)
  s_nop 0
  v_mfma_f32_16x16x32_bf16 v[28:31], a[156:159], v[144:147], v[28:31]
  ds_read_b64_tr_b16 a[150:151], v233 offset:4512
  v_cvt_pk_bf16_f32 v4, v4, v5
  v_cvt_pk_bf16_f32 v5, v6, v7
  v_mfma_f32_16x16x32_bf16 v[32:35], a[156:159], v[152:155], v[32:35]
  ds_read_b64_tr_b16 a[152:153], v233 offset:8448
  v_cvt_pk_bf16_f32 v6, v12, v13
  v_cvt_pk_bf16_f32 v7, v14, v15
  v_mfma_f32_16x16x32_bf16 v[20:23], a[160:163], v[160:163], v[20:23]
  ds_read_b64_tr_b16 a[154:155], v233 offset:8704
  buffer_store_dwordx4 v[4:7], v251, s[32:35], s37 offen offset:1024 sc1
  s_xor_b32 s37, s96, 0x1c08000
  v_mfma_f32_16x16x32_bf16 v[24:27], a[160:163], v[168:171], v[24:27]
  ds_read_b64_tr_b16 a[156:157], v233 offset:8480
  v_mfma_f32_16x16x32_bf16 v[28:31], a[164:167], v[160:163], v[28:31]
  ds_read_b64_tr_b16 a[158:159], v233 offset:8736
  v_mfma_f32_16x16x32_bf16 v[32:35], a[164:167], v[168:171], v[32:35]
  ds_read_b64_tr_b16 a[160:161], v233 offset:12672
  v_mfma_f32_16x16x32_bf16 v[20:23], a[168:171], v[176:179], v[20:23]
  ds_read_b64_tr_b16 a[162:163], v233 offset:12928
  v_mfma_f32_16x16x32_bf16 v[24:27], a[168:171], v[184:187], v[24:27]
  ds_read_b64_tr_b16 a[164:165], v233 offset:12704
  v_mfma_f32_16x16x32_bf16 v[28:31], a[172:175], v[176:179], v[28:31]
  ds_read_b64_tr_b16 a[166:167], v233 offset:12960
  v_mfma_f32_16x16x32_bf16 v[32:35], a[172:175], v[184:187], v[32:35]
  s_xor_b32 s67, s84, 1
  s_lshl_b32 s67, s67, 7
  v_add_u32_e64 v250, s67, v236
  ds_read_b64_tr_b16 a[168:169], v233 offset:16896
  v_mfma_f32_16x16x32_bf16 v[20:23], a[220:223], v[192:195], v[20:23]
  ds_read_b64_tr_b16 a[170:171], v233 offset:17152
  v_mfma_f32_16x16x32_bf16 v[24:27], a[220:223], v[196:199], v[24:27]
  ds_read_b64_tr_b16 a[172:173], v233 offset:16928
  v_mfma_f32_16x16x32_bf16 v[28:31], a[224:227], v[192:195], v[28:31]
  ds_read_b64_tr_b16 a[174:175], v233 offset:17184
  v_mfma_f32_16x16x32_bf16 v[32:35], a[224:227], v[196:199], v[32:35]
  ds_read_b64_tr_b16 a[220:221], v250 offset:0
  buffer_load_dwordx2 v[246:247], v253, s[32:35], s71 offen sc1
  v_mfma_f32_16x16x32_bf16 v[20:23], a[228:231], v[200:203], v[20:23]
  v_mfma_f32_16x16x32_bf16 v[24:27], a[228:231], v[204:207], v[24:27]
  ds_read_b64_tr_b16 a[224:225], v250 offset:32
  s_waitcnt lgkmcnt(6)
  s_nop 0
  v_mfma_f32_16x16x32_bf16 v[28:31], a[232:235], v[200:203], v[28:31]
  v_mfma_f32_16x16x32_bf16 v[32:35], a[232:235], v[204:207], v[32:35]
  v_add_u32_e32 v233, 0xffff9d00, v233
  ds_read_b64_tr_b16 a[228:229], v233 offset:64
  v_mfma_f32_16x16x32_bf16 v[20:23], a[144:147], v[208:211], v[20:23]
  ds_read_b64_tr_b16 a[230:231], v233 offset:320
  v_mfma_f32_16x16x32_bf16 v[24:27], a[144:147], v[212:215], v[24:27]
  ds_read_b64_tr_b16 a[232:233], v233 offset:96
  s_waitcnt vmcnt(7)
  s_nop 0
  buffer_store_dwordx2 v[248:249], v252, s[32:35], s39 offen sc1
  v_mfma_f32_16x16x32_bf16 v[28:31], a[148:151], v[208:211], v[28:31]
  ds_read_b64_tr_b16 a[234:235], v233 offset:352
  v_mfma_f32_16x16x32_bf16 v[32:35], a[148:151], v[212:215], v[32:35]
  ds_read_b64_tr_b16 a[144:145], v233 offset:4288
  v_mfma_f32_16x16x32_bf16 v[20:23], a[152:155], v[216:219], v[20:23]
  ds_read_b64_tr_b16 a[146:147], v233 offset:4544
  v_mfma_f32_16x16x32_bf16 v[24:27], a[152:155], v[220:223], v[24:27]
  ds_read_b64_tr_b16 a[148:149], v233 offset:4320
  v_mfma_f32_16x16x32_bf16 v[28:31], a[156:159], v[216:219], v[28:31]
  ds_read_b64_tr_b16 a[150:151], v233 offset:4576
  v_mfma_f32_16x16x32_bf16 v[32:35], a[156:159], v[220:223], v[32:35]
  ds_read_b64_tr_b16 a[152:153], v233 offset:8512
  v_mfma_f32_16x16x32_bf16 v[20:23], a[160:163], v[224:227], v[20:23]
  ds_read_b64_tr_b16 a[154:155], v233 offset:8768
  v_mfma_f32_16x16x32_bf16 v[24:27], a[160:163], v[228:231], v[24:27]
  ds_read_b64_tr_b16 a[156:157], v233 offset:8544
  v_mfma_f32_16x16x32_bf16 v[28:31], a[164:167], v[224:227], v[28:31]
  ds_read_b64_tr_b16 a[158:159], v233 offset:8800
  v_mfma_f32_16x16x32_bf16 v[32:35], a[164:167], v[228:231], v[32:35]
  ds_read_b64_tr_b16 a[160:161], v233 offset:12736
  s_waitcnt lgkmcnt(7)
  s_nop 0
  v_mfma_f32_16x16x32_bf16 v[20:23], a[168:171], v[72:75], v[20:23]
  ds_read_b64_tr_b16 a[162:163], v233 offset:12992
  v_mfma_f32_16x16x32_bf16 v[24:27], a[168:171], v[76:79], v[24:27]
  ds_read_b64_tr_b16 a[164:165], v233 offset:12768
  v_mfma_f32_16x16x32_bf16 v[28:31], a[172:175], v[72:75], v[28:31]
  ds_read_b64_tr_b16 a[166:167], v233 offset:13024
  v_mfma_f32_16x16x32_bf16 v[32:35], a[172:175], v[76:79], v[32:35]
  ds_read_b64_tr_b16 a[168:169], v233 offset:16960
  v_mfma_f32_4x4x4_16b_bf16 v[20:23], a[220:221], v[96:97], v[20:23]
  ds_read_b64_tr_b16 a[170:171], v233 offset:17216
  v_mfma_f32_4x4x4_16b_bf16 v[24:27], a[220:221], v[98:99], v[24:27]
  ds_read_b64_tr_b16 a[172:173], v233 offset:16992
  v_mfma_f32_4x4x4_16b_bf16 v[28:31], a[224:225], v[96:97], v[28:31]
  ds_read_b64_tr_b16 a[174:175], v233 offset:17248
  v_cvt_pk_bf16_f32 v20, v20, v21
  v_cvt_pk_bf16_f32 v21, v22, v23
  v_mfma_f32_4x4x4_16b_bf16 v[32:35], a[224:225], v[98:99], v[32:35]
  v_add_u32_e32 v233, 0x6300, v233
  ds_read_b64_tr_b16 a[220:221], v233 offset:64
  v_cvt_pk_bf16_f32 v22, v28, v29
  v_mfma_f32_16x16x32_bf16 v[36:39], a[228:231], v[128:131], 0
  ds_read_b64_tr_b16 a[222:223], v233 offset:320
  v_cvt_pk_bf16_f32 v23, v30, v31
  buffer_store_dwordx4 v[20:23], v251, s[32:35], s37 offen sc1
  v_mfma_f32_16x16x32_bf16 v[40:43], a[228:231], v[136:139], 0
  ds_read_b64_tr_b16 a[224:225], v233 offset:96
  v_cvt_pk_bf16_f32 v24, v24, v25
  v_cvt_pk_bf16_f32 v25, v26, v27
  v_mfma_f32_16x16x32_bf16 v[44:47], a[232:235], v[128:131], 0
  ds_read_b64_tr_b16 a[226:227], v233 offset:352
  v_cvt_pk_bf16_f32 v26, v32, v33
  v_cvt_pk_bf16_f32 v27, v34, v35
  v_mfma_f32_16x16x32_bf16 v[48:51], a[232:235], v[136:139], 0
  ds_read_b64_tr_b16 a[228:229], v233 offset:4288
  buffer_store_dwordx4 v[24:27], v251, s[32:35], s37 offen offset:1024 sc1
  s_xor_b32 s37, s96, 0x1c0c000
  v_mfma_f32_16x16x32_bf16 v[36:39], a[144:147], v[144:147], v[36:39]
  ds_read_b64_tr_b16 a[230:231], v233 offset:4544
  v_mfma_f32_16x16x32_bf16 v[40:43], a[144:147], v[152:155], v[40:43]
  ds_read_b64_tr_b16 a[232:233], v233 offset:4320
  s_waitcnt lgkmcnt(6)
  s_nop 0
  v_mfma_f32_16x16x32_bf16 v[44:47], a[148:151], v[144:147], v[44:47]
  ds_read_b64_tr_b16 a[234:235], v233 offset:4576
  v_mfma_f32_16x16x32_bf16 v[48:51], a[148:151], v[152:155], v[48:51]
  ds_read_b64_tr_b16 a[144:145], v233 offset:8512
  v_mfma_f32_16x16x32_bf16 v[36:39], a[152:155], v[160:163], v[36:39]
  ds_read_b64_tr_b16 a[146:147], v233 offset:8768
  v_mfma_f32_16x16x32_bf16 v[40:43], a[152:155], v[168:171], v[40:43]
  ds_read_b64_tr_b16 a[148:149], v233 offset:8544
  v_mfma_f32_16x16x32_bf16 v[44:47], a[156:159], v[160:163], v[44:47]
  ds_read_b64_tr_b16 a[150:151], v233 offset:8800
  v_mfma_f32_16x16x32_bf16 v[48:51], a[156:159], v[168:171], v[48:51]
  ds_read_b64_tr_b16 a[152:153], v233 offset:12736
  v_mfma_f32_16x16x32_bf16 v[36:39], a[160:163], v[176:179], v[36:39]
  ds_read_b64_tr_b16 a[154:155], v233 offset:12992
  v_mfma_f32_16x16x32_bf16 v[40:43], a[160:163], v[184:187], v[40:43]
  ds_read_b64_tr_b16 a[156:157], v233 offset:12768
  v_mfma_f32_16x16x32_bf16 v[44:47], a[164:167], v[176:179], v[44:47]
  ds_read_b64_tr_b16 a[158:159], v233 offset:13024
  v_mfma_f32_16x16x32_bf16 v[48:51], a[164:167], v[184:187], v[48:51]
  ds_read_b64_tr_b16 a[160:161], v233 offset:16960
  v_mfma_f32_16x16x32_bf16 v[36:39], a[168:171], v[192:195], v[36:39]
  ds_read_b64_tr_b16 a[162:163], v233 offset:17216
  v_mfma_f32_16x16x32_bf16 v[40:43], a[168:171], v[196:199], v[40:43]
  ds_read_b64_tr_b16 a[164:165], v233 offset:16992
  v_mfma_f32_16x16x32_bf16 v[44:47], a[172:175], v[192:195], v[44:47]
  ds_read_b64_tr_b16 a[166:167], v233 offset:17248
  v_mfma_f32_16x16x32_bf16 v[48:51], a[172:175], v[196:199], v[48:51]
  ds_read_b64_tr_b16 a[168:169], v250 offset:64
  s_waitcnt lgkmcnt(7)
  s_nop 0
  v_mfma_f32_16x16x32_bf16 v[36:39], a[220:223], v[200:203], v[36:39]
  v_mfma_f32_16x16x32_bf16 v[40:43], a[220:223], v[204:207], v[40:43]
  ds_read_b64_tr_b16 a[172:173], v250 offset:96
  v_mfma_f32_16x16x32_bf16 v[44:47], a[224:227], v[200:203], v[44:47]
  v_mfma_f32_16x16x32_bf16 v[48:51], a[224:227], v[204:207], v[48:51]
  v_add_u32_e32 v233, 0xc600, v233
  ds_read_b64_tr_b16 a[220:221], v233 offset:64
  v_mfma_f32_16x16x32_bf16 v[36:39], a[228:231], v[208:211], v[36:39]
  ds_read_b64_tr_b16 a[222:223], v233 offset:320
  v_mfma_f32_16x16x32_bf16 v[40:43], a[228:231], v[212:215], v[40:43]
  ds_read_b64_tr_b16 a[224:225], v233 offset:96
  v_mfma_f32_16x16x32_bf16 v[44:47], a[232:235], v[208:211], v[44:47]
  ds_read_b64_tr_b16 a[226:227], v233 offset:352
  v_mfma_f32_16x16x32_bf16 v[48:51], a[232:235], v[212:215], v[48:51]
  ds_read_b64_tr_b16 a[228:229], v233 offset:4288
  v_mfma_f32_16x16x32_bf16 v[36:39], a[144:147], v[216:219], v[36:39]
  ds_read_b64_tr_b16 a[230:231], v233 offset:4544
  v_mfma_f32_16x16x32_bf16 v[40:43], a[144:147], v[220:223], v[40:43]
  ds_read_b64_tr_b16 a[232:233], v233 offset:4320
  v_mfma_f32_16x16x32_bf16 v[44:47], a[148:151], v[216:219], v[44:47]
  ds_read_b64_tr_b16 a[234:235], v233 offset:4576
  v_mfma_f32_16x16x32_bf16 v[48:51], a[148:151], v[220:223], v[48:51]
  ds_read_b64_tr_b16 a[144:145], v233 offset:8512
  v_mfma_f32_16x16x32_bf16 v[36:39], a[152:155], v[224:227], v[36:39]
  ds_read_b64_tr_b16 a[146:147], v233 offset:8768
  v_mfma_f32_16x16x32_bf16 v[40:43], a[152:155], v[228:231], v[40:43]
  ds_read_b64_tr_b16 a[148:149], v233 offset:8544
  s_waitcnt lgkmcnt(7)
  s_nop 0
  v_mfma_f32_16x16x32_bf16 v[44:47], a[156:159], v[224:227], v[44:47]
  ds_read_b64_tr_b16 a[150:151], v233 offset:8800
  v_mfma_f32_16x16x32_bf16 v[48:51], a[156:159], v[228:231], v[48:51]
  ds_read_b64_tr_b16 a[152:153], v233 offset:12736
  v_mfma_f32_16x16x32_bf16 v[36:39], a[160:163], v[72:75], v[36:39]
  ds_read_b64_tr_b16 a[154:155], v233 offset:12992
  v_mfma_f32_16x16x32_bf16 v[40:43], a[160:163], v[76:79], v[40:43]
  ds_read_b64_tr_b16 a[156:157], v233 offset:12768
  v_mfma_f32_16x16x32_bf16 v[44:47], a[164:167], v[72:75], v[44:47]
  ds_read_b64_tr_b16 a[158:159], v233 offset:13024
  s_waitcnt vmcnt(3)
  s_nop 0
  v_cmp_eq_u64_e64 s[94:95], v[246:247], s[74:75]
  v_mfma_f32_16x16x32_bf16 v[48:51], a[164:167], v[76:79], v[48:51]
  ds_read_b64_tr_b16 a[160:161], v233 offset:16960
s_and_b32 s82, s36, s94
  s_cbranch_scc1 Lslow7
Lret7:
  s_mov_b32 s83, 0
  s_xor_b32 s82, s84, 3
  s_lshl_b32 s82, s82, 1
  v_mfma_f32_4x4x4_16b_bf16 v[36:39], a[168:169], v[96:97], v[36:39]
  ds_read_b64_tr_b16 a[162:163], v233 offset:17216
  s_lshl_b32 s82, 3, s82
  s_or_b32 s83, s83, s82
  s_andn2_b32 s83, s83, s94
  s_or_b32 s36, s36, s83
  v_mfma_f32_4x4x4_16b_bf16 v[40:43], a[168:169], v[98:99], v[40:43]
  ds_read_b64_tr_b16 a[164:165], v233 offset:16992
  s_xor_b32 s82, s98, 0x1400000
  s_cmp_eq_u32 s83, 0
  s_cselect_b32 s82, s82, 0x7ffffff0
  buffer_load_dwordx4 a[64:67], v251, s[32:35], s82 offen sc1
  buffer_load_dwordx4 a[68:71], v251, s[32:35], s82 offen offset:1024 sc1
  v_mfma_f32_4x4x4_16b_bf16 v[44:47], a[172:173], v[96:97], v[44:47]
  ds_read_b64_tr_b16 a[166:167], v233 offset:17248
  buffer_load_dwordx4 a[72:75], v251, s[32:35], s82 offen offset:2048 sc1
  buffer_load_dwordx4 a[76:79], v251, s[32:35], s82 offen offset:3072 sc1
  v_mfma_f32_16x16x32_bf16 v[52:55], a[176:179], a[236:239], 0
  v_cvt_pk_bf16_f32 v36, v36, v37
  v_mfma_f32_16x16x32_bf16 v[60:63], a[180:183], a[236:239], 0
  v_cvt_pk_bf16_f32 v37, v38, v39
  v_mfma_f32_16x16x32_bf16 v[56:59], a[176:179], a[240:243], 0
  v_cvt_pk_bf16_f32 v38, v44, v45
  v_mfma_f32_16x16x32_bf16 v[64:67], a[180:183], a[240:243], 0
  v_cvt_pk_bf16_f32 v39, v46, v47
  v_mfma_f32_16x16x32_bf16 v[164:167], a[252:255], a[244:247], 0
  v_accvgpr_read_b32 v172, a186
  v_accvgpr_read_b32 v173, a187
  v_accvgpr_read_b32 v174, a186
  v_mfma_f32_4x4x4_16b_bf16 v[48:51], a[172:173], v[98:99], v[48:51]
  v_add_u32_e32 v233, 0xfffe7400, v233
  ds_read_b64_tr_b16 a[168:169], v233 offset:64
  v_mov_b32_dpp v174, v173 quad_perm:[0,1,2,3] row_mask:0x2 bank_mask:0xf
  buffer_load_dwordx2 v[246:247], v253, s[32:35], s71 offen sc1
  v_mfma_f32_16x16x32_bf16 v[100:103], a[220:223], v[128:131], 0
  ds_read_b64_tr_b16 a[170:171], v233 offset:320
  buffer_store_dwordx4 v[36:39], v251, s[32:35], s37 offen sc1
  v_cvt_pk_bf16_f32 v40, v40, v41
  v_mfma_f32_16x16x32_bf16 v[104:107], a[220:223], v[136:139], 0
  ds_read_b64_tr_b16 a[172:173], v233 offset:96
  v_cvt_pk_bf16_f32 v41, v42, v43
  v_cvt_pk_bf16_f32 v42, v48, v49
  v_mfma_f32_16x16x32_bf16 v[108:111], a[224:227], v[128:131], 0
  ds_read_b64_tr_b16 a[174:175], v233 offset:352
  v_cvt_pk_bf16_f32 v43, v50, v51
  buffer_store_dwordx4 v[40:43], v251, s[32:35], s37 offen offset:1024 sc1
  v_mfma_f32_16x16x32_bf16 v[116:119], a[224:227], v[136:139], 0
  ds_read_b64_tr_b16 a[220:221], v233 offset:4288
  s_waitcnt lgkmcnt(5)
  s_nop 0
  v_mfma_f32_16x16x32_bf16 v[100:103], a[228:231], v[144:147], v[100:103]
  ds_read_b64_tr_b16 a[222:223], v233 offset:4544
  v_mfma_f32_16x16x32_bf16 v[104:107], a[228:231], v[152:155], v[104:107]
  ds_read_b64_tr_b16 a[224:225], v233 offset:4320
  v_mfma_f32_16x16x32_bf16 v[108:111], a[232:235], v[144:147], v[108:111]
  ds_read_b64_tr_b16 a[226:227], v233 offset:4576
  v_mfma_f32_16x16x32_bf16 v[116:119], a[232:235], v[152:155], v[116:119]
  ds_read_b64_tr_b16 a[228:229], v233 offset:8512
  v_mfma_f32_16x16x32_bf16 v[100:103], a[144:147], v[160:163], v[100:103]
  ds_read_b64_tr_b16 a[230:231], v233 offset:8768
  v_mfma_f32_16x16x32_bf16 v[104:107], a[144:147], v[168:171], v[104:107]
  ds_read_b64_tr_b16 a[232:233], v233 offset:8544
  v_mfma_f32_16x16x32_bf16 v[108:111], a[148:151], v[160:163], v[108:111]
  ds_read_b64_tr_b16 a[234:235], v233 offset:8800
  v_mfma_f32_16x16x32_bf16 v[116:119], a[148:151], v[168:171], v[116:119]
  ds_read_b64_tr_b16 a[144:145], v233 offset:12736
  v_mfma_f32_16x16x32_bf16 v[100:103], a[152:155], v[176:179], v[100:103]
  ds_read_b64_tr_b16 a[146:147], v233 offset:12992
  v_mfma_f32_16x16x32_bf16 v[104:107], a[152:155], v[184:187], v[104:107]
  ds_read_b64_tr_b16 a[148:149], v233 offset:12768
  v_mfma_f32_16x16x32_bf16 v[108:111], a[156:159], v[176:179], v[108:111]
  ds_read_b64_tr_b16 a[150:151], v233 offset:13024
  v_mfma_f32_16x16x32_bf16 v[116:119], a[156:159], v[184:187], v[116:119]
  s_lshl_b32 s67, s84, 7
  v_add_u32_e32 v250, s67, v236
  ds_read_b64_tr_b16 a[152:153], v233 offset:16960
  v_mfma_f32_16x16x32_bf16 v[100:103], a[160:163], v[192:195], v[100:103]
  ds_read_b64_tr_b16 a[154:155], v233 offset:17216
  v_mfma_f32_16x16x32_bf16 v[104:107], a[160:163], v[196:199], v[104:107]
  ds_read_b64_tr_b16 a[156:157], v233 offset:16992
  v_mfma_f32_16x16x32_bf16 v[108:111], a[164:167], v[192:195], v[108:111]
  ds_read_b64_tr_b16 a[158:159], v233 offset:17248
  v_mfma_f32_16x16x32_bf16 v[116:119], a[164:167], v[196:199], v[116:119]
  ds_read_b64_tr_b16 a[160:161], v250 offset:64
  s_xor_b32 s72, s96, 0x2004800
  buffer_load_dwordx4 a[112:115], v251, s[32:35], s72 offen sc1
  buffer_load_dwordx4 a[116:119], v251, s[32:35], s72 offen offset:1024 sc1
  s_waitcnt lgkmcnt(6)
  s_nop 0
  v_mfma_f32_16x16x32_bf16 v[100:103], a[168:171], v[200:203], v[100:103]
  v_mfma_f32_16x16x32_bf16 v[104:107], a[168:171], v[204:207], v[104:107]
  ds_read_b64_tr_b16 a[164:165], v250 offset:96
  v_mfma_f32_16x16x32_bf16 v[108:111], a[172:175], v[200:203], v[108:111]
  v_mfma_f32_16x16x32_bf16 v[116:119], a[172:175], v[204:207], v[116:119]
  v_mfma_f32_16x16x32_bf16 v[100:103], a[220:223], v[208:211], v[100:103]
  v_mfma_f32_16x16x32_bf16 v[104:107], a[220:223], v[212:215], v[104:107]
  v_mfma_f32_16x16x32_bf16 v[108:111], a[224:227], v[208:211], v[108:111]
  v_mfma_f32_16x16x32_bf16 v[116:119], a[224:227], v[212:215], v[116:119]
  v_mfma_f32_16x16x32_bf16 v[100:103], a[228:231], v[216:219], v[100:103]
  v_mfma_f32_16x16x32_bf16 v[104:107], a[228:231], v[220:223], v[104:107]
  v_mfma_f32_16x16x32_bf16 v[108:111], a[232:235], v[216:219], v[108:111]
  v_mfma_f32_16x16x32_bf16 v[116:119], a[232:235], v[220:223], v[116:119]
  v_mfma_f32_16x16x32_bf16 v[100:103], a[144:147], v[224:227], v[100:103]
  v_mfma_f32_16x16x32_bf16 v[104:107], a[144:147], v[228:231], v[104:107]
  s_waitcnt lgkmcnt(0)
  s_nop 0
  v_mfma_f32_16x16x32_bf16 v[108:111], a[148:151], v[224:227], v[108:111]
  v_mfma_f32_16x16x32_bf16 v[116:119], a[148:151], v[228:231], v[116:119]
  v_mfma_f32_16x16x32_bf16 v[100:103], a[152:155], v[72:75], v[100:103]
  v_mfma_f32_16x16x32_bf16 v[104:107], a[152:155], v[76:79], v[104:107]
  v_mfma_f32_16x16x32_bf16 v[108:111], a[156:159], v[72:75], v[108:111]
  v_mfma_f32_16x16x32_bf16 v[116:119], a[156:159], v[76:79], v[116:119]
  s_nop 2
  s_nop 0
  v_mfma_f32_4x4x4_16b_bf16 v[100:103], a[160:161], v[96:97], v[100:103]
  v_mfma_f32_4x4x4_16b_bf16 v[104:107], a[160:161], v[98:99], v[104:107]
  v_mfma_f32_4x4x4_16b_bf16 v[108:111], a[164:165], v[96:97], v[108:111]
  v_mfma_f32_4x4x4_16b_bf16 v[116:119], a[164:165], v[98:99], v[116:119]
  s_waitcnt vmcnt(4)
  v_cmp_eq_u64_e64 s[94:95], v[246:247], s[74:75]
  s_nop 0
s_and_b32 s82, s36, s94
  s_cbranch_scc1 Lslow8
Lret8:
  s_mov_b32 s83, 0
  s_xor_b32 s82, s84, 2
  s_lshl_b32 s82, s82, 1
  s_lshl_b32 s82, 3, s82
  s_or_b32 s83, s83, s82
  s_andn2_b32 s83, s83, s94
  s_or_b32 s36, s36, s83
  s_xor_b32 s82, s98, 0x1800000
  s_cmp_eq_u32 s83, 0
  s_cselect_b32 s82, s82, 0x7ffffff0
  buffer_load_dwordx4 a[80:83], v251, s[32:35], s82 offen sc1
  buffer_load_dwordx4 a[84:87], v251, s[32:35], s82 offen offset:1024 sc1
  buffer_load_dwordx4 a[88:91], v251, s[32:35], s82 offen offset:2048 sc1
  buffer_load_dwordx4 a[92:95], v251, s[32:35], s82 offen offset:3072 sc1
s_cmp_lg_u32 s36, 0
  s_cbranch_scc1 Lslow9
Lret9:
  v_mfma_f32_16x16x32_bf16 v[120:123], a[252:255], a[128:131], 0
  v_mfma_f32_16x16x32_bf16 v[120:123], a[252:255], a[132:135], v[120:123]
  v_mfma_f32_16x16x32_bf16 v[120:123], a[252:255], a[136:139], v[120:123]
  v_mfma_f32_16x16x32_bf16 v[120:123], a[252:255], a[140:143], v[120:123]
  v_mfma_f32_16x16x32_bf16 v[100:103], a[176:179], a[0:3], v[100:103]
  v_mfma_f32_16x16x32_bf16 v[108:111], a[180:183], a[0:3], v[108:111]
  v_mfma_f32_16x16x32_bf16 v[104:107], a[176:179], a[4:7], v[104:107]
  v_mfma_f32_16x16x32_bf16 v[116:119], a[180:183], a[4:7], v[116:119]
  v_mfma_f32_16x16x32_bf16 v[100:103], a[176:179], a[8:11], v[100:103]
  v_mfma_f32_16x16x32_bf16 v[108:111], a[180:183], a[8:11], v[108:111]
  v_mfma_f32_16x16x32_bf16 v[104:107], a[176:179], a[12:15], v[104:107]
  v_mfma_f32_16x16x32_bf16 v[116:119], a[180:183], a[12:15], v[116:119]
  v_mfma_f32_16x16x32_bf16 v[100:103], a[176:179], a[16:19], v[100:103]
  v_mfma_f32_16x16x32_bf16 v[108:111], a[180:183], a[16:19], v[108:111]
  v_mfma_f32_16x16x32_bf16 v[104:107], a[176:179], a[20:23], v[104:107]
  v_mfma_f32_16x16x32_bf16 v[116:119], a[180:183], a[20:23], v[116:119]
  v_mfma_f32_16x16x32_bf16 v[100:103], a[176:179], a[24:27], v[100:103]
  v_mfma_f32_16x16x32_bf16 v[108:111], a[180:183], a[24:27], v[108:111]
  v_mfma_f32_16x16x32_bf16 v[104:107], a[176:179], a[28:31], v[104:107]
  v_mfma_f32_16x16x32_bf16 v[116:119], a[180:183], a[28:31], v[116:119]
  v_fma_f32 v120, v120, v174, v164
  v_fma_f32 v121, v121, v174, v165
  v_fma_f32 v122, v122, v174, v166
  v_fma_f32 v123, v123, v174, v167
  v_cvt_pk_bf16_f32 v120, v120, v121
  v_cvt_pk_bf16_f32 v121, v122, v123
  buffer_store_dwordx2 v[120:121], v255, s[28:31], s85 offen
  v_mfma_f32_16x16x32_bf16 v[100:103], a[176:179], a[32:35], v[100:103]
  v_mfma_f32_16x16x32_bf16 v[108:111], a[180:183], a[32:35], v[108:111]
  v_mfma_f32_16x16x32_bf16 v[104:107], a[176:179], a[36:39], v[104:107]
  v_mfma_f32_16x16x32_bf16 v[116:119], a[180:183], a[36:39], v[116:119]
  v_mfma_f32_16x16x32_bf16 v[100:103], a[176:179], a[40:43], v[100:103]
  v_mfma_f32_16x16x32_bf16 v[108:111], a[180:183], a[40:43], v[108:111]
  v_mfma_f32_16x16x32_bf16 v[104:107], a[176:179], a[44:47], v[104:107]
  v_mfma_f32_16x16x32_bf16 v[116:119], a[180:183], a[44:47], v[116:119]
  v_mfma_f32_16x16x32_bf16 v[100:103], a[176:179], a[48:51], v[100:103]
  v_mfma_f32_16x16x32_bf16 v[108:111], a[180:183], a[48:51], v[108:111]
  v_mfma_f32_16x16x32_bf16 v[104:107], a[176:179], a[52:55], v[104:107]
  v_mfma_f32_16x16x32_bf16 v[116:119], a[180:183], a[52:55], v[116:119]
  v_mfma_f32_16x16x32_bf16 v[100:103], a[176:179], a[56:59], v[100:103]
  v_mfma_f32_16x16x32_bf16 v[108:111], a[180:183], a[56:59], v[108:111]
  v_mfma_f32_16x16x32_bf16 v[104:107], a[176:179], a[60:63], v[104:107]
  v_mfma_f32_16x16x32_bf16 v[116:119], a[180:183], a[60:63], v[116:119]
  s_xor_b32 s82, s98, 0x1c00000
  buffer_load_dwordx4 a[96:99], v251, s[32:35], s82 offen sc1
  buffer_load_dwordx4 a[100:103], v251, s[32:35], s82 offen offset:1024 sc1
  buffer_load_dwordx4 a[104:107], v251, s[32:35], s82 offen offset:2048 sc1
  buffer_load_dwordx4 a[108:111], v251, s[32:35], s82 offen offset:3072 sc1
  v_mfma_f32_16x16x32_bf16 v[100:103], a[176:179], a[64:67], v[100:103]
  v_mfma_f32_16x16x32_bf16 v[108:111], a[180:183], a[64:67], v[108:111]
  v_mfma_f32_16x16x32_bf16 v[104:107], a[176:179], a[68:71], v[104:107]
  v_mfma_f32_16x16x32_bf16 v[116:119], a[180:183], a[68:71], v[116:119]
  v_mfma_f32_16x16x32_bf16 v[100:103], a[176:179], a[72:75], v[100:103]
  v_mfma_f32_16x16x32_bf16 v[108:111], a[180:183], a[72:75], v[108:111]
  v_mfma_f32_16x16x32_bf16 v[104:107], a[176:179], a[76:79], v[104:107]
  v_mfma_f32_16x16x32_bf16 v[116:119], a[180:183], a[76:79], v[116:119]
  s_waitcnt vmcnt(10)
  v_mfma_f32_16x16x32_bf16 v[80:83], a[176:179], a[112:115], v[100:103]
  v_mfma_f32_16x16x32_bf16 v[88:91], a[180:183], a[112:115], v[108:111]
  s_waitcnt vmcnt(9)
  v_mfma_f32_16x16x32_bf16 v[84:87], a[176:179], a[116:119], v[104:107]
  v_mfma_f32_16x16x32_bf16 v[92:95], a[180:183], a[116:119], v[116:119]
  s_nop 6
  v_cmp_u_f32_e64 s[94:95], v80, v84
  s_nop 0
s_cmp_lg_u64 s[94:95], 0
  s_cbranch_scc1 Lslow10
Lret10:
  s_waitcnt vmcnt(8)
  v_mfma_f32_16x16x32_bf16 v[80:83], a[176:179], a[80:83], v[80:83]
  v_mfma_f32_16x16x32_bf16 v[88:91], a[180:183], a[80:83], v[88:91]
  s_waitcnt vmcnt(7)
  v_mfma_f32_16x16x32_bf16 v[84:87], a[176:179], a[84:87], v[84:87]
  v_mfma_f32_16x16x32_bf16 v[92:95], a[180:183], a[84:87], v[92:95]
  s_waitcnt vmcnt(6)
  v_mfma_f32_16x16x32_bf16 v[80:83], a[176:179], a[88:91], v[80:83]
  v_mfma_f32_16x16x32_bf16 v[88:91], a[180:183], a[88:91], v[88:91]
  s_waitcnt vmcnt(5)
  v_mfma_f32_16x16x32_bf16 v[84:87], a[176:179], a[92:95], v[84:87]
  v_mfma_f32_16x16x32_bf16 v[92:95], a[180:183], a[92:95], v[92:95]
  s_waitcnt vmcnt(3)
  v_mfma_f32_16x16x32_bf16 v[100:103], a[176:179], a[96:99], v[80:83]
  v_mfma_f32_16x16x32_bf16 v[108:111], a[180:183], a[96:99], v[88:91]
  s_waitcnt vmcnt(2)
  v_mfma_f32_16x16x32_bf16 v[104:107], a[176:179], a[100:103], v[84:87]
  v_mfma_f32_16x16x32_bf16 v[116:119], a[180:183], a[100:103], v[92:95]
  s_waitcnt vmcnt(1)
  v_mfma_f32_16x16x32_bf16 v[100:103], a[176:179], a[104:107], v[100:103]
  v_mfma_f32_16x16x32_bf16 v[108:111], a[180:183], a[104:107], v[108:111]
  s_waitcnt vmcnt(0)
  v_mfma_f32_16x16x32_bf16 v[104:107], a[176:179], a[108:111], v[104:107]
  v_mfma_f32_16x16x32_bf16 v[116:119], a[180:183], a[108:111], v[116:119]
  s_nop 6
  v_cmp_u_f32_e64 s[94:95], v100, v104
  s_nop 0
s_cmp_lg_u64 s[94:95], 0
  s_cbranch_scc1 Lslow11
Lret11:
  v_pk_fma_f32 v[100:101], v[100:101], v[172:173], v[52:53] op_sel:[0,0,0] op_sel_hi:[1,0,1]
  v_pk_fma_f32 v[102:103], v[102:103], v[172:173], v[54:55] op_sel:[0,0,0] op_sel_hi:[1,0,1]
  v_pk_fma_f32 v[108:109], v[108:109], v[172:173], v[60:61] op_sel:[0,0,0] op_sel_hi:[1,0,1]
  v_pk_fma_f32 v[110:111], v[110:111], v[172:173], v[62:63] op_sel:[0,0,0] op_sel_hi:[1,0,1]
  v_cvt_pk_bf16_f32 v100, v100, v101
  v_cvt_pk_bf16_f32 v101, v102, v103
  v_cvt_pk_bf16_f32 v102, v108, v109
  v_cvt_pk_bf16_f32 v103, v110, v111
  buffer_store_dwordx2 v[100:101], v254, s[28:31], s86 offen
  buffer_store_dwordx2 v[102:103], v254, s[28:31], s86 offen offset:32
  v_pk_fma_f32 v[104:105], v[104:105], v[172:173], v[56:57] op_sel:[0,1,0] op_sel_hi:[1,1,1]
  v_pk_fma_f32 v[106:107], v[106:107], v[172:173], v[58:59] op_sel:[0,1,0] op_sel_hi:[1,1,1]
  v_pk_fma_f32 v[116:117], v[116:117], v[172:173], v[64:65] op_sel:[0,1,0] op_sel_hi:[1,1,1]
  v_pk_fma_f32 v[118:119], v[118:119], v[172:173], v[66:67] op_sel:[0,1,0] op_sel_hi:[1,1,1]
  v_cvt_pk_bf16_f32 v104, v104, v105
  v_cvt_pk_bf16_f32 v105, v106, v107
  v_cvt_pk_bf16_f32 v106, v116, v117
  v_cvt_pk_bf16_f32 v107, v118, v119
  s_add_u32 s82, s86, s78
  buffer_store_dwordx2 v[104:105], v254, s[28:31], s82 offen
  buffer_store_dwordx2 v[106:107], v254, s[28:31], s82 offen offset:32
  v_accvgpr_read_b32 v239, a190
  s_add_u32 s7, s2, s3
  s_cmp_eq_u32 s7, 0
  s_cselect_b32 s7, 0, 0x7ffffff0
  v_mov_b32_e32 v240, s99
  buffer_store_dword v240, v239, s[32:35], s7 offen sc1
L_end:
  s_endpgm
Lslow0:
  s_cmp_eq_u32 s88, 0
  s_cbranch_scc1 Lret0
  s_sub_u32 s88, s88, 1
  buffer_load_dwordx2 v[246:247], v239, s[32:35], s100 offen sc1
  s_waitcnt vmcnt(0)
  v_cmp_eq_u64_e64 s[94:95], v[246:247], s[74:75]
  s_nop 1
  s_cmp_lg_u64 s[94:95], -1
  s_cbranch_scc1 Lslow0
  s_branch Lret0
Lslow1:
  s_cmp_eq_u32 s88, 0
  s_cbranch_scc1 Lret1
  s_sub_u32 s88, s88, 1
  s_nop 7
  s_nop 7
  buffer_load_dwordx4 v[108:111], v239, s[32:35], s101 offen sc1
  buffer_load_dwordx4 v[124:127], v239, s[32:35], s100 offen sc1
  s_waitcnt vmcnt(0)
  v_add_f32_e32 v108, v124, v108
  v_add_f32_e32 v109, v125, v109
  v_add_f32_e32 v110, v126, v110
  v_add_f32_e64 v111, v127, v111
  v_cmp_u_f32_e64 s[94:95], v108, v109
  v_cmp_u_f32_e64 vcc, v110, v111
  s_nop 0
  s_or_b64 s[94:95], s[94:95], vcc
  s_waitcnt vmcnt(0)
  s_nop 7
  s_cbranch_scc1 Lslow1
  s_branch Lret1
Lslow2:
  s_cmp_eq_u32 s88, 0
  s_cbranch_scc1 Lret2
  s_sub_u32 s88, s88, 1
  s_nop 7
  s_nop 7
  buffer_load_dwordx4 v[124:127], v241, s[32:35], s101 offen sc1
  s_waitcnt vmcnt(0)
  v_max3_u32 v108, v124, v125, v126
  v_max_u32_e32 v108, v108, v127
  v_cmp_eq_u32_e64 s[94:95], -1, v108
  s_nop 0
  s_cmp_lg_u64 s[94:95], 0
  s_waitcnt vmcnt(0)
  s_nop 7
  s_cbranch_scc1 Lslow2
  s_branch Lret2
Lslow3:
  s_mov_b32 s83, 0xffff0000
  s_and_b32 s83, s83, s36
  s_cbranch_scc0 Lsk3_0
  s_andn2_b32 s82, s83, s94
  s_cbranch_scc1 Lsk3_0
  s_andn2_b32 s36, s36, s83
  buffer_load_dwordx4 a[128:131], v251, s[32:35], s98 offen sc1
  buffer_load_dwordx4 a[132:135], v251, s[32:35], s98 offen offset:1024 sc1
  buffer_load_dwordx4 a[136:139], v251, s[32:35], s98 offen offset:2048 sc1
  buffer_load_dwordx4 a[140:143], v251, s[32:35], s98 offen offset:3072 sc1
Lsk3_0:
  s_mov_b32 s83, 0
  s_xor_b32 s82, s84, 1
  s_lshl_b32 s82, s82, 1
  s_lshl_b32 s82, 3, s82
  s_or_b32 s83, s83, s82
  s_and_b32 s83, s83, s36
  s_cbranch_scc0 Lsk3_7
  s_andn2_b32 s82, s83, s94
  s_cbranch_scc1 Lsk3_7
  s_andn2_b32 s36, s36, s83
  s_xor_b32 s82, s98, 0x1c00000
  buffer_load_dwordx4 a[96:99], v251, s[32:35], s82 offen sc1
  buffer_load_dwordx4 a[100:103], v251, s[32:35], s82 offen offset:1024 sc1
  buffer_load_dwordx4 a[104:107], v251, s[32:35], s82 offen offset:2048 sc1
  buffer_load_dwordx4 a[108:111], v251, s[32:35], s82 offen offset:3072 sc1
Lsk3_7:
  s_mov_b32 s83, 0
  s_xor_b32 s82, s4, 1
  s_bitset1_b32 s83, s82
  s_and_b32 s83, s83, s36
  s_cbranch_scc0 Lsk3_8
  s_andn2_b32 s82, s83, s94
  s_cbranch_scc1 Lsk3_8
  s_andn2_b32 s36, s36, s83
  s_xor_b32 s82, s96, 0x2004800
  buffer_load_dwordx4 a[112:115], v251, s[32:35], s82 offen sc1
  buffer_load_dwordx4 a[116:119], v251, s[32:35], s82 offen offset:1024 sc1
Lsk3_8:
  s_branch Lret3
Lslow4:
  s_mov_b32 s83, 0xffff0000
  s_and_b32 s83, s83, s36
  s_cbranch_scc0 Lsk4_0
  s_andn2_b32 s82, s83, s94
  s_cbranch_scc1 Lsk4_0
  s_andn2_b32 s36, s36, s83
  buffer_load_dwordx4 a[128:131], v251, s[32:35], s98 offen sc1
  buffer_load_dwordx4 a[132:135], v251, s[32:35], s98 offen offset:1024 sc1
  buffer_load_dwordx4 a[136:139], v251, s[32:35], s98 offen offset:2048 sc1
  buffer_load_dwordx4 a[140:143], v251, s[32:35], s98 offen offset:3072 sc1
Lsk4_0:
  s_mov_b32 s83, 0
  s_xor_b32 s82, s84, 1
  s_lshl_b32 s82, s82, 1
  s_lshl_b32 s82, 3, s82
  s_or_b32 s83, s83, s82
  s_and_b32 s83, s83, s36
  s_cbranch_scc0 Lsk4_7
  s_andn2_b32 s82, s83, s94
  s_cbranch_scc1 Lsk4_7
  s_andn2_b32 s36, s36, s83
  s_xor_b32 s82, s98, 0x1c00000
  buffer_load_dwordx4 a[96:99], v251, s[32:35], s82 offen sc1
  buffer_load_dwordx4 a[100:103], v251, s[32:35], s82 offen offset:1024 sc1
  buffer_load_dwordx4 a[104:107], v251, s[32:35], s82 offen offset:2048 sc1
  buffer_load_dwordx4 a[108:111], v251, s[32:35], s82 offen offset:3072 sc1
Lsk4_7:
  s_mov_b32 s83, 0
  s_xor_b32 s82, s4, 1
  s_bitset1_b32 s83, s82
  s_and_b32 s83, s83, s36
  s_cbranch_scc0 Lsk4_8
  s_andn2_b32 s82, s83, s94
  s_cbranch_scc1 Lsk4_8
  s_andn2_b32 s36, s36, s83
  s_xor_b32 s82, s96, 0x2004800
  buffer_load_dwordx4 a[112:115], v251, s[32:35], s82 offen sc1
  buffer_load_dwordx4 a[116:119], v251, s[32:35], s82 offen offset:1024 sc1
Lsk4_8:
  s_mov_b32 s83, 0
  s_xor_b32 s82, s84, 7
  s_lshl_b32 s82, s82, 1
  s_lshl_b32 s82, 3, s82
  s_or_b32 s83, s83, s82
  s_and_b32 s83, s83, s36
  s_cbranch_scc0 Lsk4_1
  s_andn2_b32 s82, s83, s94
  s_cbranch_scc1 Lsk4_1
  s_andn2_b32 s36, s36, s83
  s_xor_b32 s82, s98, 0x400000
  buffer_load_dwordx4 a[0:3], v251, s[32:35], s82 offen sc1
  buffer_load_dwordx4 a[4:7], v251, s[32:35], s82 offen offset:1024 sc1
  buffer_load_dwordx4 a[8:11], v251, s[32:35], s82 offen offset:2048 sc1
  buffer_load_dwordx4 a[12:15], v251, s[32:35], s82 offen offset:3072 sc1
Lsk4_1:
  s_branch Lret4
Lslow5:
  s_mov_b32 s83, 0xffff0000
  s_and_b32 s83, s83, s36
  s_cbranch_scc0 Lsk5_0
  s_andn2_b32 s82, s83, s94
  s_cbranch_scc1 Lsk5_0
  s_andn2_b32 s36, s36, s83
  buffer_load_dwordx4 a[128:131], v251, s[32:35], s98 offen sc1
  buffer_load_dwordx4 a[132:135], v251, s[32:35], s98 offen offset:1024 sc1
  buffer_load_dwordx4 a[136:139], v251, s[32:35], s98 offen offset:2048 sc1
  buffer_load_dwordx4 a[140:143], v251, s[32:35], s98 offen offset:3072 sc1
Lsk5_0:
  s_mov_b32 s83, 0
  s_xor_b32 s82, s84, 1
  s_lshl_b32 s82, s82, 1
  s_lshl_b32 s82, 3, s82
  s_or_b32 s83, s83, s82
  s_and_b32 s83, s83, s36
  s_cbranch_scc0 Lsk5_7
  s_andn2_b32 s82, s83, s94
  s_cbranch_scc1 Lsk5_7
  s_andn2_b32 s36, s36, s83
  s_xor_b32 s82, s98, 0x1c00000
  buffer_load_dwordx4 a[96:99], v251, s[32:35], s82 offen sc1
  buffer_load_dwordx4 a[100:103], v251, s[32:35], s82 offen offset:1024 sc1
  buffer_load_dwordx4 a[104:107], v251, s[32:35], s82 offen offset:2048 sc1
  buffer_load_dwordx4 a[108:111], v251, s[32:35], s82 offen offset:3072 sc1
Lsk5_7:
  s_mov_b32 s83, 0
  s_xor_b32 s82, s4, 1
  s_bitset1_b32 s83, s82
  s_and_b32 s83, s83, s36
  s_cbranch_scc0 Lsk5_8
  s_andn2_b32 s82, s83, s94
  s_cbranch_scc1 Lsk5_8
  s_andn2_b32 s36, s36, s83
  s_xor_b32 s82, s96, 0x2004800
  buffer_load_dwordx4 a[112:115], v251, s[32:35], s82 offen sc1
  buffer_load_dwordx4 a[116:119], v251, s[32:35], s82 offen offset:1024 sc1
Lsk5_8:
  s_mov_b32 s83, 0
  s_xor_b32 s82, s84, 7
  s_lshl_b32 s82, s82, 1
  s_lshl_b32 s82, 3, s82
  s_or_b32 s83, s83, s82
  s_and_b32 s83, s83, s36
  s_cbranch_scc0 Lsk5_1
  s_andn2_b32 s82, s83, s94
  s_cbranch_scc1 Lsk5_1
  s_andn2_b32 s36, s36, s83
  s_xor_b32 s82, s98, 0x400000
  buffer_load_dwordx4 a[0:3], v251, s[32:35], s82 offen sc1
  buffer_load_dwordx4 a[4:7], v251, s[32:35], s82 offen offset:1024 sc1
  buffer_load_dwordx4 a[8:11], v251, s[32:35], s82 offen offset:2048 sc1
  buffer_load_dwordx4 a[12:15], v251, s[32:35], s82 offen offset:3072 sc1
Lsk5_1:
  s_mov_b32 s83, 0
  s_xor_b32 s82, s84, 6
  s_lshl_b32 s82, s82, 1
  s_lshl_b32 s82, 3, s82
  s_or_b32 s83, s83, s82
  s_and_b32 s83, s83, s36
  s_cbranch_scc0 Lsk5_2
  s_andn2_b32 s82, s83, s94
  s_cbranch_scc1 Lsk5_2
  s_andn2_b32 s36, s36, s83
  s_xor_b32 s82, s98, 0x800000
  buffer_load_dwordx4 a[16:19], v251, s[32:35], s82 offen sc1
  buffer_load_dwordx4 a[20:23], v251, s[32:35], s82 offen offset:1024 sc1
  buffer_load_dwordx4 a[24:27], v251, s[32:35], s82 offen offset:2048 sc1
  buffer_load_dwordx4 a[28:31], v251, s[32:35], s82 offen offset:3072 sc1
Lsk5_2:
  s_branch Lret5
Lslow6:
  s_mov_b32 s83, 0xffff0000
  s_and_b32 s83, s83, s36
  s_cbranch_scc0 Lsk6_0
  s_andn2_b32 s82, s83, s94
  s_cbranch_scc1 Lsk6_0
  s_andn2_b32 s36, s36, s83
  buffer_load_dwordx4 a[128:131], v251, s[32:35], s98 offen sc1
  buffer_load_dwordx4 a[132:135], v251, s[32:35], s98 offen offset:1024 sc1
  buffer_load_dwordx4 a[136:139], v251, s[32:35], s98 offen offset:2048 sc1
  buffer_load_dwordx4 a[140:143], v251, s[32:35], s98 offen offset:3072 sc1
Lsk6_0:
  s_mov_b32 s83, 0
  s_xor_b32 s82, s84, 1
  s_lshl_b32 s82, s82, 1
  s_lshl_b32 s82, 3, s82
  s_or_b32 s83, s83, s82
  s_and_b32 s83, s83, s36
  s_cbranch_scc0 Lsk6_7
  s_andn2_b32 s82, s83, s94
  s_cbranch_scc1 Lsk6_7
  s_andn2_b32 s36, s36, s83
  s_xor_b32 s82, s98, 0x1c00000
  buffer_load_dwordx4 a[96:99], v251, s[32:35], s82 offen sc1
  buffer_load_dwordx4 a[100:103], v251, s[32:35], s82 offen offset:1024 sc1
  buffer_load_dwordx4 a[104:107], v251, s[32:35], s82 offen offset:2048 sc1
  buffer_load_dwordx4 a[108:111], v251, s[32:35], s82 offen offset:3072 sc1
Lsk6_7:
  s_mov_b32 s83, 0
  s_xor_b32 s82, s4, 1
  s_bitset1_b32 s83, s82
  s_and_b32 s83, s83, s36
  s_cbranch_scc0 Lsk6_8
  s_andn2_b32 s82, s83, s94
  s_cbranch_scc1 Lsk6_8
  s_andn2_b32 s36, s36, s83
  s_xor_b32 s82, s96, 0x2004800
  buffer_load_dwordx4 a[112:115], v251, s[32:35], s82 offen sc1
  buffer_load_dwordx4 a[116:119], v251, s[32:35], s82 offen offset:1024 sc1
Lsk6_8:
  s_mov_b32 s83, 0
  s_xor_b32 s82, s84, 7
  s_lshl_b32 s82, s82, 1
  s_lshl_b32 s82, 3, s82
  s_or_b32 s83, s83, s82
  s_and_b32 s83, s83, s36
  s_cbranch_scc0 Lsk6_1
  s_andn2_b32 s82, s83, s94
  s_cbranch_scc1 Lsk6_1
  s_andn2_b32 s36, s36, s83
  s_xor_b32 s82, s98, 0x400000
  buffer_load_dwordx4 a[0:3], v251, s[32:35], s82 offen sc1
  buffer_load_dwordx4 a[4:7], v251, s[32:35], s82 offen offset:1024 sc1
  buffer_load_dwordx4 a[8:11], v251, s[32:35], s82 offen offset:2048 sc1
  buffer_load_dwordx4 a[12:15], v251, s[32:35], s82 offen offset:3072 sc1
Lsk6_1:
  s_mov_b32 s83, 0
  s_xor_b32 s82, s84, 6
  s_lshl_b32 s82, s82, 1
  s_lshl_b32 s82, 3, s82
  s_or_b32 s83, s83, s82
  s_and_b32 s83, s83, s36
  s_cbranch_scc0 Lsk6_2
  s_andn2_b32 s82, s83, s94
  s_cbranch_scc1 Lsk6_2
  s_andn2_b32 s36, s36, s83
  s_xor_b32 s82, s98, 0x800000
  buffer_load_dwordx4 a[16:19], v251, s[32:35], s82 offen sc1
  buffer_load_dwordx4 a[20:23], v251, s[32:35], s82 offen offset:1024 sc1
  buffer_load_dwordx4 a[24:27], v251, s[32:35], s82 offen offset:2048 sc1
  buffer_load_dwordx4 a[28:31], v251, s[32:35], s82 offen offset:3072 sc1
Lsk6_2:
  s_mov_b32 s83, 0
  s_xor_b32 s82, s84, 5
  s_lshl_b32 s82, s82, 1
  s_lshl_b32 s82, 3, s82
  s_or_b32 s83, s83, s82
  s_and_b32 s83, s83, s36
  s_cbranch_scc0 Lsk6_3
  s_andn2_b32 s82, s83, s94
  s_cbranch_scc1 Lsk6_3
  s_andn2_b32 s36, s36, s83
  s_xor_b32 s82, s98, 0xc00000
  buffer_load_dwordx4 a[32:35], v251, s[32:35], s82 offen sc1
  buffer_load_dwordx4 a[36:39], v251, s[32:35], s82 offen offset:1024 sc1
  buffer_load_dwordx4 a[40:43], v251, s[32:35], s82 offen offset:2048 sc1
  buffer_load_dwordx4 a[44:47], v251, s[32:35], s82 offen offset:3072 sc1
Lsk6_3:
  s_branch Lret6
Lslow7:
  s_mov_b32 s83, 0xffff0000
  s_and_b32 s83, s83, s36
  s_cbranch_scc0 Lsk7_0
  s_andn2_b32 s82, s83, s94
  s_cbranch_scc1 Lsk7_0
  s_andn2_b32 s36, s36, s83
  buffer_load_dwordx4 a[128:131], v251, s[32:35], s98 offen sc1
  buffer_load_dwordx4 a[132:135], v251, s[32:35], s98 offen offset:1024 sc1
  buffer_load_dwordx4 a[136:139], v251, s[32:35], s98 offen offset:2048 sc1
  buffer_load_dwordx4 a[140:143], v251, s[32:35], s98 offen offset:3072 sc1
Lsk7_0:
  s_mov_b32 s83, 0
  s_xor_b32 s82, s84, 1
  s_lshl_b32 s82, s82, 1
  s_lshl_b32 s82, 3, s82
  s_or_b32 s83, s83, s82
  s_and_b32 s83, s83, s36
  s_cbranch_scc0 Lsk7_7
  s_andn2_b32 s82, s83, s94
  s_cbranch_scc1 Lsk7_7
  s_andn2_b32 s36, s36, s83
  s_xor_b32 s82, s98, 0x1c00000
  buffer_load_dwordx4 a[96:99], v251, s[32:35], s82 offen sc1
  buffer_load_dwordx4 a[100:103], v251, s[32:35], s82 offen offset:1024 sc1
  buffer_load_dwordx4 a[104:107], v251, s[32:35], s82 offen offset:2048 sc1
  buffer_load_dwordx4 a[108:111], v251, s[32:35], s82 offen offset:3072 sc1
Lsk7_7:
  s_mov_b32 s83, 0
  s_xor_b32 s82, s4, 1
  s_bitset1_b32 s83, s82
  s_and_b32 s83, s83, s36
  s_cbranch_scc0 Lsk7_8
  s_andn2_b32 s82, s83, s94
  s_cbranch_scc1 Lsk7_8
  s_andn2_b32 s36, s36, s83
  s_xor_b32 s82, s96, 0x2004800
  buffer_load_dwordx4 a[112:115], v251, s[32:35], s82 offen sc1
  buffer_load_dwordx4 a[116:119], v251, s[32:35], s82 offen offset:1024 sc1
Lsk7_8:
  s_mov_b32 s83, 0
  s_xor_b32 s82, s84, 7
  s_lshl_b32 s82, s82, 1
  s_lshl_b32 s82, 3, s82
  s_or_b32 s83, s83, s82
  s_and_b32 s83, s83, s36
  s_cbranch_scc0 Lsk7_1
  s_andn2_b32 s82, s83, s94
  s_cbranch_scc1 Lsk7_1
  s_andn2_b32 s36, s36, s83
  s_xor_b32 s82, s98, 0x400000
  buffer_load_dwordx4 a[0:3], v251, s[32:35], s82 offen sc1
  buffer_load_dwordx4 a[4:7], v251, s[32:35], s82 offen offset:1024 sc1
  buffer_load_dwordx4 a[8:11], v251, s[32:35], s82 offen offset:2048 sc1
  buffer_load_dwordx4 a[12:15], v251, s[32:35], s82 offen offset:3072 sc1
Lsk7_1:
  s_mov_b32 s83, 0
  s_xor_b32 s82, s84, 6
  s_lshl_b32 s82, s82, 1
  s_lshl_b32 s82, 3, s82
  s_or_b32 s83, s83, s82
  s_and_b32 s83, s83, s36
  s_cbranch_scc0 Lsk7_2
  s_andn2_b32 s82, s83, s94
  s_cbranch_scc1 Lsk7_2
  s_andn2_b32 s36, s36, s83
  s_xor_b32 s82, s98, 0x800000
  buffer_load_dwordx4 a[16:19], v251, s[32:35], s82 offen sc1
  buffer_load_dwordx4 a[20:23], v251, s[32:35], s82 offen offset:1024 sc1
  buffer_load_dwordx4 a[24:27], v251, s[32:35], s82 offen offset:2048 sc1
  buffer_load_dwordx4 a[28:31], v251, s[32:35], s82 offen offset:3072 sc1
Lsk7_2:
  s_mov_b32 s83, 0
  s_xor_b32 s82, s84, 5
  s_lshl_b32 s82, s82, 1
  s_lshl_b32 s82, 3, s82
  s_or_b32 s83, s83, s82
  s_and_b32 s83, s83, s36
  s_cbranch_scc0 Lsk7_3
  s_andn2_b32 s82, s83, s94
  s_cbranch_scc1 Lsk7_3
  s_andn2_b32 s36, s36, s83
  s_xor_b32 s82, s98, 0xc00000
  buffer_load_dwordx4 a[32:35], v251, s[32:35], s82 offen sc1
  buffer_load_dwordx4 a[36:39], v251, s[32:35], s82 offen offset:1024 sc1
  buffer_load_dwordx4 a[40:43], v251, s[32:35], s82 offen offset:2048 sc1
  buffer_load_dwordx4 a[44:47], v251, s[32:35], s82 offen offset:3072 sc1
Lsk7_3:
  s_mov_b32 s83, 0
  s_xor_b32 s82, s84, 4
  s_lshl_b32 s82, s82, 1
  s_lshl_b32 s82, 3, s82
  s_or_b32 s83, s83, s82
  s_and_b32 s83, s83, s36
  s_cbranch_scc0 Lsk7_4
  s_andn2_b32 s82, s83, s94
  s_cbranch_scc1 Lsk7_4
  s_andn2_b32 s36, s36, s83
  s_xor_b32 s82, s98, 0x1000000
  buffer_load_dwordx4 a[48:51], v251, s[32:35], s82 offen sc1
  buffer_load_dwordx4 a[52:55], v251, s[32:35], s82 offen offset:1024 sc1
  buffer_load_dwordx4 a[56:59], v251, s[32:35], s82 offen offset:2048 sc1
  buffer_load_dwordx4 a[60:63], v251, s[32:35], s82 offen offset:3072 sc1
Lsk7_4:
  s_branch Lret7
Lslow8:
  s_mov_b32 s83, 0xffff0000
  s_and_b32 s83, s83, s36
  s_cbranch_scc0 Lsk8_0
  s_andn2_b32 s82, s83, s94
  s_cbranch_scc1 Lsk8_0
  s_andn2_b32 s36, s36, s83
  buffer_load_dwordx4 a[128:131], v251, s[32:35], s98 offen sc1
  buffer_load_dwordx4 a[132:135], v251, s[32:35], s98 offen offset:1024 sc1
  buffer_load_dwordx4 a[136:139], v251, s[32:35], s98 offen offset:2048 sc1
  buffer_load_dwordx4 a[140:143], v251, s[32:35], s98 offen offset:3072 sc1
Lsk8_0:
  s_mov_b32 s83, 0
  s_xor_b32 s82, s84, 1
  s_lshl_b32 s82, s82, 1
  s_lshl_b32 s82, 3, s82
  s_or_b32 s83, s83, s82
  s_and_b32 s83, s83, s36
  s_cbranch_scc0 Lsk8_7
  s_andn2_b32 s82, s83, s94
  s_cbranch_scc1 Lsk8_7
  s_andn2_b32 s36, s36, s83
  s_xor_b32 s82, s98, 0x1c00000
  buffer_load_dwordx4 a[96:99], v251, s[32:35], s82 offen sc1
  buffer_load_dwordx4 a[100:103], v251, s[32:35], s82 offen offset:1024 sc1
  buffer_load_dwordx4 a[104:107], v251, s[32:35], s82 offen offset:2048 sc1
  buffer_load_dwordx4 a[108:111], v251, s[32:35], s82 offen offset:3072 sc1
Lsk8_7:
  s_mov_b32 s83, 0
  s_xor_b32 s82, s4, 1
  s_bitset1_b32 s83, s82
  s_and_b32 s83, s83, s36
  s_cbranch_scc0 Lsk8_8
  s_andn2_b32 s82, s83, s94
  s_cbranch_scc1 Lsk8_8
  s_andn2_b32 s36, s36, s83
  s_xor_b32 s82, s96, 0x2004800
  buffer_load_dwordx4 a[112:115], v251, s[32:35], s82 offen sc1
  buffer_load_dwordx4 a[116:119], v251, s[32:35], s82 offen offset:1024 sc1
Lsk8_8:
  s_mov_b32 s83, 0
  s_xor_b32 s82, s84, 7
  s_lshl_b32 s82, s82, 1
  s_lshl_b32 s82, 3, s82
  s_or_b32 s83, s83, s82
  s_and_b32 s83, s83, s36
  s_cbranch_scc0 Lsk8_1
  s_andn2_b32 s82, s83, s94
  s_cbranch_scc1 Lsk8_1
  s_andn2_b32 s36, s36, s83
  s_xor_b32 s82, s98, 0x400000
  buffer_load_dwordx4 a[0:3], v251, s[32:35], s82 offen sc1
  buffer_load_dwordx4 a[4:7], v251, s[32:35], s82 offen offset:1024 sc1
  buffer_load_dwordx4 a[8:11], v251, s[32:35], s82 offen offset:2048 sc1
  buffer_load_dwordx4 a[12:15], v251, s[32:35], s82 offen offset:3072 sc1
Lsk8_1:
  s_mov_b32 s83, 0
  s_xor_b32 s82, s84, 6
  s_lshl_b32 s82, s82, 1
  s_lshl_b32 s82, 3, s82
  s_or_b32 s83, s83, s82
  s_and_b32 s83, s83, s36
  s_cbranch_scc0 Lsk8_2
  s_andn2_b32 s82, s83, s94
  s_cbranch_scc1 Lsk8_2
  s_andn2_b32 s36, s36, s83
  s_xor_b32 s82, s98, 0x800000
  buffer_load_dwordx4 a[16:19], v251, s[32:35], s82 offen sc1
  buffer_load_dwordx4 a[20:23], v251, s[32:35], s82 offen offset:1024 sc1
  buffer_load_dwordx4 a[24:27], v251, s[32:35], s82 offen offset:2048 sc1
  buffer_load_dwordx4 a[28:31], v251, s[32:35], s82 offen offset:3072 sc1
Lsk8_2:
  s_mov_b32 s83, 0
  s_xor_b32 s82, s84, 5
  s_lshl_b32 s82, s82, 1
  s_lshl_b32 s82, 3, s82
  s_or_b32 s83, s83, s82
  s_and_b32 s83, s83, s36
  s_cbranch_scc0 Lsk8_3
  s_andn2_b32 s82, s83, s94
  s_cbranch_scc1 Lsk8_3
  s_andn2_b32 s36, s36, s83
  s_xor_b32 s82, s98, 0xc00000
  buffer_load_dwordx4 a[32:35], v251, s[32:35], s82 offen sc1
  buffer_load_dwordx4 a[36:39], v251, s[32:35], s82 offen offset:1024 sc1
  buffer_load_dwordx4 a[40:43], v251, s[32:35], s82 offen offset:2048 sc1
  buffer_load_dwordx4 a[44:47], v251, s[32:35], s82 offen offset:3072 sc1
Lsk8_3:
  s_mov_b32 s83, 0
  s_xor_b32 s82, s84, 4
  s_lshl_b32 s82, s82, 1
  s_lshl_b32 s82, 3, s82
  s_or_b32 s83, s83, s82
  s_and_b32 s83, s83, s36
  s_cbranch_scc0 Lsk8_4
  s_andn2_b32 s82, s83, s94
  s_cbranch_scc1 Lsk8_4
  s_andn2_b32 s36, s36, s83
  s_xor_b32 s82, s98, 0x1000000
  buffer_load_dwordx4 a[48:51], v251, s[32:35], s82 offen sc1
  buffer_load_dwordx4 a[52:55], v251, s[32:35], s82 offen offset:1024 sc1
  buffer_load_dwordx4 a[56:59], v251, s[32:35], s82 offen offset:2048 sc1
  buffer_load_dwordx4 a[60:63], v251, s[32:35], s82 offen offset:3072 sc1
Lsk8_4:
  s_mov_b32 s83, 0
  s_xor_b32 s82, s84, 3
  s_lshl_b32 s82, s82, 1
  s_lshl_b32 s82, 3, s82
  s_or_b32 s83, s83, s82
  s_and_b32 s83, s83, s36
  s_cbranch_scc0 Lsk8_5
  s_andn2_b32 s82, s83, s94
  s_cbranch_scc1 Lsk8_5
  s_andn2_b32 s36, s36, s83
  s_xor_b32 s82, s98, 0x1400000
  buffer_load_dwordx4 a[64:67], v251, s[32:35], s82 offen sc1
  buffer_load_dwordx4 a[68:71], v251, s[32:35], s82 offen offset:1024 sc1
  buffer_load_dwordx4 a[72:75], v251, s[32:35], s82 offen offset:2048 sc1
  buffer_load_dwordx4 a[76:79], v251, s[32:35], s82 offen offset:3072 sc1
Lsk8_5:
  s_waitcnt vmcnt(0)
  s_branch Lret8
Lslow9:
  s_cmp_eq_u32 s88, 0
  s_cbranch_scc1 Lret9
  s_sub_u32 s88, s88, 1
  buffer_load_dwordx2 v[246:247], v253, s[32:35], s71 offen sc1
  s_waitcnt vmcnt(0)
  v_cmp_eq_u64_e64 s[94:95], v[246:247], s[74:75]
  s_nop 1
  s_mov_b32 s83, 0xffff0000
  s_and_b32 s83, s83, s36
  s_cbranch_scc0 Lsk9_0
  s_andn2_b32 s82, s83, s94
  s_cbranch_scc1 Lsk9_0
  s_andn2_b32 s36, s36, s83
  buffer_load_dwordx4 a[128:131], v251, s[32:35], s98 offen sc1
  buffer_load_dwordx4 a[132:135], v251, s[32:35], s98 offen offset:1024 sc1
  buffer_load_dwordx4 a[136:139], v251, s[32:35], s98 offen offset:2048 sc1
  buffer_load_dwordx4 a[140:143], v251, s[32:35], s98 offen offset:3072 sc1
Lsk9_0:
  s_mov_b32 s83, 0
  s_xor_b32 s82, s4, 1
  s_bitset1_b32 s83, s82
  s_and_b32 s83, s83, s36
  s_cbranch_scc0 Lsk9_8
  s_andn2_b32 s82, s83, s94
  s_cbranch_scc1 Lsk9_8
  s_andn2_b32 s36, s36, s83
  s_xor_b32 s82, s96, 0x2004800
  buffer_load_dwordx4 a[112:115], v251, s[32:35], s82 offen sc1
  buffer_load_dwordx4 a[116:119], v251, s[32:35], s82 offen offset:1024 sc1
Lsk9_8:
  s_mov_b32 s83, 0
  s_xor_b32 s82, s84, 7
  s_lshl_b32 s82, s82, 1
  s_lshl_b32 s82, 3, s82
  s_or_b32 s83, s83, s82
  s_and_b32 s83, s83, s36
  s_cbranch_scc0 Lsk9_1
  s_andn2_b32 s82, s83, s94
  s_cbranch_scc1 Lsk9_1
  s_andn2_b32 s36, s36, s83
  s_xor_b32 s82, s98, 0x400000
  buffer_load_dwordx4 a[0:3], v251, s[32:35], s82 offen sc1
  buffer_load_dwordx4 a[4:7], v251, s[32:35], s82 offen offset:1024 sc1
  buffer_load_dwordx4 a[8:11], v251, s[32:35], s82 offen offset:2048 sc1
  buffer_load_dwordx4 a[12:15], v251, s[32:35], s82 offen offset:3072 sc1
Lsk9_1:
  s_mov_b32 s83, 0
  s_xor_b32 s82, s84, 6
  s_lshl_b32 s82, s82, 1
  s_lshl_b32 s82, 3, s82
  s_or_b32 s83, s83, s82
  s_and_b32 s83, s83, s36
  s_cbranch_scc0 Lsk9_2
  s_andn2_b32 s82, s83, s94
  s_cbranch_scc1 Lsk9_2
  s_andn2_b32 s36, s36, s83
  s_xor_b32 s82, s98, 0x800000
  buffer_load_dwordx4 a[16:19], v251, s[32:35], s82 offen sc1
  buffer_load_dwordx4 a[20:23], v251, s[32:35], s82 offen offset:1024 sc1
  buffer_load_dwordx4 a[24:27], v251, s[32:35], s82 offen offset:2048 sc1
  buffer_load_dwordx4 a[28:31], v251, s[32:35], s82 offen offset:3072 sc1
Lsk9_2:
  s_mov_b32 s83, 0
  s_xor_b32 s82, s84, 5
  s_lshl_b32 s82, s82, 1
  s_lshl_b32 s82, 3, s82
  s_or_b32 s83, s83, s82
  s_and_b32 s83, s83, s36
  s_cbranch_scc0 Lsk9_3
  s_andn2_b32 s82, s83, s94
  s_cbranch_scc1 Lsk9_3
  s_andn2_b32 s36, s36, s83
  s_xor_b32 s82, s98, 0xc00000
  buffer_load_dwordx4 a[32:35], v251, s[32:35], s82 offen sc1
  buffer_load_dwordx4 a[36:39], v251, s[32:35], s82 offen offset:1024 sc1
  buffer_load_dwordx4 a[40:43], v251, s[32:35], s82 offen offset:2048 sc1
  buffer_load_dwordx4 a[44:47], v251, s[32:35], s82 offen offset:3072 sc1
Lsk9_3:
  s_mov_b32 s83, 0
  s_xor_b32 s82, s84, 4
  s_lshl_b32 s82, s82, 1
  s_lshl_b32 s82, 3, s82
  s_or_b32 s83, s83, s82
  s_and_b32 s83, s83, s36
  s_cbranch_scc0 Lsk9_4
  s_andn2_b32 s82, s83, s94
  s_cbranch_scc1 Lsk9_4
  s_andn2_b32 s36, s36, s83
  s_xor_b32 s82, s98, 0x1000000
  buffer_load_dwordx4 a[48:51], v251, s[32:35], s82 offen sc1
  buffer_load_dwordx4 a[52:55], v251, s[32:35], s82 offen offset:1024 sc1
  buffer_load_dwordx4 a[56:59], v251, s[32:35], s82 offen offset:2048 sc1
  buffer_load_dwordx4 a[60:63], v251, s[32:35], s82 offen offset:3072 sc1
Lsk9_4:
  s_mov_b32 s83, 0
  s_xor_b32 s82, s84, 3
  s_lshl_b32 s82, s82, 1
  s_lshl_b32 s82, 3, s82
  s_or_b32 s83, s83, s82
  s_and_b32 s83, s83, s36
  s_cbranch_scc0 Lsk9_5
  s_andn2_b32 s82, s83, s94
  s_cbranch_scc1 Lsk9_5
  s_andn2_b32 s36, s36, s83
  s_xor_b32 s82, s98, 0x1400000
  buffer_load_dwordx4 a[64:67], v251, s[32:35], s82 offen sc1
  buffer_load_dwordx4 a[68:71], v251, s[32:35], s82 offen offset:1024 sc1
  buffer_load_dwordx4 a[72:75], v251, s[32:35], s82 offen offset:2048 sc1
  buffer_load_dwordx4 a[76:79], v251, s[32:35], s82 offen offset:3072 sc1
Lsk9_5:
  s_mov_b32 s83, 0
  s_xor_b32 s82, s84, 2
  s_lshl_b32 s82, s82, 1
  s_lshl_b32 s82, 3, s82
  s_or_b32 s83, s83, s82
  s_and_b32 s83, s83, s36
  s_cbranch_scc0 Lsk9_6
  s_andn2_b32 s82, s83, s94
  s_cbranch_scc1 Lsk9_6
  s_andn2_b32 s36, s36, s83
  s_xor_b32 s82, s98, 0x1800000
  buffer_load_dwordx4 a[80:83], v251, s[32:35], s82 offen sc1
  buffer_load_dwordx4 a[84:87], v251, s[32:35], s82 offen offset:1024 sc1
  buffer_load_dwordx4 a[88:91], v251, s[32:35], s82 offen offset:2048 sc1
  buffer_load_dwordx4 a[92:95], v251, s[32:35], s82 offen offset:3072 sc1
Lsk9_6:
  s_mov_b32 s83, 0
  s_xor_b32 s82, s84, 1
  s_lshl_b32 s82, s82, 1
  s_lshl_b32 s82, 3, s82
  s_or_b32 s83, s83, s82
  s_and_b32 s83, s83, s94
  s_andn2_b32 s36, s36, s83
  s_cbranch_scc1 Lslow9
  s_waitcnt vmcnt(0)
  s_branch Lret9
Lslow10:
  s_cmp_eq_u32 s88, 0
  s_cbranch_scc1 Lret10
  s_sub_u32 s88, s88, 1
  s_nop 7
  s_nop 7
  s_xor_b32 s82, s96, 0x2004800
  buffer_load_dwordx4 a[112:115], v251, s[32:35], s82 offen sc1
  buffer_load_dwordx4 a[116:119], v251, s[32:35], s82 offen offset:1024 sc1
  s_waitcnt vmcnt(1)
  v_mfma_f32_16x16x32_bf16 v[80:83], a[176:179], a[112:115], v[100:103]
  v_mfma_f32_16x16x32_bf16 v[88:91], a[180:183], a[112:115], v[108:111]
  s_waitcnt vmcnt(0)
  v_mfma_f32_16x16x32_bf16 v[84:87], a[176:179], a[116:119], v[104:107]
  v_mfma_f32_16x16x32_bf16 v[92:95], a[180:183], a[116:119], v[116:119]
  s_nop 6
  v_cmp_u_f32_e64 s[94:95], v80, v84
  s_nop 0
  s_cmp_lg_u64 s[94:95], 0
  s_waitcnt vmcnt(0)
  s_nop 7
  s_cbranch_scc1 Lslow10
  s_branch Lret10
Lslow11:
  s_cmp_eq_u32 s88, 0
  s_cbranch_scc1 Lret11
  s_sub_u32 s88, s88, 1
  s_nop 7
  s_nop 7
  s_xor_b32 s82, s98, 0x1c00000
  buffer_load_dwordx4 a[96:99], v251, s[32:35], s82 offen sc1
  buffer_load_dwordx4 a[100:103], v251, s[32:35], s82 offen offset:1024 sc1
  buffer_load_dwordx4 a[104:107], v251, s[32:35], s82 offen offset:2048 sc1
  buffer_load_dwordx4 a[108:111], v251, s[32:35], s82 offen offset:3072 sc1
  s_waitcnt vmcnt(3)
  v_mfma_f32_16x16x32_bf16 v[100:103], a[176:179], a[96:99], v[80:83]
  v_mfma_f32_16x16x32_bf16 v[108:111], a[180:183], a[96:99], v[88:91]
  s_waitcnt vmcnt(2)
  v_mfma_f32_16x16x32_bf16 v[104:107], a[176:179], a[100:103], v[84:87]
  v_mfma_f32_16x16x32_bf16 v[116:119], a[180:183], a[100:103], v[92:95]
  s_waitcnt vmcnt(1)
  v_mfma_f32_16x16x32_bf16 v[100:103], a[176:179], a[104:107], v[100:103]
  v_mfma_f32_16x16x32_bf16 v[108:111], a[180:183], a[104:107], v[108:111]
  s_waitcnt vmcnt(0)
  v_mfma_f32_16x16x32_bf16 v[104:107], a[176:179], a[108:111], v[104:107]
  v_mfma_f32_16x16x32_bf16 v[116:119], a[180:183], a[108:111], v[116:119]
  s_nop 6
  v_cmp_u_f32_e64 s[94:95], v100, v104
  s_nop 0
  s_cmp_lg_u64 s[94:95], 0
  s_waitcnt vmcnt(0)
  s_nop 7
  s_cbranch_scc1 Lslow11
  s_branch Lret11
.p2align 8
L_tab:
.long 0x0,0x0,0x0,0x0,0xc0,0x8,0x7ffffff0,0x10,0x180,0x10,0x7ffffff0,0x20,0x240,0x18,0x7ffffff0,0x30
.long 0x300,0x7ffffff0,0x7ffffff0,0x40,0x3c0,0x7ffffff0,0x7ffffff0,0x50,0x480,0x7ffffff0,0x7ffffff0,0x60,0x540,0x7ffffff0,0x7ffffff0,0x70
.long 0x600,0x7ffffff0,0x7ffffff0,0x80,0x6c0,0x7ffffff0,0x7ffffff0,0x90,0x780,0x7ffffff0,0x7ffffff0,0xa0,0x840,0x7ffffff0,0x7ffffff0,0xb0
.long 0x900,0x7ffffff0,0x7ffffff0,0xc0,0x9c0,0x7ffffff0,0x7ffffff0,0xd0,0xa80,0x7ffffff0,0x7ffffff0,0xe0,0xb40,0x7ffffff0,0x7ffffff0,0xf0
.long 0x10,0x20,0x7ffffff0,0x100,0xd0,0x28,0x7ffffff0,0x110,0x190,0x30,0x7ffffff0,0x120,0x250,0x38,0x7ffffff0,0x130
.long 0x310,0x7ffffff0,0x7ffffff0,0x140,0x3d0,0x7ffffff0,0x7ffffff0,0x150,0x490,0x7ffffff0,0x7ffffff0,0x160,0x550,0x7ffffff0,0x7ffffff0,0x170
.long 0x610,0x7ffffff0,0x7ffffff0,0x180,0x6d0,0x7ffffff0,0x7ffffff0,0x190,0x790,0x7ffffff0,0x7ffffff0,0x1a0,0x850,0x7ffffff0,0x7ffffff0,0x1b0
.long 0x910,0x7ffffff0,0x7ffffff0,0x1c0,0x9d0,0x7ffffff0,0x7ffffff0,0x1d0,0xa90,0x7ffffff0,0x7ffffff0,0x1e0,0xb50,0x7ffffff0,0x7ffffff0,0x1f0
.long 0x20,0x4,0x7ffffff0,0x200,0xe0,0xc,0x7ffffff0,0x210,0x1a0,0x14,0x7ffffff0,0x220,0x260,0x1c,0x7ffffff0,0x230
.long 0x320,0x7ffffff0,0x7ffffff0,0x240,0x3e0,0x7ffffff0,0x7ffffff0,0x250,0x4a0,0x7ffffff0,0x7ffffff0,0x260,0x560,0x7ffffff0,0x7ffffff0,0x270
.long 0x620,0x7ffffff0,0x7ffffff0,0x280,0x6e0,0x7ffffff0,0x7ffffff0,0x290,0x7a0,0x7ffffff0,0x7ffffff0,0x2a0,0x860,0x7ffffff0,0x7ffffff0,0x2b0
.long 0x920,0x7ffffff0,0x7ffffff0,0x2c0,0x9e0,0x7ffffff0,0x7ffffff0,0x2d0,0xaa0,0x7ffffff0,0x7ffffff0,0x2e0,0xb60,0x7ffffff0,0x7ffffff0,0x2f0
.long 0x30,0x24,0x7ffffff0,0x300,0xf0,0x2c,0x7ffffff0,0x310,0x1b0,0x34,0x7ffffff0,0x320,0x270,0x3c,0x7ffffff0,0x330
.long 0x330,0x7ffffff0,0x7ffffff0,0x340,0x3f0,0x7ffffff0,0x7ffffff0,0x350,0x4b0,0x7ffffff0,0x7ffffff0,0x360,0x570,0x7ffffff0,0x7ffffff0,0x370
.long 0x630,0x7ffffff0,0x7ffffff0,0x380,0x6f0,0x7ffffff0,0x7ffffff0,0x390,0x7b0,0x7ffffff0,0x7ffffff0,0x3a0,0x870,0x7ffffff0,0x7ffffff0,0x3b0
.long 0x930,0x7ffffff0,0x7ffffff0,0x3c0,0x9f0,0x7ffffff0,0x7ffffff0,0x3d0,0xab0,0x7ffffff0,0x7ffffff0,0x3e0,0xb70,0x7ffffff0,0x7ffffff0,0x3f0
.long 0x0,0x0,0x4200,0x1ef00,0x10,0x10,0x4208,0x1ef08,0x20,0x20,0x4210,0x1ef10,0x30,0x30,0x4218,0x1ef18
.long 0x2000,0x2400,0x4240,0x1efa0,0x2010,0x2410,0x4248,0x1efa8,0x2020,0x2420,0x4250,0x1efb0,0x2030,0x2430,0x4258,0x1efb8
.long 0x4000,0x4800,0x4280,0x1f040,0x4010,0x4810,0x4288,0x1f048,0x4020,0x4820,0x4290,0x1f050,0x4030,0x4830,0x4298,0x1f058
.long 0x6000,0x6c00,0x42c0,0x1f0e0,0x6010,0x6c10,0x42c8,0x1f0e8,0x6020,0x6c20,0x42d0,0x1f0f0,0x6030,0x6c30,0x42d8,0x1f0f8
.long 0x40,0x9000,0x4620,0x1f180,0x50,0x9010,0x4628,0x1f188,0x60,0x9020,0x4630,0x1f190,0x70,0x9030,0x4638,0x1f198
.long 0x2040,0xb400,0x4660,0x1f220,0x2050,0xb410,0x4668,0x1f228,0x2060,0xb420,0x4670,0x1f230,0x2070,0xb430,0x4678,0x1f238
.long 0x4040,0xd800,0x46a0,0x1f2c0,0x4050,0xd810,0x46a8,0x1f2c8,0x4060,0xd820,0x46b0,0x1f2d0,0x4070,0xd830,0x46b8,0x1f2d8
.long 0x6040,0xfc00,0x46e0,0x1f360,0x6050,0xfc10,0x46e8,0x1f368,0x6060,0xfc20,0x46f0,0x1f370,0x6070,0xfc30,0x46f8,0x1f378
.long 0x8000,0x24000,0x4400,0x1f400,0x8010,0x24010,0x4408,0x1f408,0x8020,0x24020,0x4410,0x1f410,0x8030,0x24030,0x4418,0x1f418
.long 0xa000,0x26400,0x4440,0x1f4a0,0xa010,0x26410,0x4448,0x1f4a8,0xa020,0x26420,0x4450,0x1f4b0,0xa030,0x26430,0x4458,0x1f4b8
.long 0xc000,0x28800,0x4480,0x1f540,0xc010,0x28810,0x4488,0x1f548,0xc020,0x28820,0x4490,0x1f550,0xc030,0x28830,0x4498,0x1f558
.long 0xe000,0x2ac00,0x44c0,0x1f5e0,0xe010,0x2ac10,0x44c8,0x1f5e8,0xe020,0x2ac20,0x44d0,0x1f5f0,0xe030,0x2ac30,0x44d8,0x1f5f8
.long 0x8040,0x2d000,0x4820,0x1f680,0x8050,0x2d010,0x4828,0x1f688,0x8060,0x2d020,0x4830,0x1f690,0x8070,0x2d030,0x4838,0x1f698
.long 0xa040,0x2f400,0x4860,0x1f720,0xa050,0x2f410,0x4868,0x1f728,0xa060,0x2f420,0x4870,0x1f730,0xa070,0x2f430,0x4878,0x1f738
.long 0xc040,0x31800,0x48a0,0x1f7c0,0xc050,0x31810,0x48a8,0x1f7c8,0xc060,0x31820,0x48b0,0x1f7d0,0xc070,0x31830,0x48b8,0x1f7d8
.long 0xe040,0x33c00,0x48e0,0x1f860,0xe050,0x33c10,0x48e8,0x1f868,0xe060,0x33c20,0x48f0,0x1f870,0xe070,0x33c30,0x48f8,0x1f878
.long 0x1ef00,0x20300,0x20580,0x1ef00,0x1ef08,0x20308,0x20588,0x1efa0,0x1ef10,0x20310,0x20590,0x1f040,0x1ef18,0x20318,0x20598,0x1f0e0
.long 0x1efa0,0x203a0,0x20620,0x1f180,0x1efa8,0x203a8,0x20628,0x1f220,0x1efb0,0x203b0,0x20630,0x1f2c0,0x1efb8,0x203b8,0x20638,0x1f360
.long 0x1f040,0x20440,0x206c0,0x1f408,0x1f048,0x20448,0x206c8,0x1f4a8,0x1f050,0x20450,0x206d0,0x1f548,0x1f058,0x20458,0x206d8,0x1f5e8
.long 0x1f0e0,0x204e0,0x20760,0x1f688,0x1f0e8,0x204e8,0x20768,0x1f728,0x1f0f0,0x204f0,0x20770,0x1f7c8,0x1f0f8,0x204f8,0x20778,0x1f868
.long 0x1f180,0x20580,0x20300,0x1ef28,0x1f188,0x20588,0x20308,0x1efc8,0x1f190,0x20590,0x20310,0x1f068,0x1f198,0x20598,0x20318,0x1f108
.long 0x1f220,0x20620,0x203a0,0x1f1a8,0x1f228,0x20628,0x203a8,0x1f248,0x1f230,0x20630,0x203b0,0x1f2e8,0x1f238,0x20638,0x203b8,0x1f388
.long 0x1f2c0,0x206c0,0x20440,0x1f430,0x1f2c8,0x206c8,0x20448,0x1f4d0,0x1f2d0,0x206d0,0x20450,0x1f570,0x1f2d8,0x206d8,0x20458,0x1f610
.long 0x1f360,0x20760,0x204e0,0x1f6b0,0x1f368,0x20768,0x204e8,0x1f750,0x1f370,0x20770,0x204f0,0x1f7f0,0x1f378,0x20778,0x204f8,0x1f890
.long 0x1f408,0x20580,0x20580,0x1ef50,0x1f410,0x20588,0x20588,0x1eff0,0x1f418,0x20590,0x20590,0x1f090,0x1f420,0x20598,0x20598,0x1f130
.long 0x1f4a8,0x20620,0x20620,0x1f1d0,0x1f4b0,0x20628,0x20628,0x1f270,0x1f4b8,0x20630,0x20630,0x1f310,0x1f4c0,0x20638,0x20638,0x1f3b0
.long 0x1f548,0x206c0,0x206c0,0x1f458,0x1f550,0x206c8,0x206c8,0x1f4f8,0x1f558,0x206d0,0x206d0,0x1f598,0x1f560,0x206d8,0x206d8,0x1f638
.long 0x1f5e8,0x20760,0x20760,0x1f6d8,0x1f5f0,0x20768,0x20768,0x1f778,0x1f5f8,0x20770,0x20770,0x1f818,0x1f600,0x20778,0x20778,0x1f8b8
.long 0x1f688,0x20580,0x20580,0x1ef78,0x1f690,0x20588,0x20588,0x1f018,0x1f698,0x20590,0x20590,0x1f0b8,0x1f6a0,0x20598,0x20598,0x1f158
.long 0x1f728,0x20620,0x20620,0x1f1f8,0x1f730,0x20628,0x20628,0x1f298,0x1f738,0x20630,0x20630,0x1f338,0x1f740,0x20638,0x20638,0x1f3d8
.long 0x1f7c8,0x206c0,0x206c0,0x1f480,0x1f7d0,0x206c8,0x206c8,0x1f520,0x1f7d8,0x206d0,0x206d0,0x1f5c0,0x1f7e0,0x206d8,0x206d8,0x1f660
.long 0x1f868,0x20760,0x20760,0x1f700,0x1f870,0x20768,0x20768,0x1f7a0,0x1f878,0x20770,0x20770,0x1f840,0x1f880,0x20778,0x20778,0x1f8e0
.long 0x24000,0x24050,0x24000,0x0,0x24060,0x240b0,0x24008,0x10,0x240c0,0x24110,0x24010,0x20,0x24120,0x24170,0x24018,0x30
.long 0x24180,0x241d0,0x24060,0x40,0x241e0,0x24230,0x24068,0x50,0x24240,0x24290,0x24070,0x60,0x242a0,0x242f0,0x24078,0x70
.long 0x24308,0x24358,0x240c0,0x80,0x24368,0x243b8,0x240c8,0x90,0x243c8,0x24418,0x240d0,0xa0,0x24428,0x24478,0x240d8,0xb0
.long 0x24488,0x244d8,0x24120,0xc0,0x244e8,0x24538,0x24128,0xd0,0x24548,0x24598,0x24130,0xe0,0x245a8,0x245f8,0x24138,0xf0
.long 0x24008,0x24058,0x24180,0x100,0x24068,0x240b8,0x24188,0x110,0x240c8,0x24118,0x24190,0x120,0x24128,0x24178,0x24198,0x130
.long 0x24188,0x241d8,0x241e0,0x140,0x241e8,0x24238,0x241e8,0x150,0x24248,0x24298,0x241f0,0x160,0x242a8,0x242f8,0x241f8,0x170
.long 0x24310,0x24360,0x24240,0x180,0x24370,0x243c0,0x24248,0x190,0x243d0,0x24420,0x24250,0x1a0,0x24430,0x24480,0x24258,0x1b0
.long 0x24490,0x244e0,0x242a0,0x1c0,0x244f0,0x24540,0x242a8,0x1d0,0x24550,0x245a0,0x242b0,0x1e0,0x245b0,0x24600,0x242b8,0x1f0
.long 0x24010,0x24040,0x24308,0x200,0x24070,0x240a0,0x24310,0x210,0x240d0,0x24100,0x24318,0x220,0x24130,0x24160,0x24320,0x230
.long 0x24190,0x241c0,0x24368,0x240,0x241f0,0x24220,0x24370,0x250,0x24250,0x24280,0x24378,0x260,0x242b0,0x242e0,0x24380,0x270
.long 0x24318,0x24348,0x243c8,0x280,0x24378,0x243a8,0x243d0,0x290,0x243d8,0x24408,0x243d8,0x2a0,0x24438,0x24468,0x243e0,0x2b0
.long 0x24498,0x244c8,0x24428,0x2c0,0x244f8,0x24528,0x24430,0x2d0,0x24558,0x24588,0x24438,0x2e0,0x245b8,0x245e8,0x24440,0x2f0
.long 0x24018,0x24048,0x24488,0x300,0x24078,0x240a8,0x24490,0x310,0x240d8,0x24108,0x24498,0x320,0x24138,0x24168,0x244a0,0x330
.long 0x24198,0x241c8,0x244e8,0x340,0x241f8,0x24228,0x244f0,0x350,0x24258,0x24288,0x244f8,0x360,0x242b8,0x242e8,0x24500,0x370
.long 0x24320,0x24350,0x24548,0x380,0x24380,0x243b0,0x24550,0x390,0x243e0,0x24410,0x24558,0x3a0,0x24440,0x24470,0x24560,0x3b0
.long 0x244a0,0x244d0,0x245a8,0x3c0,0x24500,0x24530,0x245b0,0x3d0,0x24560,0x24590,0x245b8,0x3e0,0x245c0,0x245f0,0x245c0,0x3f0
.long 0x26f00,0x26f08,0x26f00,0x27200,0x26f10,0x26f18,0x26f60,0x27560,0x26f20,0x26f30,0x26fc0,0x27d40,0x26f38,0x26f40,0x27020,0x27d40
.long 0x26f48,0x26f50,0x27260,0x27200,0x27f40,0x27f40,0x272c0,0x27560,0x26f60,0x26f68,0x27320,0x27d40,0x26f70,0x26f78,0x27380,0x27d40
.long 0x26f80,0x26f90,0x27d40,0x27200,0x26f98,0x26fa0,0x27d40,0x27560,0x26fa8,0x26fb0,0x27d40,0x27d40,0x27f40,0x27f40,0x27d40,0x27d40
.long 0x26fc0,0x26fc8,0x27d40,0x27200,0x26fd0,0x26fd8,0x27d40,0x27560,0x26fe0,0x26ff0,0x27d40,0x27d40,0x26ff8,0x27000,0x27d40,0x27d40
.long 0x27008,0x27010,0x26f30,0x27230,0x27f40,0x27f40,0x26f90,0x27590,0x27020,0x27028,0x26ff0,0x27d40,0x27030,0x27038,0x27050,0x27d40
.long 0x27040,0x27050,0x27290,0x27230,0x27058,0x27060,0x272f0,0x27590,0x27068,0x27070,0x27350,0x27d40,0x27f40,0x27f40,0x273b0,0x27d40
.long 0x27080,0x27088,0x27d40,0x27230,0x27090,0x27098,0x27d40,0x27590,0x270a0,0x270b0,0x27d40,0x27d40,0x270b8,0x270c0,0x27d40,0x27d40
.long 0x270c8,0x270d0,0x27d40,0x27230,0x27f40,0x27f40,0x27d40,0x27590,0x270e0,0x270e8,0x27d40,0x27d40,0x270f0,0x270f8,0x27d40,0x27d40
.long 0x27100,0x27110,0x27d40,0x27d40,0x27118,0x27120,0x27d40,0x27d40,0x27128,0x27130,0x27d40,0x27920,0x27f40,0x27f40,0x27d40,0x27c80
.long 0x27140,0x27148,0x27d40,0x27d40,0x27150,0x27158,0x27d40,0x27d40,0x27160,0x27170,0x27d40,0x27920,0x27178,0x27180,0x27d40,0x27c80
.long 0x27188,0x27190,0x27620,0x27d40,0x27f40,0x27f40,0x27680,0x27d40,0x271a0,0x271a8,0x276e0,0x27920,0x271b0,0x271b8,0x27740,0x27c80
.long 0x271c0,0x271d0,0x27980,0x27d40,0x271d8,0x271e0,0x279e0,0x27d40,0x271e8,0x271f0,0x27a40,0x27920,0x27f40,0x27f40,0x27aa0,0x27c80
.long 0x27200,0x27208,0x27d40,0x27d40,0x27210,0x27218,0x27d40,0x27d40,0x27220,0x27230,0x27d40,0x27950,0x27238,0x27240,0x27d40,0x27cb0
.long 0x27248,0x27250,0x27d40,0x27d40,0x27f40,0x27f40,0x27d40,0x27d40,0x27260,0x27268,0x27d40,0x27950,0x27270,0x27278,0x27d40,0x27cb0
.long 0x27280,0x27290,0x27650,0x27d40,0x27298,0x272a0,0x276b0,0x27d40,0x272a8,0x272b0,0x27710,0x27950,0x27f40,0x27f40,0x27770,0x27cb0
.long 0x272c0,0x272c8,0x279b0,0x27d40,0x272d0,0x272d8,0x27a10,0x27d40,0x272e0,0x272f0,0x27a70,0x27950,0x272f8,0x27300,0x27ad0,0x27cb0
.long 0x275c0,0x0,0x0,0x2400,0x27d40,0x10,0x10,0x2410,0x27d40,0x20,0x20,0x2420,0x27d40,0x30,0x30,0x2430
.long 0x275c0,0x40,0x40,0x2440,0x27d40,0x50,0x50,0x2450,0x27d40,0x60,0x60,0x2460,0x27d40,0x70,0x70,0x2470
.long 0x275c0,0x480,0x480,0x2480,0x27d40,0x490,0x490,0x2490,0x27d40,0x4a0,0x4a0,0x24a0,0x27d40,0x4b0,0x4b0,0x24b0
.long 0x275c0,0x4c0,0x4c0,0x24c0,0x27d40,0x4d0,0x4d0,0x24d0,0x27d40,0x4e0,0x4e0,0x24e0,0x27d40,0x4f0,0x4f0,0x24f0
.long 0x275f0,0x4800,0x1200,0x2500,0x27d40,0x4810,0x1210,0x2510,0x27d40,0x4820,0x1220,0x2520,0x27d40,0x4830,0x1230,0x2530
.long 0x275f0,0x4840,0x1240,0x2540,0x27d40,0x4850,0x1250,0x2550,0x27d40,0x4860,0x1260,0x2560,0x27d40,0x4870,0x1270,0x2570
.long 0x275f0,0x4c80,0x1680,0x2580,0x27d40,0x4c90,0x1690,0x2590,0x27d40,0x4ca0,0x16a0,0x25a0,0x27d40,0x4cb0,0x16b0,0x25b0
.long 0x275f0,0x4cc0,0x16c0,0x25c0,0x27d40,0x4cd0,0x16d0,0x25d0,0x27d40,0x4ce0,0x16e0,0x25e0,0x27d40,0x4cf0,0x16f0,0x25f0
.long 0x27d40,0x2400,0x5100,0x2600,0x27ce0,0x2410,0x5110,0x2610,0x27d40,0x2420,0x5120,0x2620,0x27d40,0x2430,0x5130,0x2630
.long 0x27d40,0x2440,0x5140,0x2640,0x27ce0,0x2450,0x5150,0x2650,0x27d40,0x2460,0x5160,0x2660,0x27d40,0x2470,0x5170,0x2670
.long 0x27d40,0x2880,0x5580,0x2680,0x27ce0,0x2890,0x5590,0x2690,0x27d40,0x28a0,0x55a0,0x26a0,0x27d40,0x28b0,0x55b0,0x26b0
.long 0x27d40,0x28c0,0x55c0,0x26c0,0x27ce0,0x28d0,0x55d0,0x26d0,0x27d40,0x28e0,0x55e0,0x26e0,0x27d40,0x28f0,0x55f0,0x26f0
.long 0x27d40,0x6c00,0x6300,0x2700,0x27d10,0x6c10,0x6310,0x2710,0x27d40,0x6c20,0x6320,0x2720,0x27d40,0x6c30,0x6330,0x2730
.long 0x27d40,0x6c40,0x6340,0x2740,0x27d10,0x6c50,0x6350,0x2750,0x27d40,0x6c60,0x6360,0x2760,0x27d40,0x6c70,0x6370,0x2770
.long 0x27d40,0x7080,0x6780,0x2780,0x27d10,0x7090,0x6790,0x2790,0x27d40,0x70a0,0x67a0,0x27a0,0x27d40,0x70b0,0x67b0,0x27b0
.long 0x27d40,0x70c0,0x67c0,0x27c0,0x27d10,0x70d0,0x67d0,0x27d0,0x27d40,0x70e0,0x67e0,0x27e0,0x27d40,0x70f0,0x67f0,0x27f0
.long 0x2400,0x23f00,0x0,0x0,0x2410,0x23f00,0x200,0x10,0x2420,0x23f00,0x7ffffff0,0x20,0x2430,0x23f00,0x7ffffff0,0x30
.long 0x2440,0x24720,0x7ffffff0,0x40,0x2450,0x24720,0x7ffffff0,0x50,0x2460,0x24720,0x7ffffff0,0x60,0x2470,0x24720,0x7ffffff0,0x70
.long 0x70000000,0x24f40,0x7ffffff0,0x80,0x70000000,0x24f40,0x7ffffff0,0x90,0x70000000,0x24f40,0x7ffffff0,0xa0,0x70000000,0x24f40,0x7ffffff0,0xb0
.long 0x70000000,0x25760,0x7ffffff0,0xc0,0x70000000,0x25760,0x7ffffff0,0xd0,0x70000000,0x25760,0x7ffffff0,0xe0,0x70000000,0x25760,0x7ffffff0,0xf0
.long 0x70000000,0x23f08,0x7ffffff0,0x4000,0x70000000,0x23f08,0x7ffffff0,0x4010,0x70000000,0x23f08,0x7ffffff0,0x4020,0x70000000,0x23f08,0x7ffffff0,0x4030
.long 0x70000000,0x24728,0x7ffffff0,0x4040,0x70000000,0x24728,0x7ffffff0,0x4050,0x70000000,0x24728,0x7ffffff0,0x4060,0x70000000,0x24728,0x7ffffff0,0x4070
.long 0x70000000,0x24f48,0x7ffffff0,0x4080,0x70000000,0x24f48,0x7ffffff0,0x4090,0x70000000,0x24f48,0x7ffffff0,0x40a0,0x70000000,0x24f48,0x7ffffff0,0x40b0
.long 0x70000000,0x25768,0x7ffffff0,0x40c0,0x70000000,0x25768,0x7ffffff0,0x40d0,0x70000000,0x25768,0x7ffffff0,0x40e0,0x70000000,0x25768,0x7ffffff0,0x40f0
.long 0x70000000,0x23f10,0x7ffffff0,0x8000,0x70000000,0x23f10,0x7ffffff0,0x8010,0x70000000,0x23f10,0x7ffffff0,0x8020,0x70000000,0x23f10,0x7ffffff0,0x8030
.long 0x70000000,0x24730,0x7ffffff0,0x8040,0x70000000,0x24730,0x7ffffff0,0x8050,0x70000000,0x24730,0x7ffffff0,0x8060,0x70000000,0x24730,0x7ffffff0,0x8070
.long 0x70000000,0x24f50,0x7ffffff0,0x8080,0x70000000,0x24f50,0x7ffffff0,0x8090,0x70000000,0x24f50,0x7ffffff0,0x80a0,0x70000000,0x24f50,0x7ffffff0,0x80b0
.long 0x70000000,0x25770,0x7ffffff0,0x80c0,0x70000000,0x25770,0x7ffffff0,0x80d0,0x70000000,0x25770,0x7ffffff0,0x80e0,0x70000000,0x25770,0x7ffffff0,0x80f0
.long 0x70000000,0x23f18,0x7ffffff0,0xc000,0x70000000,0x23f18,0x7ffffff0,0xc010,0x70000000,0x23f18,0x7ffffff0,0xc020,0x70000000,0x23f18,0x7ffffff0,0xc030
.long 0x70000000,0x24738,0x7ffffff0,0xc040,0x70000000,0x24738,0x7ffffff0,0xc050,0x70000000,0x24738,0x7ffffff0,0xc060,0x70000000,0x24738,0x7ffffff0,0xc070
.long 0x70000000,0x24f58,0x7ffffff0,0xc080,0x70000000,0x24f58,0x7ffffff0,0xc090,0x70000000,0x24f58,0x7ffffff0,0xc0a0,0x70000000,0x24f58,0x7ffffff0,0xc0b0
.long 0x70000000,0x25778,0x7ffffff0,0xc0c0,0x70000000,0x25778,0x7ffffff0,0xc0d0,0x70000000,0x25778,0x7ffffff0,0xc0e0,0x70000000,0x25778,0x7ffffff0,0xc0f0
.long 0x0,0x0,0x0,0x0,0x8,0x8,0x480,0x480,0x10,0x10,0x900,0x900,0x18,0x18,0xd80,0xd80
.long 0x20,0x20,0x1200,0x1200,0x28,0x28,0x1680,0x1680,0x30,0x30,0x1b00,0x1b00,0x38,0x38,0x1f80,0x1f80
.long 0x40,0x40,0x2400,0x2400,0x48,0x48,0x2880,0x2880,0x50,0x50,0x2d00,0x2d00,0x58,0x58,0x3180,0x3180
.long 0x60,0x60,0x3600,0x3600,0x68,0x68,0x3a80,0x3a80,0x70,0x70,0x3f00,0x3f00,0x78,0x78,0x4380,0x4380
.long 0x80,0x0,0x8,0x4800,0x88,0x8,0x488,0x4c80,0x90,0x10,0x908,0x5100,0x98,0x18,0xd88,0x5580
.long 0xa0,0x20,0x1208,0x5a00,0xa8,0x28,0x1688,0x5e80,0xb0,0x30,0x1b08,0x6300,0xb8,0x38,0x1f88,0x6780
.long 0xc0,0x40,0x2408,0x6c00,0xc8,0x48,0x2888,0x7080,0xd0,0x50,0x2d08,0x7500,0xd8,0x58,0x3188,0x7980
.long 0xe0,0x60,0x3608,0x7e00,0xe8,0x68,0x3a88,0x8280,0xf0,0x70,0x3f08,0x8700,0xf8,0x78,0x4388,0x8b80
.long 0x100,0x7ffffff0,0x10,0x7ffffff0,0x108,0x7ffffff0,0x490,0x7ffffff0,0x110,0x7ffffff0,0x910,0x7ffffff0,0x118,0x7ffffff0,0xd90,0x7ffffff0
.long 0x120,0x7ffffff0,0x1210,0x7ffffff0,0x128,0x7ffffff0,0x1690,0x7ffffff0,0x130,0x7ffffff0,0x1b10,0x7ffffff0,0x138,0x7ffffff0,0x1f90,0x7ffffff0
.long 0x140,0x7ffffff0,0x2410,0x7ffffff0,0x148,0x7ffffff0,0x2890,0x7ffffff0,0x150,0x7ffffff0,0x2d10,0x7ffffff0,0x158,0x7ffffff0,0x3190,0x7ffffff0
.long 0x160,0x7ffffff0,0x3610,0x7ffffff0,0x168,0x7ffffff0,0x3a90,0x7ffffff0,0x170,0x7ffffff0,0x3f10,0x7ffffff0,0x178,0x7ffffff0,0x4390,0x7ffffff0
.long 0x180,0x7ffffff0,0x18,0x7ffffff0,0x188,0x7ffffff0,0x498,0x7ffffff0,0x190,0x7ffffff0,0x918,0x7ffffff0,0x198,0x7ffffff0,0xd98,0x7ffffff0
.long 0x1a0,0x7ffffff0,0x1218,0x7ffffff0,0x1a8,0x7ffffff0,0x1698,0x7ffffff0,0x1b0,0x7ffffff0,0x1b18,0x7ffffff0,0x1b8,0x7ffffff0,0x1f98,0x7ffffff0
.long 0x1c0,0x7ffffff0,0x2418,0x7ffffff0,0x1c8,0x7ffffff0,0x2898,0x7ffffff0,0x1d0,0x7ffffff0,0x2d18,0x7ffffff0,0x1d8,0x7ffffff0,0x3198,0x7ffffff0
.long 0x1e0,0x7ffffff0,0x3618,0x7ffffff0,0x1e8,0x7ffffff0,0x3a98,0x7ffffff0,0x1f0,0x7ffffff0,0x3f18,0x7ffffff0,0x1f8,0x7ffffff0,0x4398,0x7ffffff0
.long 0xc00,0x0,0x0,0x0,0xcc0,0x8,0x7ffffff0,0x10,0x18000000,0x10,0x7ffffff0,0x20,0x18000000,0x18,0x7ffffff0,0x30
.long 0xd80,0x7ffffff0,0x7ffffff0,0x40,0x18000000,0x7ffffff0,0x7ffffff0,0x50,0x18000000,0x7ffffff0,0x7ffffff0,0x60,0x18000000,0x7ffffff0,0x7ffffff0,0x70
.long 0x18000000,0x7ffffff0,0x7ffffff0,0x80,0x18000000,0x7ffffff0,0x7ffffff0,0x90,0x18000000,0x7ffffff0,0x7ffffff0,0xa0,0x18000000,0x7ffffff0,0x7ffffff0,0xb0
.long 0x18000000,0x7ffffff0,0x7ffffff0,0xc0,0x18000000,0x7ffffff0,0x7ffffff0,0xd0,0x18000000,0x7ffffff0,0x7ffffff0,0xe0,0x18000000,0x7ffffff0,0x7ffffff0,0xf0
.long 0xc10,0x20,0x7ffffff0,0x100,0xcd0,0x28,0x7ffffff0,0x110,0x18000010,0x30,0x7ffffff0,0x120,0x18000010,0x38,0x7ffffff0,0x130
.long 0xd90,0x7ffffff0,0x7ffffff0,0x140,0x18000010,0x7ffffff0,0x7ffffff0,0x150,0x18000010,0x7ffffff0,0x7ffffff0,0x160,0x18000010,0x7ffffff0,0x7ffffff0,0x170
.long 0x18000010,0x7ffffff0,0x7ffffff0,0x180,0x18000010,0x7ffffff0,0x7ffffff0,0x190,0x18000010,0x7ffffff0,0x7ffffff0,0x1a0,0x18000010,0x7ffffff0,0x7ffffff0,0x1b0
.long 0x18000010,0x7ffffff0,0x7ffffff0,0x1c0,0x18000010,0x7ffffff0,0x7ffffff0,0x1d0,0x18000010,0x7ffffff0,0x7ffffff0,0x1e0,0x18000010,0x7ffffff0,0x7ffffff0,0x1f0
.long 0xc20,0x4,0x7ffffff0,0x200,0xce0,0xc,0x7ffffff0,0x210,0x18000020,0x14,0x7ffffff0,0x220,0x18000020,0x1c,0x7ffffff0,0x230
.long 0xda0,0x7ffffff0,0x7ffffff0,0x240,0x18000020,0x7ffffff0,0x7ffffff0,0x250,0x18000020,0x7ffffff0,0x7ffffff0,0x260,0x18000020,0x7ffffff0,0x7ffffff0,0x270
.long 0x18000020,0x7ffffff0,0x7ffffff0,0x280,0x18000020,0x7ffffff0,0x7ffffff0,0x290,0x18000020,0x7ffffff0,0x7ffffff0,0x2a0,0x18000020,0x7ffffff0,0x7ffffff0,0x2b0
.long 0x18000020,0x7ffffff0,0x7ffffff0,0x2c0,0x18000020,0x7ffffff0,0x7ffffff0,0x2d0,0x18000020,0x7ffffff0,0x7ffffff0,0x2e0,0x18000020,0x7ffffff0,0x7ffffff0,0x2f0
.long 0xc30,0x24,0x7ffffff0,0x300,0xcf0,0x2c,0x7ffffff0,0x310,0x18000030,0x34,0x7ffffff0,0x320,0x18000030,0x3c,0x7ffffff0,0x330
.long 0xdb0,0x7ffffff0,0x7ffffff0,0x340,0x18000030,0x7ffffff0,0x7ffffff0,0x350,0x18000030,0x7ffffff0,0x7ffffff0,0x360,0x18000030,0x7ffffff0,0x7ffffff0,0x370
.long 0x18000030,0x7ffffff0,0x7ffffff0,0x380,0x18000030,0x7ffffff0,0x7ffffff0,0x390,0x18000030,0x7ffffff0,0x7ffffff0,0x3a0,0x18000030,0x7ffffff0,0x7ffffff0,0x3b0
.long 0x18000030,0x7ffffff0,0x7ffffff0,0x3c0,0x18000030,0x7ffffff0,0x7ffffff0,0x3d0,0x18000030,0x7ffffff0,0x7ffffff0,0x3e0,0x18000030,0x7ffffff0,0x7ffffff0,0x3f0
.long 0x0,0x12000,0x4200,0x1ef00,0x10,0x12010,0x4208,0x1ef08,0x20,0x12020,0x4210,0x1ef10,0x30,0x12030,0x4218,0x1ef18
.long 0x2000,0x14400,0x4240,0x1efa0,0x2010,0x14410,0x4248,0x1efa8,0x2020,0x14420,0x4250,0x1efb0,0x2030,0x14430,0x4258,0x1efb8
.long 0x4000,0x16800,0x4280,0x1f040,0x4010,0x16810,0x4288,0x1f048,0x4020,0x16820,0x4290,0x1f050,0x4030,0x16830,0x4298,0x1f058
.long 0x6000,0x18c00,0x42c0,0x1f0e0,0x6010,0x18c10,0x42c8,0x1f0e8,0x6020,0x18c20,0x42d0,0x1f0f0,0x6030,0x18c30,0x42d8,0x1f0f8
.long 0x40,0x1b000,0x4620,0x1f180,0x50,0x1b010,0x4628,0x1f188,0x60,0x1b020,0x4630,0x1f190,0x70,0x1b030,0x4638,0x1f198
.long 0x2040,0x1d400,0x4660,0x1f220,0x2050,0x1d410,0x4668,0x1f228,0x2060,0x1d420,0x4670,0x1f230,0x2070,0x1d430,0x4678,0x1f238
.long 0x4040,0x1f800,0x46a0,0x1f2c0,0x4050,0x1f810,0x46a8,0x1f2c8,0x4060,0x1f820,0x46b0,0x1f2d0,0x4070,0x1f830,0x46b8,0x1f2d8
.long 0x6040,0x21c00,0x46e0,0x1f360,0x6050,0x21c10,0x46e8,0x1f368,0x6060,0x21c20,0x46f0,0x1f370,0x6070,0x21c30,0x46f8,0x1f378
.long 0x8000,0x36000,0x4400,0x1f400,0x8010,0x36010,0x4408,0x1f408,0x8020,0x36020,0x4410,0x1f410,0x8030,0x36030,0x4418,0x1f418
.long 0xa000,0x38400,0x4440,0x1f4a0,0xa010,0x38410,0x4448,0x1f4a8,0xa020,0x38420,0x4450,0x1f4b0,0xa030,0x38430,0x4458,0x1f4b8
.long 0xc000,0x3a800,0x4480,0x1f540,0xc010,0x3a810,0x4488,0x1f548,0xc020,0x3a820,0x4490,0x1f550,0xc030,0x3a830,0x4498,0x1f558
.long 0xe000,0x3cc00,0x44c0,0x1f5e0,0xe010,0x3cc10,0x44c8,0x1f5e8,0xe020,0x3cc20,0x44d0,0x1f5f0,0xe030,0x3cc30,0x44d8,0x1f5f8
.long 0x8040,0x3f000,0x4820,0x1f680,0x8050,0x3f010,0x4828,0x1f688,0x8060,0x3f020,0x4830,0x1f690,0x8070,0x3f030,0x4838,0x1f698
.long 0xa040,0x41400,0x4860,0x1f720,0xa050,0x41410,0x4868,0x1f728,0xa060,0x41420,0x4870,0x1f730,0xa070,0x41430,0x4878,0x1f738
.long 0xc040,0x43800,0x48a0,0x1f7c0,0xc050,0x43810,0x48a8,0x1f7c8,0xc060,0x43820,0x48b0,0x1f7d0,0xc070,0x43830,0x48b8,0x1f7d8
.long 0xe040,0x45c00,0x48e0,0x1f860,0xe050,0x45c10,0x48e8,0x1f868,0xe060,0x45c20,0x48f0,0x1f870,0xe070,0x45c30,0x48f8,0x1f878
.long 0x1ef00,0x20300,0x20580,0x20340,0x1ef08,0x20308,0x20588,0x203e0,0x1ef10,0x20310,0x20590,0x20480,0x1ef18,0x20318,0x20598,0x20520
.long 0x1efa0,0x203a0,0x20620,0x205c0,0x1efa8,0x203a8,0x20628,0x20660,0x1efb0,0x203b0,0x20630,0x20700,0x1efb8,0x203b8,0x20638,0x207a0
.long 0x1f040,0x20440,0x206c0,0x20848,0x1f048,0x20448,0x206c8,0x208e8,0x1f050,0x20450,0x206d0,0x20988,0x1f058,0x20458,0x206d8,0x20a28
.long 0x1f0e0,0x204e0,0x20760,0x20ac8,0x1f0e8,0x204e8,0x20768,0x20b68,0x1f0f0,0x204f0,0x20770,0x20c08,0x1f0f8,0x204f8,0x20778,0x20ca8
.long 0x1f180,0x20580,0x20300,0x20368,0x1f188,0x20588,0x20308,0x20408,0x1f190,0x20590,0x20310,0x204a8,0x1f198,0x20598,0x20318,0x20548
.long 0x1f220,0x20620,0x203a0,0x205e8,0x1f228,0x20628,0x203a8,0x20688,0x1f230,0x20630,0x203b0,0x20728,0x1f238,0x20638,0x203b8,0x207c8
.long 0x1f2c0,0x206c0,0x20440,0x20870,0x1f2c8,0x206c8,0x20448,0x20910,0x1f2d0,0x206d0,0x20450,0x209b0,0x1f2d8,0x206d8,0x20458,0x20a50
.long 0x1f360,0x20760,0x204e0,0x20af0,0x1f368,0x20768,0x204e8,0x20b90,0x1f370,0x20770,0x204f0,0x20c30,0x1f378,0x20778,0x204f8,0x20cd0
.long 0x1f408,0x20580,0x20580,0x20390,0x1f410,0x20588,0x20588,0x20430,0x1f418,0x20590,0x20590,0x204d0,0x1f420,0x20598,0x20598,0x20570
.long 0x1f4a8,0x20620,0x20620,0x20610,0x1f4b0,0x20628,0x20628,0x206b0,0x1f4b8,0x20630,0x20630,0x20750,0x1f4c0,0x20638,0x20638,0x207f0
.long 0x1f548,0x206c0,0x206c0,0x20898,0x1f550,0x206c8,0x206c8,0x20938,0x1f558,0x206d0,0x206d0,0x209d8,0x1f560,0x206d8,0x206d8,0x20a78
.long 0x1f5e8,0x20760,0x20760,0x20b18,0x1f5f0,0x20768,0x20768,0x20bb8,0x1f5f8,0x20770,0x20770,0x20c58,0x1f600,0x20778,0x20778,0x20cf8
.long 0x1f688,0x20580,0x20580,0x203b8,0x1f690,0x20588,0x20588,0x20458,0x1f698,0x20590,0x20590,0x204f8,0x1f6a0,0x20598,0x20598,0x20598
.long 0x1f728,0x20620,0x20620,0x20638,0x1f730,0x20628,0x20628,0x206d8,0x1f738,0x20630,0x20630,0x20778,0x1f740,0x20638,0x20638,0x20818
.long 0x1f7c8,0x206c0,0x206c0,0x208c0,0x1f7d0,0x206c8,0x206c8,0x20960,0x1f7d8,0x206d0,0x206d0,0x20a00,0x1f7e0,0x206d8,0x206d8,0x20aa0
.long 0x1f868,0x20760,0x20760,0x20b40,0x1f870,0x20768,0x20768,0x20be0,0x1f878,0x20770,0x20770,0x20c80,0x1f880,0x20778,0x20778,0x20d20
.long 0x24c40,0x24c90,0x24020,0x400,0x24ca0,0x24cf0,0x24048,0x410,0x24d00,0x24d50,0x24048,0x420,0x24d60,0x24db0,0x24048,0x430
.long 0x24dc0,0x24e10,0x24080,0x440,0x24e20,0x24e70,0x240a8,0x450,0x24e80,0x24ed0,0x240a8,0x460,0x24ee0,0x24f30,0x240a8,0x470
.long 0x24f48,0x24f98,0x240e0,0x480,0x24fa8,0x24ff8,0x24108,0x490,0x25008,0x25058,0x24108,0x4a0,0x25068,0x250b8,0x24108,0x4b0
.long 0x250c8,0x25118,0x24140,0x4c0,0x25128,0x25178,0x24168,0x4d0,0x25188,0x251d8,0x24168,0x4e0,0x251e8,0x25238,0x24168,0x4f0
.long 0x24c48,0x24c98,0x241a0,0x500,0x24ca8,0x24cf8,0x241c8,0x510,0x24d08,0x24d58,0x241c8,0x520,0x24d68,0x24db8,0x241c8,0x530
.long 0x24dc8,0x24e18,0x24200,0x540,0x24e28,0x24e78,0x24228,0x550,0x24e88,0x24ed8,0x24228,0x560,0x24ee8,0x24f38,0x24228,0x570
.long 0x24f50,0x24fa0,0x24260,0x580,0x24fb0,0x25000,0x24288,0x590,0x25010,0x25060,0x24288,0x5a0,0x25070,0x250c0,0x24288,0x5b0
.long 0x250d0,0x25120,0x242c0,0x5c0,0x25130,0x25180,0x242e8,0x5d0,0x25190,0x251e0,0x242e8,0x5e0,0x251f0,0x25240,0x242e8,0x5f0
.long 0x24c50,0x24c80,0x24328,0x600,0x24cb0,0x24ce0,0x24350,0x610,0x24d10,0x24d40,0x24350,0x620,0x24d70,0x24da0,0x24350,0x630
.long 0x24dd0,0x24e00,0x24388,0x640,0x24e30,0x24e60,0x243b0,0x650,0x24e90,0x24ec0,0x243b0,0x660,0x24ef0,0x24f20,0x243b0,0x670
.long 0x24f58,0x24f88,0x243e8,0x680,0x24fb8,0x24fe8,0x24410,0x690,0x25018,0x25048,0x24410,0x6a0,0x25078,0x250a8,0x24410,0x6b0
.long 0x250d8,0x25108,0x24448,0x6c0,0x25138,0x25168,0x24470,0x6d0,0x25198,0x251c8,0x24470,0x6e0,0x251f8,0x25228,0x24470,0x6f0
.long 0x24c58,0x24c88,0x244a8,0x700,0x24cb8,0x24ce8,0x244d0,0x710,0x24d18,0x24d48,0x244d0,0x720,0x24d78,0x24da8,0x244d0,0x730
.long 0x24dd8,0x24e08,0x24508,0x740,0x24e38,0x24e68,0x24530,0x750,0x24e98,0x24ec8,0x24530,0x760,0x24ef8,0x24f28,0x24530,0x770
.long 0x24f60,0x24f90,0x24568,0x780,0x24fc0,0x24ff0,0x24590,0x790,0x25020,0x25050,0x24590,0x7a0,0x25080,0x250b0,0x24590,0x7b0
.long 0x250e0,0x25110,0x245c8,0x7c0,0x25140,0x25170,0x245f0,0x7d0,0x251a0,0x251d0,0x245f0,0x7e0,0x25200,0x25230,0x245f0,0x7f0
.long 0x27308,0x27310,0x26f00,0x27200,0x27f40,0x27f40,0x26f60,0x27560,0x27320,0x27328,0x26fc0,0x27d40,0x27330,0x27338,0x27020,0x27d40
.long 0x27340,0x27350,0x27260,0x27200,0x27358,0x27360,0x272c0,0x27560,0x27368,0x27370,0x27320,0x27d40,0x27f40,0x27f40,0x27380,0x27d40
.long 0x27380,0x27388,0x27d40,0x27200,0x27390,0x27398,0x27d40,0x27560,0x273a0,0x273b0,0x27d40,0x27d40,0x273b8,0x273c0,0x27d40,0x27d40
.long 0x273c8,0x273d0,0x27d40,0x27200,0x27f40,0x27f40,0x27d40,0x27560,0x273e0,0x273e8,0x27d40,0x27d40,0x273f0,0x273f8,0x27d40,0x27d40
.long 0x27400,0x27410,0x26f30,0x27230,0x27418,0x27420,0x26f90,0x27590,0x27428,0x27430,0x26ff0,0x27d40,0x27f40,0x27f40,0x27050,0x27d40
.long 0x27440,0x27448,0x27290,0x27230,0x27450,0x27458,0x272f0,0x27590,0x27460,0x27470,0x27350,0x27d40,0x27478,0x27480,0x273b0,0x27d40
.long 0x27488,0x27490,0x27d40,0x27230,0x27f40,0x27f40,0x27d40,0x27590,0x274a0,0x274a8,0x27d40,0x27d40,0x274b0,0x274b8,0x27d40,0x27d40
.long 0x274c0,0x274d0,0x27d40,0x27230,0x274d8,0x274e0,0x27d40,0x27590,0x274e8,0x274f0,0x27d40,0x27d40,0x27f40,0x27f40,0x27d40,0x27d40
.long 0x27500,0x27508,0x27d40,0x27d40,0x27510,0x27518,0x27d40,0x27d40,0x27520,0x27530,0x27d40,0x27920,0x27538,0x27540,0x27d40,0x27c80
.long 0x27548,0x27550,0x27d40,0x27d40,0x27f40,0x27f40,0x27d40,0x27d40,0x27560,0x27568,0x27d40,0x27920,0x27570,0x27578,0x27d40,0x27c80
.long 0x27580,0x27590,0x27620,0x27d40,0x27598,0x275a0,0x27680,0x27d40,0x275a8,0x275b0,0x276e0,0x27920,0x27f40,0x27f40,0x27740,0x27c80
.long 0x275c0,0x275c8,0x27980,0x27d40,0x275d0,0x275d8,0x279e0,0x27d40,0x275e0,0x275f0,0x27a40,0x27920,0x275f8,0x27600,0x27aa0,0x27c80
.long 0x27608,0x27610,0x27d40,0x27d40,0x27f40,0x27f40,0x27d40,0x27d40,0x27f40,0x27f40,0x27d40,0x27950,0x27620,0x27628,0x27d40,0x27cb0
.long 0x27630,0x27638,0x27d40,0x27d40,0x27640,0x27650,0x27d40,0x27d40,0x27658,0x27660,0x27d40,0x27950,0x27668,0x27670,0x27d40,0x27cb0
.long 0x27f40,0x27f40,0x27650,0x27d40,0x27680,0x27688,0x276b0,0x27d40,0x27690,0x27698,0x27710,0x27950,0x276a0,0x276b0,0x27770,0x27cb0
.long 0x276b8,0x276c0,0x279b0,0x27d40,0x276c8,0x276d0,0x27a10,0x27d40,0x27f40,0x27f40,0x27a70,0x27950,0x276e0,0x276e8,0x27ad0,0x27cb0
.long 0x275c0,0x900,0x900,0x4c80,0x27d40,0x910,0x910,0x4c90,0x27d40,0x920,0x920,0x4ca0,0x27d40,0x930,0x930,0x4cb0
.long 0x275c0,0x940,0x940,0x4cc0,0x27d40,0x950,0x950,0x4cd0,0x27d40,0x960,0x960,0x4ce0,0x27d40,0x970,0x970,0x4cf0
.long 0x275c0,0xd80,0xd80,0x4d00,0x27d40,0xd90,0xd90,0x4d10,0x27d40,0xda0,0xda0,0x4d20,0x27d40,0xdb0,0xdb0,0x4d30
.long 0x275c0,0xdc0,0xdc0,0x4d40,0x27d40,0xdd0,0xdd0,0x4d50,0x27d40,0xde0,0xde0,0x4d60,0x27d40,0xdf0,0xdf0,0x4d70
.long 0x275f0,0x5100,0x1b00,0x4d80,0x27d40,0x5110,0x1b10,0x4d90,0x27d40,0x5120,0x1b20,0x4da0,0x27d40,0x5130,0x1b30,0x4db0
.long 0x275f0,0x5140,0x1b40,0x4dc0,0x27d40,0x5150,0x1b50,0x4dd0,0x27d40,0x5160,0x1b60,0x4de0,0x27d40,0x5170,0x1b70,0x4df0
.long 0x275f0,0x5580,0x1f80,0x4e00,0x27d40,0x5590,0x1f90,0x4e10,0x27d40,0x55a0,0x1fa0,0x4e20,0x27d40,0x55b0,0x1fb0,0x4e30
.long 0x275f0,0x55c0,0x1fc0,0x4e40,0x27d40,0x55d0,0x1fd0,0x4e50,0x27d40,0x55e0,0x1fe0,0x4e60,0x27d40,0x55f0,0x1ff0,0x4e70
.long 0x27d40,0x2d00,0x5a00,0x4e80,0x27ce0,0x2d10,0x5a10,0x4e90,0x27d40,0x2d20,0x5a20,0x4ea0,0x27d40,0x2d30,0x5a30,0x4eb0
.long 0x27d40,0x2d40,0x5a40,0x4ec0,0x27ce0,0x2d50,0x5a50,0x4ed0,0x27d40,0x2d60,0x5a60,0x4ee0,0x27d40,0x2d70,0x5a70,0x4ef0
.long 0x27d40,0x3180,0x5e80,0x4f00,0x27ce0,0x3190,0x5e90,0x4f10,0x27d40,0x31a0,0x5ea0,0x4f20,0x27d40,0x31b0,0x5eb0,0x4f30
.long 0x27d40,0x31c0,0x5ec0,0x4f40,0x27ce0,0x31d0,0x5ed0,0x4f50,0x27d40,0x31e0,0x5ee0,0x4f60,0x27d40,0x31f0,0x5ef0,0x4f70
.long 0x27d40,0x7500,0x6c00,0x4f80,0x27d10,0x7510,0x6c10,0x4f90,0x27d40,0x7520,0x6c20,0x4fa0,0x27d40,0x7530,0x6c30,0x4fb0
.long 0x27d40,0x7540,0x6c40,0x4fc0,0x27d10,0x7550,0x6c50,0x4fd0,0x27d40,0x7560,0x6c60,0x4fe0,0x27d40,0x7570,0x6c70,0x4ff0
.long 0x27d40,0x7980,0x7080,0x5000,0x27d10,0x7990,0x7090,0x5010,0x27d40,0x79a0,0x70a0,0x5020,0x27d40,0x79b0,0x70b0,0x5030
.long 0x27d40,0x79c0,0x70c0,0x5040,0x27d10,0x79d0,0x70d0,0x5050,0x27d40,0x79e0,0x70e0,0x5060,0x27d40,0x79f0,0x70f0,0x5070
.long 0x4c80,0x23f00,0x0,0x0,0x4c90,0x23f00,0x200,0x10,0x4ca0,0x23f00,0x7ffffff0,0x20,0x4cb0,0x23f00,0x7ffffff0,0x30
.long 0x4cc0,0x24720,0x7ffffff0,0x40,0x4cd0,0x24720,0x7ffffff0,0x50,0x4ce0,0x24720,0x7ffffff0,0x60,0x4cf0,0x24720,0x7ffffff0,0x70
.long 0x70000000,0x24f40,0x7ffffff0,0x80,0x70000000,0x24f40,0x7ffffff0,0x90,0x70000000,0x24f40,0x7ffffff0,0xa0,0x70000000,0x24f40,0x7ffffff0,0xb0
.long 0x70000000,0x25760,0x7ffffff0,0xc0,0x70000000,0x25760,0x7ffffff0,0xd0,0x70000000,0x25760,0x7ffffff0,0xe0,0x70000000,0x25760,0x7ffffff0,0xf0
.long 0x70000000,0x23f08,0x7ffffff0,0x4000,0x70000000,0x23f08,0x7ffffff0,0x4010,0x70000000,0x23f08,0x7ffffff0,0x4020,0x70000000,0x23f08,0x7ffffff0,0x4030
.long 0x70000000,0x24728,0x7ffffff0,0x4040,0x70000000,0x24728,0x7ffffff0,0x4050,0x70000000,0x24728,0x7ffffff0,0x4060,0x70000000,0x24728,0x7ffffff0,0x4070
.long 0x70000000,0x24f48,0x7ffffff0,0x4080,0x70000000,0x24f48,0x7ffffff0,0x4090,0x70000000,0x24f48,0x7ffffff0,0x40a0,0x70000000,0x24f48,0x7ffffff0,0x40b0
.long 0x70000000,0x25768,0x7ffffff0,0x40c0,0x70000000,0x25768,0x7ffffff0,0x40d0,0x70000000,0x25768,0x7ffffff0,0x40e0,0x70000000,0x25768,0x7ffffff0,0x40f0
.long 0x70000000,0x23f10,0x7ffffff0,0x8000,0x70000000,0x23f10,0x7ffffff0,0x8010,0x70000000,0x23f10,0x7ffffff0,0x8020,0x70000000,0x23f10,0x7ffffff0,0x8030
.long 0x70000000,0x24730,0x7ffffff0,0x8040,0x70000000,0x24730,0x7ffffff0,0x8050,0x70000000,0x24730,0x7ffffff0,0x8060,0x70000000,0x24730,0x7ffffff0,0x8070
.long 0x70000000,0x24f50,0x7ffffff0,0x8080,0x70000000,0x24f50,0x7ffffff0,0x8090,0x70000000,0x24f50,0x7ffffff0,0x80a0,0x70000000,0x24f50,0x7ffffff0,0x80b0
.long 0x70000000,0x25770,0x7ffffff0,0x80c0,0x70000000,0x25770,0x7ffffff0,0x80d0,0x70000000,0x25770,0x7ffffff0,0x80e0,0x70000000,0x25770,0x7ffffff0,0x80f0
.long 0x70000000,0x23f18,0x7ffffff0,0xc000,0x70000000,0x23f18,0x7ffffff0,0xc010,0x70000000,0x23f18,0x7ffffff0,0xc020,0x70000000,0x23f18,0x7ffffff0,0xc030
.long 0x70000000,0x24738,0x7ffffff0,0xc040,0x70000000,0x24738,0x7ffffff0,0xc050,0x70000000,0x24738,0x7ffffff0,0xc060,0x70000000,0x24738,0x7ffffff0,0xc070
.long 0x70000000,0x24f58,0x7ffffff0,0xc080,0x70000000,0x24f58,0x7ffffff0,0xc090,0x70000000,0x24f58,0x7ffffff0,0xc0a0,0x70000000,0x24f58,0x7ffffff0,0xc0b0
.long 0x70000000,0x25778,0x7ffffff0,0xc0c0,0x70000000,0x25778,0x7ffffff0,0xc0d0,0x70000000,0x25778,0x7ffffff0,0xc0e0,0x70000000,0x25778,0x7ffffff0,0xc0f0
.long 0x0,0x0,0x9000,0x9000,0x8,0x8,0x9480,0x9480,0x10,0x10,0x9900,0x9900,0x18,0x18,0x9d80,0x9d80
.long 0x20,0x20,0xa200,0xa200,0x28,0x28,0xa680,0xa680,0x30,0x30,0xab00,0xab00,0x38,0x38,0xaf80,0xaf80
.long 0x40,0x40,0xb400,0xb400,0x48,0x48,0xb880,0xb880,0x50,0x50,0xbd00,0xbd00,0x58,0x58,0xc180,0xc180
.long 0x60,0x60,0xc600,0xc600,0x68,0x68,0xca80,0xca80,0x70,0x70,0xcf00,0xcf00,0x78,0x78,0xd380,0xd380
.long 0x80,0x0,0x9008,0xd800,0x88,0x8,0x9488,0xdc80,0x90,0x10,0x9908,0xe100,0x98,0x18,0x9d88,0xe580
.long 0xa0,0x20,0xa208,0xea00,0xa8,0x28,0xa688,0xee80,0xb0,0x30,0xab08,0xf300,0xb8,0x38,0xaf88,0xf780
.long 0xc0,0x40,0xb408,0xfc00,0xc8,0x48,0xb888,0x10080,0xd0,0x50,0xbd08,0x10500,0xd8,0x58,0xc188,0x10980
.long 0xe0,0x60,0xc608,0x10e00,0xe8,0x68,0xca88,0x11280,0xf0,0x70,0xcf08,0x11700,0xf8,0x78,0xd388,0x11b80
.long 0x100,0x7ffffff0,0x9010,0x7ffffff0,0x108,0x7ffffff0,0x9490,0x7ffffff0,0x110,0x7ffffff0,0x9910,0x7ffffff0,0x118,0x7ffffff0,0x9d90,0x7ffffff0
.long 0x120,0x7ffffff0,0xa210,0x7ffffff0,0x128,0x7ffffff0,0xa690,0x7ffffff0,0x130,0x7ffffff0,0xab10,0x7ffffff0,0x138,0x7ffffff0,0xaf90,0x7ffffff0
.long 0x140,0x7ffffff0,0xb410,0x7ffffff0,0x148,0x7ffffff0,0xb890,0x7ffffff0,0x150,0x7ffffff0,0xbd10,0x7ffffff0,0x158,0x7ffffff0,0xc190,0x7ffffff0
.long 0x160,0x7ffffff0,0xc610,0x7ffffff0,0x168,0x7ffffff0,0xca90,0x7ffffff0,0x170,0x7ffffff0,0xcf10,0x7ffffff0,0x178,0x7ffffff0,0xd390,0x7ffffff0
.long 0x180,0x7ffffff0,0x9018,0x7ffffff0,0x188,0x7ffffff0,0x9498,0x7ffffff0,0x190,0x7ffffff0,0x9918,0x7ffffff0,0x198,0x7ffffff0,0x9d98,0x7ffffff0
.long 0x1a0,0x7ffffff0,0xa218,0x7ffffff0,0x1a8,0x7ffffff0,0xa698,0x7ffffff0,0x1b0,0x7ffffff0,0xab18,0x7ffffff0,0x1b8,0x7ffffff0,0xaf98,0x7ffffff0
.long 0x1c0,0x7ffffff0,0xb418,0x7ffffff0,0x1c8,0x7ffffff0,0xb898,0x7ffffff0,0x1d0,0x7ffffff0,0xbd18,0x7ffffff0,0x1d8,0x7ffffff0,0xc198,0x7ffffff0
.long 0x1e0,0x7ffffff0,0xc618,0x7ffffff0,0x1e8,0x7ffffff0,0xca98,0x7ffffff0,0x1f0,0x7ffffff0,0xcf18,0x7ffffff0,0x1f8,0x7ffffff0,0xd398,0x7ffffff0
.long 0x18000000,0x0,0x0,0x0,0x18000000,0x8,0x7ffffff0,0x10,0xe40,0x10,0x7ffffff0,0x20,0xf00,0x18,0x7ffffff0,0x30
.long 0x1bc0,0x7ffffff0,0x7ffffff0,0x40,0x18000000,0x7ffffff0,0x7ffffff0,0x50,0x18000000,0x7ffffff0,0x7ffffff0,0x60,0x18000000,0x7ffffff0,0x7ffffff0,0x70
.long 0x18000000,0x7ffffff0,0x7ffffff0,0x80,0x18000000,0x7ffffff0,0x7ffffff0,0x90,0x18000000,0x7ffffff0,0x7ffffff0,0xa0,0x18000000,0x7ffffff0,0x7ffffff0,0xb0
.long 0x18000000,0x7ffffff0,0x7ffffff0,0xc0,0x18000000,0x7ffffff0,0x7ffffff0,0xd0,0x18000000,0x7ffffff0,0x7ffffff0,0xe0,0x18000000,0x7ffffff0,0x7ffffff0,0xf0
.long 0x18000010,0x20,0x7ffffff0,0x100,0x18000010,0x28,0x7ffffff0,0x110,0xe50,0x30,0x7ffffff0,0x120,0xf10,0x38,0x7ffffff0,0x130
.long 0x1bd0,0x7ffffff0,0x7ffffff0,0x140,0x18000010,0x7ffffff0,0x7ffffff0,0x150,0x18000010,0x7ffffff0,0x7ffffff0,0x160,0x18000010,0x7ffffff0,0x7ffffff0,0x170
.long 0x18000010,0x7ffffff0,0x7ffffff0,0x180,0x18000010,0x7ffffff0,0x7ffffff0,0x190,0x18000010,0x7ffffff0,0x7ffffff0,0x1a0,0x18000010,0x7ffffff0,0x7ffffff0,0x1b0
.long 0x18000010,0x7ffffff0,0x7ffffff0,0x1c0,0x18000010,0x7ffffff0,0x7ffffff0,0x1d0,0x18000010,0x7ffffff0,0x7ffffff0,0x1e0,0x18000010,0x7ffffff0,0x7ffffff0,0x1f0
.long 0x18000020,0x4,0x7ffffff0,0x200,0x18000020,0xc,0x7ffffff0,0x210,0xe60,0x14,0x7ffffff0,0x220,0xf20,0x1c,0x7ffffff0,0x230
.long 0x1be0,0x7ffffff0,0x7ffffff0,0x240,0x18000020,0x7ffffff0,0x7ffffff0,0x250,0x18000020,0x7ffffff0,0x7ffffff0,0x260,0x18000020,0x7ffffff0,0x7ffffff0,0x270
.long 0x18000020,0x7ffffff0,0x7ffffff0,0x280,0x18000020,0x7ffffff0,0x7ffffff0,0x290,0x18000020,0x7ffffff0,0x7ffffff0,0x2a0,0x18000020,0x7ffffff0,0x7ffffff0,0x2b0
.long 0x18000020,0x7ffffff0,0x7ffffff0,0x2c0,0x18000020,0x7ffffff0,0x7ffffff0,0x2d0,0x18000020,0x7ffffff0,0x7ffffff0,0x2e0,0x18000020,0x7ffffff0,0x7ffffff0,0x2f0
.long 0x18000030,0x24,0x7ffffff0,0x300,0x18000030,0x2c,0x7ffffff0,0x310,0xe70,0x34,0x7ffffff0,0x320,0xf30,0x3c,0x7ffffff0,0x330
.long 0x1bf0,0x7ffffff0,0x7ffffff0,0x340,0x18000030,0x7ffffff0,0x7ffffff0,0x350,0x18000030,0x7ffffff0,0x7ffffff0,0x360,0x18000030,0x7ffffff0,0x7ffffff0,0x370
.long 0x18000030,0x7ffffff0,0x7ffffff0,0x380,0x18000030,0x7ffffff0,0x7ffffff0,0x390,0x18000030,0x7ffffff0,0x7ffffff0,0x3a0,0x18000030,0x7ffffff0,0x7ffffff0,0x3b0
.long 0x18000030,0x7ffffff0,0x7ffffff0,0x3c0,0x18000030,0x7ffffff0,0x7ffffff0,0x3d0,0x18000030,0x7ffffff0,0x7ffffff0,0x3e0,0x18000030,0x7ffffff0,0x7ffffff0,0x3f0
.long 0x0,0x48000,0x4200,0x1ef00,0x10,0x48010,0x4208,0x1ef08,0x20,0x48020,0x4210,0x1ef10,0x30,0x48030,0x4218,0x1ef18
.long 0x2000,0x4a400,0x4240,0x1efa0,0x2010,0x4a410,0x4248,0x1efa8,0x2020,0x4a420,0x4250,0x1efb0,0x2030,0x4a430,0x4258,0x1efb8
.long 0x4000,0x4c800,0x4280,0x1f040,0x4010,0x4c810,0x4288,0x1f048,0x4020,0x4c820,0x4290,0x1f050,0x4030,0x4c830,0x4298,0x1f058
.long 0x6000,0x4ec00,0x42c0,0x1f0e0,0x6010,0x4ec10,0x42c8,0x1f0e8,0x6020,0x4ec20,0x42d0,0x1f0f0,0x6030,0x4ec30,0x42d8,0x1f0f8
.long 0x40,0x51000,0x4620,0x1f180,0x50,0x51010,0x4628,0x1f188,0x60,0x51020,0x4630,0x1f190,0x70,0x51030,0x4638,0x1f198
.long 0x2040,0x53400,0x4660,0x1f220,0x2050,0x53410,0x4668,0x1f228,0x2060,0x53420,0x4670,0x1f230,0x2070,0x53430,0x4678,0x1f238
.long 0x4040,0x55800,0x46a0,0x1f2c0,0x4050,0x55810,0x46a8,0x1f2c8,0x4060,0x55820,0x46b0,0x1f2d0,0x4070,0x55830,0x46b8,0x1f2d8
.long 0x6040,0x57c00,0x46e0,0x1f360,0x6050,0x57c10,0x46e8,0x1f368,0x6060,0x57c20,0x46f0,0x1f370,0x6070,0x57c30,0x46f8,0x1f378
.long 0x8000,0x6c000,0x4400,0x1f400,0x8010,0x6c010,0x4408,0x1f408,0x8020,0x6c020,0x4410,0x1f410,0x8030,0x6c030,0x4418,0x1f418
.long 0xa000,0x6e400,0x4440,0x1f4a0,0xa010,0x6e410,0x4448,0x1f4a8,0xa020,0x6e420,0x4450,0x1f4b0,0xa030,0x6e430,0x4458,0x1f4b8
.long 0xc000,0x70800,0x4480,0x1f540,0xc010,0x70810,0x4488,0x1f548,0xc020,0x70820,0x4490,0x1f550,0xc030,0x70830,0x4498,0x1f558
.long 0xe000,0x72c00,0x44c0,0x1f5e0,0xe010,0x72c10,0x44c8,0x1f5e8,0xe020,0x72c20,0x44d0,0x1f5f0,0xe030,0x72c30,0x44d8,0x1f5f8
.long 0x8040,0x75000,0x4820,0x1f680,0x8050,0x75010,0x4828,0x1f688,0x8060,0x75020,0x4830,0x1f690,0x8070,0x75030,0x4838,0x1f698
.long 0xa040,0x77400,0x4860,0x1f720,0xa050,0x77410,0x4868,0x1f728,0xa060,0x77420,0x4870,0x1f730,0xa070,0x77430,0x4878,0x1f738
.long 0xc040,0x79800,0x48a0,0x1f7c0,0xc050,0x79810,0x48a8,0x1f7c8,0xc060,0x79820,0x48b0,0x1f7d0,0xc070,0x79830,0x48b8,0x1f7d8
.long 0xe040,0x7bc00,0x48e0,0x1f860,0xe050,0x7bc10,0x48e8,0x1f868,0xe060,0x7bc20,0x48f0,0x1f870,0xe070,0x7bc30,0x48f8,0x1f878
.long 0x1ef40,0x20300,0x20580,0x21780,0x1ef48,0x20308,0x20588,0x21820,0x1ef50,0x20310,0x20590,0x218c0,0x1ef58,0x20318,0x20598,0x21960
.long 0x1efe0,0x203a0,0x20620,0x21a00,0x1efe8,0x203a8,0x20628,0x21aa0,0x1eff0,0x203b0,0x20630,0x21b40,0x1eff8,0x203b8,0x20638,0x21be0
.long 0x1f080,0x20440,0x206c0,0x21c88,0x1f088,0x20448,0x206c8,0x21d28,0x1f090,0x20450,0x206d0,0x21dc8,0x1f098,0x20458,0x206d8,0x21e68
.long 0x1f120,0x204e0,0x20760,0x21f08,0x1f128,0x204e8,0x20768,0x21fa8,0x1f130,0x204f0,0x20770,0x22048,0x1f138,0x204f8,0x20778,0x220e8
.long 0x1f1c0,0x20580,0x20300,0x217a8,0x1f1c8,0x20588,0x20308,0x21848,0x1f1d0,0x20590,0x20310,0x218e8,0x1f1d8,0x20598,0x20318,0x21988
.long 0x1f260,0x20620,0x203a0,0x21a28,0x1f268,0x20628,0x203a8,0x21ac8,0x1f270,0x20630,0x203b0,0x21b68,0x1f278,0x20638,0x203b8,0x21c08
.long 0x1f300,0x206c0,0x20440,0x21cb0,0x1f308,0x206c8,0x20448,0x21d50,0x1f310,0x206d0,0x20450,0x21df0,0x1f318,0x206d8,0x20458,0x21e90
.long 0x1f3a0,0x20760,0x204e0,0x21f30,0x1f3a8,0x20768,0x204e8,0x21fd0,0x1f3b0,0x20770,0x204f0,0x22070,0x1f3b8,0x20778,0x204f8,0x22110
.long 0x1f448,0x20580,0x20580,0x217d0,0x1f450,0x20588,0x20588,0x21870,0x1f458,0x20590,0x20590,0x21910,0x1f460,0x20598,0x20598,0x219b0
.long 0x1f4e8,0x20620,0x20620,0x21a50,0x1f4f0,0x20628,0x20628,0x21af0,0x1f4f8,0x20630,0x20630,0x21b90,0x1f500,0x20638,0x20638,0x21c30
.long 0x1f588,0x206c0,0x206c0,0x21cd8,0x1f590,0x206c8,0x206c8,0x21d78,0x1f598,0x206d0,0x206d0,0x21e18,0x1f5a0,0x206d8,0x206d8,0x21eb8
.long 0x1f628,0x20760,0x20760,0x21f58,0x1f630,0x20768,0x20768,0x21ff8,0x1f638,0x20770,0x20770,0x22098,0x1f640,0x20778,0x20778,0x22138
.long 0x1f6c8,0x20580,0x20580,0x217f8,0x1f6d0,0x20588,0x20588,0x21898,0x1f6d8,0x20590,0x20590,0x21938,0x1f6e0,0x20598,0x20598,0x219d8
.long 0x1f768,0x20620,0x20620,0x21a78,0x1f770,0x20628,0x20628,0x21b18,0x1f778,0x20630,0x20630,0x21bb8,0x1f780,0x20638,0x20638,0x21c58
.long 0x1f808,0x206c0,0x206c0,0x21d00,0x1f810,0x206c8,0x206c8,0x21da0,0x1f818,0x206d0,0x206d0,0x21e40,0x1f820,0x206d8,0x206d8,0x21ee0
.long 0x1f8a8,0x20760,0x20760,0x21f80,0x1f8b0,0x20768,0x20768,0x22020,0x1f8b8,0x20770,0x20770,0x220c0,0x1f8c0,0x20778,0x20778,0x22160
.long 0x25880,0x258d0,0x24020,0x800,0x258e0,0x25930,0x24048,0x810,0x25940,0x25990,0x24048,0x820,0x259a0,0x259f0,0x24048,0x830
.long 0x25a00,0x25a50,0x24080,0x840,0x25a60,0x25ab0,0x240a8,0x850,0x25ac0,0x25b10,0x240a8,0x860,0x25b20,0x25b70,0x240a8,0x870
.long 0x25b88,0x25bd8,0x240e0,0x880,0x25be8,0x25c38,0x24108,0x890,0x25c48,0x25c98,0x24108,0x8a0,0x25ca8,0x25cf8,0x24108,0x8b0
.long 0x25d08,0x25d58,0x24140,0x8c0,0x25d68,0x25db8,0x24168,0x8d0,0x25dc8,0x25e18,0x24168,0x8e0,0x25e28,0x25e78,0x24168,0x8f0
.long 0x25888,0x258d8,0x241a0,0x900,0x258e8,0x25938,0x241c8,0x910,0x25948,0x25998,0x241c8,0x920,0x259a8,0x259f8,0x241c8,0x930
.long 0x25a08,0x25a58,0x24200,0x940,0x25a68,0x25ab8,0x24228,0x950,0x25ac8,0x25b18,0x24228,0x960,0x25b28,0x25b78,0x24228,0x970
.long 0x25b90,0x25be0,0x24260,0x980,0x25bf0,0x25c40,0x24288,0x990,0x25c50,0x25ca0,0x24288,0x9a0,0x25cb0,0x25d00,0x24288,0x9b0
.long 0x25d10,0x25d60,0x242c0,0x9c0,0x25d70,0x25dc0,0x242e8,0x9d0,0x25dd0,0x25e20,0x242e8,0x9e0,0x25e30,0x25e80,0x242e8,0x9f0
.long 0x25890,0x258c0,0x24328,0xa00,0x258f0,0x25920,0x24350,0xa10,0x25950,0x25980,0x24350,0xa20,0x259b0,0x259e0,0x24350,0xa30
.long 0x25a10,0x25a40,0x24388,0xa40,0x25a70,0x25aa0,0x243b0,0xa50,0x25ad0,0x25b00,0x243b0,0xa60,0x25b30,0x25b60,0x243b0,0xa70
.long 0x25b98,0x25bc8,0x243e8,0xa80,0x25bf8,0x25c28,0x24410,0xa90,0x25c58,0x25c88,0x24410,0xaa0,0x25cb8,0x25ce8,0x24410,0xab0
.long 0x25d18,0x25d48,0x24448,0xac0,0x25d78,0x25da8,0x24470,0xad0,0x25dd8,0x25e08,0x24470,0xae0,0x25e38,0x25e68,0x24470,0xaf0
.long 0x25898,0x258c8,0x244a8,0xb00,0x258f8,0x25928,0x244d0,0xb10,0x25958,0x25988,0x244d0,0xb20,0x259b8,0x259e8,0x244d0,0xb30
.long 0x25a18,0x25a48,0x24508,0xb40,0x25a78,0x25aa8,0x24530,0xb50,0x25ad8,0x25b08,0x24530,0xb60,0x25b38,0x25b68,0x24530,0xb70
.long 0x25ba0,0x25bd0,0x24568,0xb80,0x25c00,0x25c30,0x24590,0xb90,0x25c60,0x25c90,0x24590,0xba0,0x25cc0,0x25cf0,0x24590,0xbb0
.long 0x25d20,0x25d50,0x245c8,0xbc0,0x25d80,0x25db0,0x245f0,0xbd0,0x25de0,0x25e10,0x245f0,0xbe0,0x25e40,0x25e70,0x245f0,0xbf0
.long 0x276f0,0x276f8,0x26f00,0x27200,0x27700,0x27710,0x26f60,0x27560,0x27718,0x27720,0x26fc0,0x27d40,0x27728,0x27730,0x27020,0x27d40
.long 0x27f40,0x27f40,0x27260,0x27200,0x27740,0x27748,0x272c0,0x27560,0x27750,0x27758,0x27320,0x27d40,0x27760,0x27770,0x27380,0x27d40
.long 0x27778,0x27780,0x27d40,0x27200,0x27788,0x27790,0x27d40,0x27560,0x27f40,0x27f40,0x27d40,0x27d40,0x277a0,0x277a8,0x27d40,0x27d40
.long 0x277b0,0x277b8,0x27d40,0x27200,0x277c0,0x277d0,0x27d40,0x27560,0x277d8,0x277e0,0x27d40,0x27d40,0x277e8,0x277f0,0x27d40,0x27d40
.long 0x27f40,0x27f40,0x26f30,0x27230,0x27800,0x27808,0x26f90,0x27590,0x27810,0x27818,0x26ff0,0x27d40,0x27820,0x27830,0x27050,0x27d40
.long 0x27838,0x27840,0x27290,0x27230,0x27848,0x27850,0x272f0,0x27590,0x27f40,0x27f40,0x27350,0x27d40,0x27860,0x27868,0x273b0,0x27d40
.long 0x27870,0x27878,0x27d40,0x27230,0x27880,0x27890,0x27d40,0x27590,0x27898,0x278a0,0x27d40,0x27d40,0x278a8,0x278b0,0x27d40,0x27d40
.long 0x27f40,0x27f40,0x27d40,0x27230,0x278c0,0x278c8,0x27d40,0x27590,0x278d0,0x278d8,0x27d40,0x27d40,0x278e0,0x278f0,0x27d40,0x27d40
.long 0x278f8,0x27900,0x27d40,0x27d40,0x27908,0x27910,0x27d40,0x27d40,0x27f40,0x27f40,0x27d40,0x27920,0x27920,0x27928,0x27d40,0x27c80
.long 0x27930,0x27938,0x27d40,0x27d40,0x27940,0x27950,0x27d40,0x27d40,0x27958,0x27960,0x27d40,0x27920,0x27968,0x27970,0x27d40,0x27c80
.long 0x27f40,0x27f40,0x27620,0x27d40,0x27980,0x27988,0x27680,0x27d40,0x27990,0x27998,0x276e0,0x27920,0x279a0,0x279b0,0x27740,0x27c80
.long 0x279b8,0x279c0,0x27980,0x27d40,0x279c8,0x279d0,0x279e0,0x27d40,0x27f40,0x27f40,0x27a40,0x27920,0x279e0,0x279e8,0x27aa0,0x27c80
.long 0x279f0,0x279f8,0x27d40,0x27d40,0x27a00,0x27a10,0x27d40,0x27d40,0x27a18,0x27a20,0x27d40,0x27950,0x27a28,0x27a30,0x27d40,0x27cb0
.long 0x27f40,0x27f40,0x27d40,0x27d40,0x27a40,0x27a48,0x27d40,0x27d40,0x27a50,0x27a58,0x27d40,0x27950,0x27a60,0x27a70,0x27d40,0x27cb0
.long 0x27a78,0x27a80,0x27650,0x27d40,0x27a88,0x27a90,0x276b0,0x27d40,0x27f40,0x27f40,0x27710,0x27950,0x27aa0,0x27aa8,0x27770,0x27cb0
.long 0x27ab0,0x27ab8,0x279b0,0x27d40,0x27ac0,0x27ad0,0x27a10,0x27d40,0x27ad8,0x27ae0,0x27a70,0x27950,0x27ae8,0x27af0,0x27ad0,0x27cb0
.long 0x275c0,0x1200,0x2880,0x7500,0x27d40,0x1210,0x2890,0x7510,0x27d40,0x1220,0x28a0,0x7520,0x27d40,0x1230,0x28b0,0x7530
.long 0x275c0,0x1240,0x28c0,0x7540,0x27d40,0x1250,0x28d0,0x7550,0x27d40,0x1260,0x28e0,0x7560,0x27d40,0x1270,0x28f0,0x7570
.long 0x275c0,0x1680,0x2d00,0x7580,0x27d40,0x1690,0x2d10,0x7590,0x27d40,0x16a0,0x2d20,0x75a0,0x27d40,0x16b0,0x2d30,0x75b0
.long 0x275c0,0x16c0,0x2d40,0x75c0,0x27d40,0x16d0,0x2d50,0x75d0,0x27d40,0x16e0,0x2d60,0x75e0,0x27d40,0x16f0,0x2d70,0x75f0
.long 0x275f0,0x5a00,0x3a80,0x7600,0x27d40,0x5a10,0x3a90,0x7610,0x27d40,0x5a20,0x3aa0,0x7620,0x27d40,0x5a30,0x3ab0,0x7630
.long 0x275f0,0x5a40,0x3ac0,0x7640,0x27d40,0x5a50,0x3ad0,0x7650,0x27d40,0x5a60,0x3ae0,0x7660,0x27d40,0x5a70,0x3af0,0x7670
.long 0x275f0,0x5e80,0x3f00,0x7680,0x27d40,0x5e90,0x3f10,0x7690,0x27d40,0x5ea0,0x3f20,0x76a0,0x27d40,0x5eb0,0x3f30,0x76b0
.long 0x275f0,0x5ec0,0x3f40,0x76c0,0x27d40,0x5ed0,0x3f50,0x76d0,0x27d40,0x5ee0,0x3f60,0x76e0,0x27d40,0x5ef0,0x3f70,0x76f0
.long 0x27d40,0x3600,0x7980,0x7700,0x27ce0,0x3610,0x7990,0x7710,0x27d40,0x3620,0x79a0,0x7720,0x27d40,0x3630,0x79b0,0x7730
.long 0x27d40,0x3640,0x79c0,0x7740,0x27ce0,0x3650,0x79d0,0x7750,0x27d40,0x3660,0x79e0,0x7760,0x27d40,0x3670,0x79f0,0x7770
.long 0x27d40,0x3a80,0x7e00,0x7780,0x27ce0,0x3a90,0x7e10,0x7790,0x27d40,0x3aa0,0x7e20,0x77a0,0x27d40,0x3ab0,0x7e30,0x77b0
.long 0x27d40,0x3ac0,0x7e40,0x77c0,0x27ce0,0x3ad0,0x7e50,0x77d0,0x27d40,0x3ae0,0x7e60,0x77e0,0x27d40,0x3af0,0x7e70,0x77f0
.long 0x27d40,0x7e00,0x8b80,0x7800,0x27d10,0x7e10,0x8b90,0x7810,0x27d40,0x7e20,0x8ba0,0x7820,0x27d40,0x7e30,0x8bb0,0x7830
.long 0x27d40,0x7e40,0x8bc0,0x7840,0x27d10,0x7e50,0x8bd0,0x7850,0x27d40,0x7e60,0x8be0,0x7860,0x27d40,0x7e70,0x8bf0,0x7870
.long 0x27d40,0x8280,0x9000,0x7880,0x27d10,0x8290,0x9010,0x7890,0x27d40,0x82a0,0x9020,0x78a0,0x27d40,0x82b0,0x9030,0x78b0
.long 0x27d40,0x82c0,0x9040,0x78c0,0x27d10,0x82d0,0x9050,0x78d0,0x27d40,0x82e0,0x9060,0x78e0,0x27d40,0x82f0,0x9070,0x78f0
.long 0x7500,0x23f00,0x0,0x0,0x7510,0x23f00,0x200,0x10,0x7520,0x23f00,0x7ffffff0,0x20,0x7530,0x23f00,0x7ffffff0,0x30
.long 0x7540,0x24720,0x7ffffff0,0x40,0x7550,0x24720,0x7ffffff0,0x50,0x7560,0x24720,0x7ffffff0,0x60,0x7570,0x24720,0x7ffffff0,0x70
.long 0x70000000,0x24f40,0x7ffffff0,0x80,0x70000000,0x24f40,0x7ffffff0,0x90,0x70000000,0x24f40,0x7ffffff0,0xa0,0x70000000,0x24f40,0x7ffffff0,0xb0
.long 0x70000000,0x25760,0x7ffffff0,0xc0,0x70000000,0x25760,0x7ffffff0,0xd0,0x70000000,0x25760,0x7ffffff0,0xe0,0x70000000,0x25760,0x7ffffff0,0xf0
.long 0x70000000,0x23f08,0x7ffffff0,0x4000,0x70000000,0x23f08,0x7ffffff0,0x4010,0x70000000,0x23f08,0x7ffffff0,0x4020,0x70000000,0x23f08,0x7ffffff0,0x4030
.long 0x70000000,0x24728,0x7ffffff0,0x4040,0x70000000,0x24728,0x7ffffff0,0x4050,0x70000000,0x24728,0x7ffffff0,0x4060,0x70000000,0x24728,0x7ffffff0,0x4070
.long 0x70000000,0x24f48,0x7ffffff0,0x4080,0x70000000,0x24f48,0x7ffffff0,0x4090,0x70000000,0x24f48,0x7ffffff0,0x40a0,0x70000000,0x24f48,0x7ffffff0,0x40b0
.long 0x70000000,0x25768,0x7ffffff0,0x40c0,0x70000000,0x25768,0x7ffffff0,0x40d0,0x70000000,0x25768,0x7ffffff0,0x40e0,0x70000000,0x25768,0x7ffffff0,0x40f0
.long 0x70000000,0x23f10,0x7ffffff0,0x8000,0x70000000,0x23f10,0x7ffffff0,0x8010,0x70000000,0x23f10,0x7ffffff0,0x8020,0x70000000,0x23f10,0x7ffffff0,0x8030
.long 0x70000000,0x24730,0x7ffffff0,0x8040,0x70000000,0x24730,0x7ffffff0,0x8050,0x70000000,0x24730,0x7ffffff0,0x8060,0x70000000,0x24730,0x7ffffff0,0x8070
.long 0x70000000,0x24f50,0x7ffffff0,0x8080,0x70000000,0x24f50,0x7ffffff0,0x8090,0x70000000,0x24f50,0x7ffffff0,0x80a0,0x70000000,0x24f50,0x7ffffff0,0x80b0
.long 0x70000000,0x25770,0x7ffffff0,0x80c0,0x70000000,0x25770,0x7ffffff0,0x80d0,0x70000000,0x25770,0x7ffffff0,0x80e0,0x70000000,0x25770,0x7ffffff0,0x80f0
.long 0x70000000,0x23f18,0x7ffffff0,0xc000,0x70000000,0x23f18,0x7ffffff0,0xc010,0x70000000,0x23f18,0x7ffffff0,0xc020,0x70000000,0x23f18,0x7ffffff0,0xc030
.long 0x70000000,0x24738,0x7ffffff0,0xc040,0x70000000,0x24738,0x7ffffff0,0xc050,0x70000000,0x24738,0x7ffffff0,0xc060,0x70000000,0x24738,0x7ffffff0,0xc070
.long 0x70000000,0x24f58,0x7ffffff0,0xc080,0x70000000,0x24f58,0x7ffffff0,0xc090,0x70000000,0x24f58,0x7ffffff0,0xc0a0,0x70000000,0x24f58,0x7ffffff0,0xc0b0
.long 0x70000000,0x25778,0x7ffffff0,0xc0c0,0x70000000,0x25778,0x7ffffff0,0xc0d0,0x70000000,0x25778,0x7ffffff0,0xc0e0,0x70000000,0x25778,0x7ffffff0,0xc0f0
.long 0x0,0x0,0x12000,0x12000,0x8,0x8,0x12480,0x12480,0x10,0x10,0x12900,0x12900,0x18,0x18,0x12d80,0x12d80
.long 0x20,0x20,0x13200,0x13200,0x28,0x28,0x13680,0x13680,0x30,0x30,0x13b00,0x13b00,0x38,0x38,0x13f80,0x13f80
.long 0x40,0x40,0x14400,0x14400,0x48,0x48,0x14880,0x14880,0x50,0x50,0x14d00,0x14d00,0x58,0x58,0x15180,0x15180
.long 0x60,0x60,0x15600,0x15600,0x68,0x68,0x15a80,0x15a80,0x70,0x70,0x15f00,0x15f00,0x78,0x78,0x16380,0x16380
.long 0x80,0x0,0x12008,0x16800,0x88,0x8,0x12488,0x16c80,0x90,0x10,0x12908,0x17100,0x98,0x18,0x12d88,0x17580
.long 0xa0,0x20,0x13208,0x17a00,0xa8,0x28,0x13688,0x17e80,0xb0,0x30,0x13b08,0x18300,0xb8,0x38,0x13f88,0x18780
.long 0xc0,0x40,0x14408,0x18c00,0xc8,0x48,0x14888,0x19080,0xd0,0x50,0x14d08,0x19500,0xd8,0x58,0x15188,0x19980
.long 0xe0,0x60,0x15608,0x19e00,0xe8,0x68,0x15a88,0x1a280,0xf0,0x70,0x15f08,0x1a700,0xf8,0x78,0x16388,0x1ab80
.long 0x100,0x7ffffff0,0x12010,0x7ffffff0,0x108,0x7ffffff0,0x12490,0x7ffffff0,0x110,0x7ffffff0,0x12910,0x7ffffff0,0x118,0x7ffffff0,0x12d90,0x7ffffff0
.long 0x120,0x7ffffff0,0x13210,0x7ffffff0,0x128,0x7ffffff0,0x13690,0x7ffffff0,0x130,0x7ffffff0,0x13b10,0x7ffffff0,0x138,0x7ffffff0,0x13f90,0x7ffffff0
.long 0x140,0x7ffffff0,0x14410,0x7ffffff0,0x148,0x7ffffff0,0x14890,0x7ffffff0,0x150,0x7ffffff0,0x14d10,0x7ffffff0,0x158,0x7ffffff0,0x15190,0x7ffffff0
.long 0x160,0x7ffffff0,0x15610,0x7ffffff0,0x168,0x7ffffff0,0x15a90,0x7ffffff0,0x170,0x7ffffff0,0x15f10,0x7ffffff0,0x178,0x7ffffff0,0x16390,0x7ffffff0
.long 0x180,0x7ffffff0,0x12018,0x7ffffff0,0x188,0x7ffffff0,0x12498,0x7ffffff0,0x190,0x7ffffff0,0x12918,0x7ffffff0,0x198,0x7ffffff0,0x12d98,0x7ffffff0
.long 0x1a0,0x7ffffff0,0x13218,0x7ffffff0,0x1a8,0x7ffffff0,0x13698,0x7ffffff0,0x1b0,0x7ffffff0,0x13b18,0x7ffffff0,0x1b8,0x7ffffff0,0x13f98,0x7ffffff0
.long 0x1c0,0x7ffffff0,0x14418,0x7ffffff0,0x1c8,0x7ffffff0,0x14898,0x7ffffff0,0x1d0,0x7ffffff0,0x14d18,0x7ffffff0,0x1d8,0x7ffffff0,0x15198,0x7ffffff0
.long 0x1e0,0x7ffffff0,0x15618,0x7ffffff0,0x1e8,0x7ffffff0,0x15a98,0x7ffffff0,0x1f0,0x7ffffff0,0x15f18,0x7ffffff0,0x1f8,0x7ffffff0,0x16398,0x7ffffff0
.long 0xfc0,0x0,0x0,0x0,0x1080,0x8,0x7ffffff0,0x10,0x1140,0x10,0x7ffffff0,0x20,0x1200,0x18,0x7ffffff0,0x30
.long 0x12c0,0x7ffffff0,0x7ffffff0,0x40,0x1380,0x7ffffff0,0x7ffffff0,0x50,0x1440,0x7ffffff0,0x7ffffff0,0x60,0x1500,0x7ffffff0,0x7ffffff0,0x70
.long 0x15c0,0x7ffffff0,0x7ffffff0,0x80,0x1680,0x7ffffff0,0x7ffffff0,0x90,0x1740,0x7ffffff0,0x7ffffff0,0xa0,0x1800,0x7ffffff0,0x7ffffff0,0xb0
.long 0x18c0,0x7ffffff0,0x7ffffff0,0xc0,0x1980,0x7ffffff0,0x7ffffff0,0xd0,0x1a40,0x7ffffff0,0x7ffffff0,0xe0,0x1b00,0x7ffffff0,0x7ffffff0,0xf0
.long 0xfd0,0x20,0x7ffffff0,0x100,0x1090,0x28,0x7ffffff0,0x110,0x1150,0x30,0x7ffffff0,0x120,0x1210,0x38,0x7ffffff0,0x130
.long 0x12d0,0x7ffffff0,0x7ffffff0,0x140,0x1390,0x7ffffff0,0x7ffffff0,0x150,0x1450,0x7ffffff0,0x7ffffff0,0x160,0x1510,0x7ffffff0,0x7ffffff0,0x170
.long 0x15d0,0x7ffffff0,0x7ffffff0,0x180,0x1690,0x7ffffff0,0x7ffffff0,0x190,0x1750,0x7ffffff0,0x7ffffff0,0x1a0,0x1810,0x7ffffff0,0x7ffffff0,0x1b0
.long 0x18d0,0x7ffffff0,0x7ffffff0,0x1c0,0x1990,0x7ffffff0,0x7ffffff0,0x1d0,0x1a50,0x7ffffff0,0x7ffffff0,0x1e0,0x1b10,0x7ffffff0,0x7ffffff0,0x1f0
.long 0xfe0,0x4,0x7ffffff0,0x200,0x10a0,0xc,0x7ffffff0,0x210,0x1160,0x14,0x7ffffff0,0x220,0x1220,0x1c,0x7ffffff0,0x230
.long 0x12e0,0x7ffffff0,0x7ffffff0,0x240,0x13a0,0x7ffffff0,0x7ffffff0,0x250,0x1460,0x7ffffff0,0x7ffffff0,0x260,0x1520,0x7ffffff0,0x7ffffff0,0x270
.long 0x15e0,0x7ffffff0,0x7ffffff0,0x280,0x16a0,0x7ffffff0,0x7ffffff0,0x290,0x1760,0x7ffffff0,0x7ffffff0,0x2a0,0x1820,0x7ffffff0,0x7ffffff0,0x2b0
.long 0x18e0,0x7ffffff0,0x7ffffff0,0x2c0,0x19a0,0x7ffffff0,0x7ffffff0,0x2d0,0x1a60,0x7ffffff0,0x7ffffff0,0x2e0,0x1b20,0x7ffffff0,0x7ffffff0,0x2f0
.long 0xff0,0x24,0x7ffffff0,0x300,0x10b0,0x2c,0x7ffffff0,0x310,0x1170,0x34,0x7ffffff0,0x320,0x1230,0x3c,0x7ffffff0,0x330
.long 0x12f0,0x7ffffff0,0x7ffffff0,0x340,0x13b0,0x7ffffff0,0x7ffffff0,0x350,0x1470,0x7ffffff0,0x7ffffff0,0x360,0x1530,0x7ffffff0,0x7ffffff0,0x370
.long 0x15f0,0x7ffffff0,0x7ffffff0,0x380,0x16b0,0x7ffffff0,0x7ffffff0,0x390,0x1770,0x7ffffff0,0x7ffffff0,0x3a0,0x1830,0x7ffffff0,0x7ffffff0,0x3b0
.long 0x18f0,0x7ffffff0,0x7ffffff0,0x3c0,0x19b0,0x7ffffff0,0x7ffffff0,0x3d0,0x1a70,0x7ffffff0,0x7ffffff0,0x3e0,0x1b30,0x7ffffff0,0x7ffffff0,0x3f0
.long 0x0,0x5a000,0x4200,0x1ef00,0x10,0x5a010,0x4208,0x1ef08,0x20,0x5a020,0x4210,0x1ef10,0x30,0x5a030,0x4218,0x1ef18
.long 0x2000,0x5c400,0x4240,0x1efa0,0x2010,0x5c410,0x4248,0x1efa8,0x2020,0x5c420,0x4250,0x1efb0,0x2030,0x5c430,0x4258,0x1efb8
.long 0x4000,0x5e800,0x4280,0x1f040,0x4010,0x5e810,0x4288,0x1f048,0x4020,0x5e820,0x4290,0x1f050,0x4030,0x5e830,0x4298,0x1f058
.long 0x6000,0x60c00,0x42c0,0x1f0e0,0x6010,0x60c10,0x42c8,0x1f0e8,0x6020,0x60c20,0x42d0,0x1f0f0,0x6030,0x60c30,0x42d8,0x1f0f8
.long 0x40,0x63000,0x4620,0x1f180,0x50,0x63010,0x4628,0x1f188,0x60,0x63020,0x4630,0x1f190,0x70,0x63030,0x4638,0x1f198
.long 0x2040,0x65400,0x4660,0x1f220,0x2050,0x65410,0x4668,0x1f228,0x2060,0x65420,0x4670,0x1f230,0x2070,0x65430,0x4678,0x1f238
.long 0x4040,0x67800,0x46a0,0x1f2c0,0x4050,0x67810,0x46a8,0x1f2c8,0x4060,0x67820,0x46b0,0x1f2d0,0x4070,0x67830,0x46b8,0x1f2d8
.long 0x6040,0x69c00,0x46e0,0x1f360,0x6050,0x69c10,0x46e8,0x1f368,0x6060,0x69c20,0x46f0,0x1f370,0x6070,0x69c30,0x46f8,0x1f378
.long 0x8000,0x7e000,0x4400,0x1f400,0x8010,0x7e010,0x4408,0x1f408,0x8020,0x7e020,0x4410,0x1f410,0x8030,0x7e030,0x4418,0x1f418
.long 0xa000,0x80400,0x4440,0x1f4a0,0xa010,0x80410,0x4448,0x1f4a8,0xa020,0x80420,0x4450,0x1f4b0,0xa030,0x80430,0x4458,0x1f4b8
.long 0xc000,0x82800,0x4480,0x1f540,0xc010,0x82810,0x4488,0x1f548,0xc020,0x82820,0x4490,0x1f550,0xc030,0x82830,0x4498,0x1f558
.long 0xe000,0x84c00,0x44c0,0x1f5e0,0xe010,0x84c10,0x44c8,0x1f5e8,0xe020,0x84c20,0x44d0,0x1f5f0,0xe030,0x84c30,0x44d8,0x1f5f8
.long 0x8040,0x87000,0x4820,0x1f680,0x8050,0x87010,0x4828,0x1f688,0x8060,0x87020,0x4830,0x1f690,0x8070,0x87030,0x4838,0x1f698
.long 0xa040,0x89400,0x4860,0x1f720,0xa050,0x89410,0x4868,0x1f728,0xa060,0x89420,0x4870,0x1f730,0xa070,0x89430,0x4878,0x1f738
.long 0xc040,0x8b800,0x48a0,0x1f7c0,0xc050,0x8b810,0x48a8,0x1f7c8,0xc060,0x8b820,0x48b0,0x1f7d0,0xc070,0x8b830,0x48b8,0x1f7d8
.long 0xe040,0x8dc00,0x48e0,0x1f860,0xe050,0x8dc10,0x48e8,0x1f868,0xe060,0x8dc20,0x48f0,0x1f870,0xe070,0x8dc30,0x48f8,0x1f878
.long 0x1ef40,0x20300,0x20580,0x22bc0,0x1ef48,0x20308,0x20588,0x22c60,0x1ef50,0x20310,0x20590,0x22d00,0x1ef58,0x20318,0x20598,0x22da0
.long 0x1efe0,0x203a0,0x20620,0x22e40,0x1efe8,0x203a8,0x20628,0x22ee0,0x1eff0,0x203b0,0x20630,0x22f80,0x1eff8,0x203b8,0x20638,0x23020
.long 0x1f080,0x20440,0x206c0,0x230c8,0x1f088,0x20448,0x206c8,0x23168,0x1f090,0x20450,0x206d0,0x23208,0x1f098,0x20458,0x206d8,0x232a8
.long 0x1f120,0x204e0,0x20760,0x23348,0x1f128,0x204e8,0x20768,0x233e8,0x1f130,0x204f0,0x20770,0x23488,0x1f138,0x204f8,0x20778,0x23528
.long 0x1f1c0,0x20580,0x20300,0x22be8,0x1f1c8,0x20588,0x20308,0x22c88,0x1f1d0,0x20590,0x20310,0x22d28,0x1f1d8,0x20598,0x20318,0x22dc8
.long 0x1f260,0x20620,0x203a0,0x22e68,0x1f268,0x20628,0x203a8,0x22f08,0x1f270,0x20630,0x203b0,0x22fa8,0x1f278,0x20638,0x203b8,0x23048
.long 0x1f300,0x206c0,0x20440,0x230f0,0x1f308,0x206c8,0x20448,0x23190,0x1f310,0x206d0,0x20450,0x23230,0x1f318,0x206d8,0x20458,0x232d0
.long 0x1f3a0,0x20760,0x204e0,0x23370,0x1f3a8,0x20768,0x204e8,0x23410,0x1f3b0,0x20770,0x204f0,0x234b0,0x1f3b8,0x20778,0x204f8,0x23550
.long 0x1f448,0x20580,0x20580,0x22c10,0x1f450,0x20588,0x20588,0x22cb0,0x1f458,0x20590,0x20590,0x22d50,0x1f460,0x20598,0x20598,0x22df0
.long 0x1f4e8,0x20620,0x20620,0x22e90,0x1f4f0,0x20628,0x20628,0x22f30,0x1f4f8,0x20630,0x20630,0x22fd0,0x1f500,0x20638,0x20638,0x23070
.long 0x1f588,0x206c0,0x206c0,0x23118,0x1f590,0x206c8,0x206c8,0x231b8,0x1f598,0x206d0,0x206d0,0x23258,0x1f5a0,0x206d8,0x206d8,0x232f8
.long 0x1f628,0x20760,0x20760,0x23398,0x1f630,0x20768,0x20768,0x23438,0x1f638,0x20770,0x20770,0x234d8,0x1f640,0x20778,0x20778,0x23578
.long 0x1f6c8,0x20580,0x20580,0x22c38,0x1f6d0,0x20588,0x20588,0x22cd8,0x1f6d8,0x20590,0x20590,0x22d78,0x1f6e0,0x20598,0x20598,0x22e18
.long 0x1f768,0x20620,0x20620,0x22eb8,0x1f770,0x20628,0x20628,0x22f58,0x1f778,0x20630,0x20630,0x22ff8,0x1f780,0x20638,0x20638,0x23098
.long 0x1f808,0x206c0,0x206c0,0x23140,0x1f810,0x206c8,0x206c8,0x231e0,0x1f818,0x206d0,0x206d0,0x23280,0x1f820,0x206d8,0x206d8,0x23320
.long 0x1f8a8,0x20760,0x20760,0x233c0,0x1f8b0,0x20768,0x20768,0x23460,0x1f8b8,0x20770,0x20770,0x23500,0x1f8c0,0x20778,0x20778,0x235a0
.long 0x264c0,0x26510,0x24028,0xc00,0x26520,0x26570,0x24030,0xc10,0x26580,0x265d0,0x24038,0xc20,0x265e0,0x26630,0x24040,0xc30
.long 0x26640,0x26690,0x24088,0xc40,0x266a0,0x266f0,0x24090,0xc50,0x26700,0x26750,0x24098,0xc60,0x26760,0x267b0,0x240a0,0xc70
.long 0x267c8,0x26818,0x240e8,0xc80,0x26828,0x26878,0x240f0,0xc90,0x26888,0x268d8,0x240f8,0xca0,0x268e8,0x26938,0x24100,0xcb0
.long 0x26948,0x26998,0x24148,0xcc0,0x269a8,0x269f8,0x24150,0xcd0,0x26a08,0x26a58,0x24158,0xce0,0x26a68,0x26ab8,0x24160,0xcf0
.long 0x264c8,0x26518,0x241a8,0xd00,0x26528,0x26578,0x241b0,0xd10,0x26588,0x265d8,0x241b8,0xd20,0x265e8,0x26638,0x241c0,0xd30
.long 0x26648,0x26698,0x24208,0xd40,0x266a8,0x266f8,0x24210,0xd50,0x26708,0x26758,0x24218,0xd60,0x26768,0x267b8,0x24220,0xd70
.long 0x267d0,0x26820,0x24268,0xd80,0x26830,0x26880,0x24270,0xd90,0x26890,0x268e0,0x24278,0xda0,0x268f0,0x26940,0x24280,0xdb0
.long 0x26950,0x269a0,0x242c8,0xdc0,0x269b0,0x26a00,0x242d0,0xdd0,0x26a10,0x26a60,0x242d8,0xde0,0x26a70,0x26ac0,0x242e0,0xdf0
.long 0x264d0,0x26500,0x24330,0xe00,0x26530,0x26560,0x24338,0xe10,0x26590,0x265c0,0x24340,0xe20,0x265f0,0x26620,0x24348,0xe30
.long 0x26650,0x26680,0x24390,0xe30,0x266b0,0x266e0,0x24398,0xe30,0x26710,0x26740,0x243a0,0xe30,0x26770,0x267a0,0x243a8,0xe30
.long 0x267d8,0x26808,0x243f0,0xe30,0x26838,0x26868,0x243f8,0xe30,0x26898,0x268c8,0x24400,0xe30,0x268f8,0x26928,0x24408,0xe30
.long 0x26958,0x26988,0x24450,0xe30,0x269b8,0x269e8,0x24458,0xe30,0x26a18,0x26a48,0x24460,0xe30,0x26a78,0x26aa8,0x24468,0xe30
.long 0x264d8,0x26508,0x244b0,0xe30,0x26538,0x26568,0x244b8,0xe30,0x26598,0x265c8,0x244c0,0xe30,0x265f8,0x26628,0x244c8,0xe30
.long 0x26658,0x26688,0x24510,0xe30,0x266b8,0x266e8,0x24518,0xe30,0x26718,0x26748,0x24520,0xe30,0x26778,0x267a8,0x24528,0xe30
.long 0x267e0,0x26810,0x24570,0xe30,0x26840,0x26870,0x24578,0xe30,0x268a0,0x268d0,0x24580,0xe30,0x26900,0x26930,0x24588,0xe30
.long 0x26960,0x26990,0x245d0,0xe30,0x269c0,0x269f0,0x245d8,0xe30,0x26a20,0x26a50,0x245e0,0xe30,0x26a80,0x26ab0,0x245e8,0xe30
.long 0x27f40,0x27f40,0x26f00,0x27200,0x27b00,0x27b08,0x26f60,0x27560,0x27b10,0x27b18,0x26fc0,0x27d40,0x27b20,0x27b30,0x27020,0x27d40
.long 0x27b38,0x27b40,0x27260,0x27200,0x27b48,0x27b50,0x272c0,0x27560,0x27f40,0x27f40,0x27320,0x27d40,0x27b60,0x27b68,0x27380,0x27d40
.long 0x27b70,0x27b78,0x27d40,0x27200,0x27b80,0x27b90,0x27d40,0x27560,0x27b98,0x27ba0,0x27d40,0x27d40,0x27ba8,0x27bb0,0x27d40,0x27d40
.long 0x27f40,0x27f40,0x27d40,0x27200,0x27bc0,0x27bc8,0x27d40,0x27560,0x27bd0,0x27bd8,0x27d40,0x27d40,0x27be0,0x27bf0,0x27d40,0x27d40
.long 0x27bf8,0x27c00,0x26f30,0x27230,0x27c08,0x27c10,0x26f90,0x27590,0x27f40,0x27f40,0x26ff0,0x27d40,0x27c20,0x27c28,0x27050,0x27d40
.long 0x27c30,0x27c38,0x27290,0x27230,0x27c40,0x27c50,0x272f0,0x27590,0x27c58,0x27c60,0x27350,0x27d40,0x27c68,0x27c70,0x273b0,0x27d40
.long 0x27f40,0x27f40,0x27d40,0x27230,0x27c80,0x27c88,0x27d40,0x27590,0x27c90,0x27c98,0x27d40,0x27d40,0x27ca0,0x27cb0,0x27d40,0x27d40
.long 0x27cb8,0x27cc0,0x27d40,0x27230,0x27cc8,0x27cd0,0x27d40,0x27590,0x27f40,0x27f40,0x27d40,0x27d40,0x27ce0,0x27ce8,0x27d40,0x27d40
.long 0x27cf0,0x27cf8,0x27d40,0x27d40,0x27d00,0x27d10,0x27d40,0x27d40,0x27d18,0x27d20,0x27d40,0x27920,0x27d28,0x27d30,0x27d40,0x27c80
.long 0x27d28,0x27d30,0x27d40,0x27d40,0x27d28,0x27d30,0x27d40,0x27d40,0x27d28,0x27d30,0x27d40,0x27920,0x27d28,0x27d30,0x27d40,0x27c80
.long 0x27d28,0x27d30,0x27620,0x27d40,0x27d28,0x27d30,0x27680,0x27d40,0x27d28,0x27d30,0x276e0,0x27920,0x27d28,0x27d30,0x27740,0x27c80
.long 0x27d28,0x27d30,0x27980,0x27d40,0x27d28,0x27d30,0x279e0,0x27d40,0x27d28,0x27d30,0x27a40,0x27920,0x27d28,0x27d30,0x27aa0,0x27c80
.long 0x27d28,0x27d30,0x27d40,0x27d40,0x27d28,0x27d30,0x27d40,0x27d40,0x27d28,0x27d30,0x27d40,0x27950,0x27d28,0x27d30,0x27d40,0x27cb0
.long 0x27d28,0x27d30,0x27d40,0x27d40,0x27d28,0x27d30,0x27d40,0x27d40,0x27d28,0x27d30,0x27d40,0x27950,0x27d28,0x27d30,0x27d40,0x27cb0
.long 0x27d28,0x27d30,0x27650,0x27d40,0x27d28,0x27d30,0x276b0,0x27d40,0x27d28,0x27d30,0x27710,0x27950,0x27d28,0x27d30,0x27770,0x27cb0
.long 0x27d28,0x27d30,0x279b0,0x27d40,0x27d28,0x27d30,0x27a10,0x27d40,0x27d28,0x27d30,0x27a70,0x27950,0x27d28,0x27d30,0x27ad0,0x27cb0
.long 0x275c0,0x1b00,0x3180,0x9d80,0x27d40,0x1b10,0x3190,0x9d90,0x27d40,0x1b20,0x31a0,0x9da0,0x27d40,0x1b30,0x31b0,0x9db0
.long 0x275c0,0x1b40,0x31c0,0x9dc0,0x27d40,0x1b50,0x31d0,0x9dd0,0x27d40,0x1b60,0x31e0,0x9de0,0x27d40,0x1b70,0x31f0,0x9df0
.long 0x275c0,0x1f80,0x3600,0x9e00,0x27d40,0x1f90,0x3610,0x9e10,0x27d40,0x1fa0,0x3620,0x9e20,0x27d40,0x1fb0,0x3630,0x9e30
.long 0x275c0,0x1fc0,0x3640,0x9e40,0x27d40,0x1fd0,0x3650,0x9e50,0x27d40,0x1fe0,0x3660,0x9e60,0x27d40,0x1ff0,0x3670,0x9e70
.long 0x275f0,0x6300,0x4380,0x9e80,0x27d40,0x6310,0x4390,0x9e90,0x27d40,0x6320,0x43a0,0x9ea0,0x27d40,0x6330,0x43b0,0x9eb0
.long 0x275f0,0x6340,0x43c0,0x9ec0,0x27d40,0x6350,0x43d0,0x9ed0,0x27d40,0x6360,0x43e0,0x9ee0,0x27d40,0x6370,0x43f0,0x9ef0
.long 0x275f0,0x6780,0x4800,0x9f00,0x27d40,0x6790,0x4810,0x9f10,0x27d40,0x67a0,0x4820,0x9f20,0x27d40,0x67b0,0x4830,0x9f30
.long 0x275f0,0x67c0,0x4840,0x9f40,0x27d40,0x67d0,0x4850,0x9f50,0x27d40,0x67e0,0x4860,0x9f60,0x27d40,0x67f0,0x4870,0x9f70
.long 0x27d40,0x3f00,0x8280,0x9f80,0x27ce0,0x3f10,0x8290,0x9f90,0x27d40,0x3f20,0x82a0,0x9fa0,0x27d40,0x3f30,0x82b0,0x9fb0
.long 0x27d40,0x3f40,0x82c0,0x9fc0,0x27ce0,0x3f50,0x82d0,0x9fd0,0x27d40,0x3f60,0x82e0,0x9fe0,0x27d40,0x3f70,0x82f0,0x9ff0
.long 0x27d40,0x4380,0x8700,0xa000,0x27ce0,0x4390,0x8710,0xa010,0x27d40,0x43a0,0x8720,0xa020,0x27d40,0x43b0,0x8730,0xa030
.long 0x27d40,0x43c0,0x8740,0xa040,0x27ce0,0x43d0,0x8750,0xa050,0x27d40,0x43e0,0x8760,0xa060,0x27d40,0x43f0,0x8770,0xa070
.long 0x27d40,0x8700,0x9480,0xa080,0x27d10,0x8710,0x9490,0xa090,0x27d40,0x8720,0x94a0,0xa0a0,0x27d40,0x8730,0x94b0,0xa0b0
.long 0x27d40,0x8740,0x94c0,0xa0c0,0x27d10,0x8750,0x94d0,0xa0d0,0x27d40,0x8760,0x94e0,0xa0e0,0x27d40,0x8770,0x94f0,0xa0f0
.long 0x27d40,0x8b80,0x9900,0xa100,0x27d10,0x8b90,0x9910,0xa110,0x27d40,0x8ba0,0x9920,0xa120,0x27d40,0x8bb0,0x9930,0xa130
.long 0x27d40,0x8bc0,0x9940,0xa140,0x27d10,0x8bd0,0x9950,0xa150,0x27d40,0x8be0,0x9960,0xa160,0x27d40,0x8bf0,0x9970,0xa170
.long 0x9d80,0x23f00,0x0,0x0,0x9d90,0x23f00,0x200,0x10,0x9da0,0x23f00,0x7ffffff0,0x20,0x9db0,0x23f00,0x7ffffff0,0x30
.long 0x9dc0,0x24720,0x7ffffff0,0x40,0x9dd0,0x24720,0x7ffffff0,0x50,0x9de0,0x24720,0x7ffffff0,0x60,0x9df0,0x24720,0x7ffffff0,0x70
.long 0x70000000,0x24f40,0x7ffffff0,0x80,0x70000000,0x24f40,0x7ffffff0,0x90,0x70000000,0x24f40,0x7ffffff0,0xa0,0x70000000,0x24f40,0x7ffffff0,0xb0
.long 0x70000000,0x25760,0x7ffffff0,0xc0,0x70000000,0x25760,0x7ffffff0,0xd0,0x70000000,0x25760,0x7ffffff0,0xe0,0x70000000,0x25760,0x7ffffff0,0xf0
.long 0x70000000,0x23f08,0x7ffffff0,0x4000,0x70000000,0x23f08,0x7ffffff0,0x4010,0x70000000,0x23f08,0x7ffffff0,0x4020,0x70000000,0x23f08,0x7ffffff0,0x4030
.long 0x70000000,0x24728,0x7ffffff0,0x4040,0x70000000,0x24728,0x7ffffff0,0x4050,0x70000000,0x24728,0x7ffffff0,0x4060,0x70000000,0x24728,0x7ffffff0,0x4070
.long 0x70000000,0x24f48,0x7ffffff0,0x4080,0x70000000,0x24f48,0x7ffffff0,0x4090,0x70000000,0x24f48,0x7ffffff0,0x40a0,0x70000000,0x24f48,0x7ffffff0,0x40b0
.long 0x70000000,0x25768,0x7ffffff0,0x40c0,0x70000000,0x25768,0x7ffffff0,0x40d0,0x70000000,0x25768,0x7ffffff0,0x40e0,0x70000000,0x25768,0x7ffffff0,0x40f0
.long 0x70000000,0x23f10,0x7ffffff0,0x8000,0x70000000,0x23f10,0x7ffffff0,0x8010,0x70000000,0x23f10,0x7ffffff0,0x8020,0x70000000,0x23f10,0x7ffffff0,0x8030
.long 0x70000000,0x24730,0x7ffffff0,0x8040,0x70000000,0x24730,0x7ffffff0,0x8050,0x70000000,0x24730,0x7ffffff0,0x8060,0x70000000,0x24730,0x7ffffff0,0x8070
.long 0x70000000,0x24f50,0x7ffffff0,0x8080,0x70000000,0x24f50,0x7ffffff0,0x8090,0x70000000,0x24f50,0x7ffffff0,0x80a0,0x70000000,0x24f50,0x7ffffff0,0x80b0
.long 0x70000000,0x25770,0x7ffffff0,0x80c0,0x70000000,0x25770,0x7ffffff0,0x80d0,0x70000000,0x25770,0x7ffffff0,0x80e0,0x70000000,0x25770,0x7ffffff0,0x80f0
.long 0x70000000,0x23f18,0x7ffffff0,0xc000,0x70000000,0x23f18,0x7ffffff0,0xc010,0x70000000,0x23f18,0x7ffffff0,0xc020,0x70000000,0x23f18,0x7ffffff0,0xc030
.long 0x70000000,0x24738,0x7ffffff0,0xc040,0x70000000,0x24738,0x7ffffff0,0xc050,0x70000000,0x24738,0x7ffffff0,0xc060,0x70000000,0x24738,0x7ffffff0,0xc070
.long 0x70000000,0x24f58,0x7ffffff0,0xc080,0x70000000,0x24f58,0x7ffffff0,0xc090,0x70000000,0x24f58,0x7ffffff0,0xc0a0,0x70000000,0x24f58,0x7ffffff0,0xc0b0
.long 0x70000000,0x25778,0x7ffffff0,0xc0c0,0x70000000,0x25778,0x7ffffff0,0xc0d0,0x70000000,0x25778,0x7ffffff0,0xc0e0,0x70000000,0x25778,0x7ffffff0,0xc0f0
.long 0x0,0x0,0x1b000,0x1b000,0x8,0x8,0x1b480,0x1b480,0x10,0x10,0x1b900,0x1b900,0x18,0x18,0x1bd80,0x1bd80
.long 0x20,0x20,0x1c200,0x1c200,0x28,0x28,0x1c680,0x1c680,0x30,0x30,0x1cb00,0x1cb00,0x38,0x38,0x1cf80,0x1cf80
.long 0x40,0x40,0x1d400,0x1d400,0x48,0x48,0x1d880,0x1d880,0x50,0x50,0x1dd00,0x1dd00,0x58,0x58,0x1e180,0x1e180
.long 0x60,0x60,0x1e600,0x1e600,0x68,0x68,0x1ea80,0x1ea80,0x70,0x70,0x1ef00,0x1ef00,0x78,0x78,0x1f380,0x1f380
.long 0x80,0x0,0x1b008,0x1f800,0x88,0x8,0x1b488,0x1fc80,0x90,0x10,0x1b908,0x20100,0x98,0x18,0x1bd88,0x20580
.long 0xa0,0x20,0x1c208,0x20a00,0xa8,0x28,0x1c688,0x20e80,0xb0,0x30,0x1cb08,0x21300,0xb8,0x38,0x1cf88,0x21780
.long 0xc0,0x40,0x1d408,0x21c00,0xc8,0x48,0x1d888,0x22080,0xd0,0x50,0x1dd08,0x22500,0xd8,0x58,0x1e188,0x22980
.long 0xe0,0x60,0x1e608,0x22e00,0xe8,0x68,0x1ea88,0x23280,0xf0,0x70,0x1ef08,0x23700,0xf8,0x78,0x1f388,0x23b80
.long 0x100,0x7ffffff0,0x1b010,0x7ffffff0,0x108,0x7ffffff0,0x1b490,0x7ffffff0,0x110,0x7ffffff0,0x1b910,0x7ffffff0,0x118,0x7ffffff0,0x1bd90,0x7ffffff0
.long 0x120,0x7ffffff0,0x1c210,0x7ffffff0,0x128,0x7ffffff0,0x1c690,0x7ffffff0,0x130,0x7ffffff0,0x1cb10,0x7ffffff0,0x138,0x7ffffff0,0x1cf90,0x7ffffff0
.long 0x140,0x7ffffff0,0x1d410,0x7ffffff0,0x148,0x7ffffff0,0x1d890,0x7ffffff0,0x150,0x7ffffff0,0x1dd10,0x7ffffff0,0x158,0x7ffffff0,0x1e190,0x7ffffff0
.long 0x160,0x7ffffff0,0x1e610,0x7ffffff0,0x168,0x7ffffff0,0x1ea90,0x7ffffff0,0x170,0x7ffffff0,0x1ef10,0x7ffffff0,0x178,0x7ffffff0,0x1f390,0x7ffffff0
.long 0x180,0x7ffffff0,0x1b018,0x7ffffff0,0x188,0x7ffffff0,0x1b498,0x7ffffff0,0x190,0x7ffffff0,0x1b918,0x7ffffff0,0x198,0x7ffffff0,0x1bd98,0x7ffffff0
.long 0x1a0,0x7ffffff0,0x1c218,0x7ffffff0,0x1a8,0x7ffffff0,0x1c698,0x7ffffff0,0x1b0,0x7ffffff0,0x1cb18,0x7ffffff0,0x1b8,0x7ffffff0,0x1cf98,0x7ffffff0
.long 0x1c0,0x7ffffff0,0x1d418,0x7ffffff0,0x1c8,0x7ffffff0,0x1d898,0x7ffffff0,0x1d0,0x7ffffff0,0x1dd18,0x7ffffff0,0x1d8,0x7ffffff0,0x1e198,0x7ffffff0
.long 0x1e0,0x7ffffff0,0x1e618,0x7ffffff0,0x1e8,0x7ffffff0,0x1ea98,0x7ffffff0,0x1f0,0x7ffffff0,0x1ef18,0x7ffffff0,0x1f8,0x7ffffff0,0x1f398,0x7ffffff0
L_pad:
.fill ((99840 - (L_pad - parallel_sum__linear_kernel_hedgehog__dense_activation_relu__prompt_kernel)) / 4), 4, 0xbf810000
.section .rodata,"a"
.p2align 6
.amdhsa_kernel parallel_sum__linear_kernel_hedgehog__dense_activation_relu__prompt_kernel
  .amdhsa_next_free_vgpr 512
  .amdhsa_next_free_sgpr 102
  .amdhsa_accum_offset 256
  .amdhsa_group_segment_fixed_size 0
  .amdhsa_kernarg_size 80
  .amdhsa_user_sgpr_count 2
  .amdhsa_user_sgpr_kernarg_segment_ptr 1
  .amdhsa_system_sgpr_workgroup_id_x 1
.end_amdhsa_kernel
```
